```python
import torch

def _softmax(x, axis=-1):
    return torch.softmax(x, dim=axis)
def _gelu(x):
    return torch.nn.functional.gelu(x, approximate="tanh")
def _silu(x):
    return torch.nn.functional.silu(x)
def _sigmoid(x):
    return torch.sigmoid(x)
def _layernorm(x, axis=-1, eps=1e-5):
    m = x.mean(dim=axis, keepdim=True)
    v = x.var(dim=axis, keepdim=True, unbiased=False)
    return (x - m) / torch.sqrt(v + eps)
def _scatter_add(tgt, idx, src, axis=0):
    return tgt.clone().index_add_(axis, idx, src)
def _segment_sum(src, seg, n):
    out = torch.zeros((n,) + src.shape[1:], dtype=src.dtype)
    return out.index_add_(0, seg, src)
def _pad(x, pw):
    flat = tuple(v for pair in reversed(pw) for v in pair)
    return torch.nn.functional.pad(x, flat)

kernel_name = 'sequential_preLN__mha_block_cached__geglu_ffn__decode'

def setup_inputs():

    _w = (lambda a: (lambda t: t.to(torch.bfloat16) if t.is_floating_point() else t)(torch.as_tensor(a)))
    def _A_setup():
        B, Sq, D = 8, 1, 640
        H, Sk, Dh = 32, 4096, 128
        return {
            "x": _w((lambda *s: torch.randn(*s, dtype=torch.bfloat16) * 0.05)(B, Sq, D)),
            "k_cache": _w((lambda *s: torch.randn(*s, dtype=torch.bfloat16) * 3.2)(B, H, Sk, Dh)),
            "v_cache": _w((lambda *s: torch.randn(*s, dtype=torch.bfloat16) * 0.4)(B, H, Sk, Dh)),
            "wq": _w((lambda *s: torch.randn(*s, dtype=torch.bfloat16) * 3.2)(D, H * Dh) * (D ** -0.5)),
            "wo": _w((lambda *s: torch.randn(*s, dtype=torch.bfloat16) * 0.4)(H * Dh, D) * ((H * Dh) ** -0.5)),
        }
    _A_in = _A_setup()

    def _B_setup():
        B, S, D, F = 8, 1, 640, 1728
        return {
            "x": _w((lambda *s: torch.randn(*s, dtype=torch.bfloat16) * 0.05)(B, S, D)),
            "w_gate": _w((lambda *s: torch.randn(*s, dtype=torch.bfloat16) * 0.05)(D, F)),
            "w_up": _w((lambda *s: torch.randn(*s, dtype=torch.bfloat16) * 0.05)(D, F)),
            "w_down": _w((lambda *s: torch.randn(*s, dtype=torch.bfloat16) * 0.05)(F, D)),
        }
    _B_in = _B_setup()

    return {
        "A_x": _A_in["x"],
        "A_k_cache": _A_in["k_cache"],
        "A_v_cache": _A_in["v_cache"],
        "A_wq": _A_in["wq"],
        "A_wo": _A_in["wo"],
        "B_x": _B_in["x"],
        "B_w_gate": _B_in["w_gate"],
        "B_w_up": _B_in["w_up"],
        "B_w_down": _B_in["w_down"],
    }

def reference(A_x, A_k_cache, A_v_cache, A_wq, A_wo, B_x, B_w_gate, B_w_up, B_w_down):
    def _A_ref(x, k_cache, v_cache, wq, wo):
        B, Sq, D = x.shape
        H, Dh = 32, 128
        q = (lambda x, *d: x.permute(*d))((x @ wq).reshape(B, Sq, H, Dh), 0, 2, 1, 3)
        scores = torch.einsum("bhqd,bhkd->bhqk", q, k_cache) * (Dh ** -0.5)
        p = _softmax(scores, axis=-1)
        o = torch.einsum("bhqk,bhkd->bhqd", p, v_cache)
        return (lambda x, *d: x.permute(*d))(o, 0, 2, 1, 3).reshape(B, Sq, H * Dh) @ wo

    def _B_ref(x, w_gate, w_up, w_down):
        return (_gelu(x @ w_gate) * (x @ w_up)) @ w_down

    x = A_x
    h = x + _A_ref(_layernorm(x, axis=-1), A_k_cache, A_v_cache, A_wq, A_wo)
    h2 = h + _B_ref(_layernorm(h, axis=-1), B_w_gate, B_w_up, B_w_down)
    return h2
```

```asm
; @launch grid=(256,1,1) block=(256,1,1) lds=117760
.amdgcn_target "amdgcn-amd-amdhsa--gfx950"
.text
.globl sequential_preLN__mha_block_cached__geglu_ffn__decode_kernel
.p2align 8
.type sequential_preLN__mha_block_cached__geglu_ffn__decode_kernel,@function
sequential_preLN__mha_block_cached__geglu_ffn__decode_kernel:
    s_cmp_ge_u32 s2, 256
    s_cbranch_scc1 L_end
    s_load_dwordx16 s[4:19], s[0:1], 0
    s_load_dwordx8 s[20:27], s[0:1], 64
    s_sub_u32 s30, s2, 0
    s_cmp_ge_u32 s30, 24
    s_cbranch_scc1 L_nocw
    s_getpc_b64 s[28:29]
L_cw:
    s_sub_u32 s28, s28, L_cw-sequential_preLN__mha_block_cached__geglu_ffn__decode_kernel
    s_subb_u32 s29, s29, 0
    s_lshr_b32 s30, s30, 3
    s_lshl_b32 s30, s30, 14
    v_lshlrev_b32 v40, 6, v0
    v_add_u32 v40, s30, v40
    v_min_u32 v40, L_end-sequential_preLN__mha_block_cached__geglu_ffn__decode_kernel, v40
    v_mov_b32 v41, s29
    v_add_co_u32 v40, vcc, s28, v40
    s_nop 1
    v_addc_co_u32 v41, vcc, 0, v41, vcc
    global_load_dword v42, v[40:41], off
L_nocw:
    v_and_b32 v1, 63, v0
    v_lshrrev_b32 v45, 6, v0
    v_lshrrev_b32 v46, 4, v1
    v_and_b32 v47, 15, v1
    v_readfirstlane_b32 s3, v45
    s_and_b32 s72, s2, 7
    s_lshr_b32 s73, s2, 3
    s_and_b32 s74, s73, 3
    s_lshl_b32 s75, s72, 2
    s_add_u32 s74, s74, s75
    s_lshr_b32 s75, s73, 2
    s_lshl_b32 s76, s75, 5
    s_add_u32 s76, s76, s74
    s_mul_i32 s78, s3, 0
    v_lshlrev_b32 v2, 4, v47
    v_bfe_i32 v58, v1, 4, 1
    v_and_b32 v58, 0x8000, v58
    v_xor_b32 v2, v2, v58
    v_bfe_i32 v58, v1, 5, 1
    v_and_b32 v58, 0x10000, v58
    v_xor_b32 v2, v2, v58
    s_lshl_b32 s78, s76, 20
    s_lshr_b32 s79, s76, 12
    s_mov_b32 s100, 0
    s_mov_b32 s30, 0x100000
    s_mov_b32 s31, 0x20000
    v_and_b32 v62, 7, v47
    v_mul_u32_u24 v3, 1280, v62
    v_lshrrev_b32 v56, 3, v1
    v_lshl_add_u32 v57, v56, 4, v3
    v_lshl_add_u32 v3, v46, 4, v3
    s_and_b32 s77, s75, 3
    s_lshl_b32 s80, s76, 8
    v_or_b32 v58, s80, v0
    v_and_b32 v24, 0xad90, v58
    v_and_b32 v25, 0x7e02, v58
    v_and_b32 v26, 0x1c40, v58
    v_and_b32 v27, 0x7508, v58
    v_and_b32 v28, 0x3801, v58
    v_and_b32 v29, 0x9481, v58
    v_and_b32 v30, 0x9104, v58
    v_and_b32 v31, 0x0, v58
    v_and_b32 v32, 0x0, v58
    v_and_b32 v33, 0x8008, v58
    v_and_b32 v34, 0x10, v58
    v_and_b32 v35, 0x24, v58
    v_bcnt_u32_b32 v24, v24, 0
    v_bcnt_u32_b32 v25, v25, 0
    v_bcnt_u32_b32 v26, v26, 0
    v_bcnt_u32_b32 v27, v27, 0
    v_bcnt_u32_b32 v28, v28, 0
    v_bcnt_u32_b32 v29, v29, 0
    v_bcnt_u32_b32 v30, v30, 0
    v_bcnt_u32_b32 v31, v31, 0
    v_bcnt_u32_b32 v32, v32, 0
    v_bcnt_u32_b32 v33, v33, 0
    v_bcnt_u32_b32 v34, v34, 0
    v_bcnt_u32_b32 v35, v35, 0
    v_alignbit_b32 v61, v24, 0, 1
    v_alignbit_b32 v61, v25, v61, 1
    v_alignbit_b32 v61, v26, v61, 1
    v_alignbit_b32 v61, v27, v61, 1
    v_alignbit_b32 v61, v28, v61, 1
    v_alignbit_b32 v61, v29, v61, 1
    v_alignbit_b32 v61, v30, v61, 1
    v_alignbit_b32 v61, v31, v61, 1
    v_alignbit_b32 v61, v32, v61, 1
    v_alignbit_b32 v61, v33, v61, 1
    v_alignbit_b32 v61, v34, v61, 1
    v_alignbit_b32 v61, v35, v61, 1
    v_lshrrev_b32 v61, 12, v61
    s_nop 0
    v_readlane_b32 s80, v61, 0
    s_mov_b32 s101, s80
    s_waitcnt lgkmcnt(0)
    s_add_u32 s28, s6, s78
    s_addc_u32 s29, s7, s79
    v_xor_b32 v45, s80, v2
    buffer_load_dwordx4 v[64:67], v45, s[28:31], 0 offen nt
    s_xor_b32 s80, s101, 0x10100
    v_xor_b32 v45, s80, v2
    buffer_load_dwordx4 v[68:71], v45, s[28:31], 0 offen nt
    s_xor_b32 s80, s101, 0x800
    s_cmp_lg_u32 s3, 0
    s_cbranch_scc1 L_noclr
    s_mov_b32 s44, s26
    s_mov_b32 s45, s27
    s_mov_b32 s46, 1552384
    s_mov_b32 s47, 0x20000
    s_mul_i32 s14, s2, 3376
    v_lshlrev_b32 v58, 4, v1
    v_mov_b32 v52, -1
    v_mov_b32 v53, -1
    v_mov_b32 v54, -1
    v_mov_b32 v55, -1
    buffer_store_dwordx4 v[52:55], v58, s[44:47], s14 offen offset:0 sc1
    buffer_store_dwordx4 v[52:55], v58, s[44:47], s14 offen offset:1024 sc1
    buffer_store_dwordx4 v[52:55], v58, s[44:47], s14 offen offset:2048 sc1
    s_mov_b32 exec_lo, 0x7ffff
    s_mov_b32 exec_hi, 0x0
    buffer_store_dwordx4 v[52:55], v58, s[44:47], s14 offen offset:3072 sc1
    s_mov_b64 exec, -1
L_noclr:
    v_xor_b32 v45, s80, v2
    buffer_load_dwordx4 v[72:75], v45, s[28:31], 0 offen nt
    s_xor_b32 s80, s101, 0x10900
    v_xor_b32 v45, s80, v2
    buffer_load_dwordx4 v[76:79], v45, s[28:31], 0 offen nt
    s_add_u32 s100, s100, 1
    v_readlane_b32 s101, v61, s100
    s_mov_b32 s80, s101
    v_xor_b32 v45, s80, v2
    buffer_load_dwordx4 v[80:83], v45, s[28:31], 0 offen nt
    s_xor_b32 s80, s101, 0x10100
    s_mov_b32 s48, s4
    s_mov_b32 s49, s5
    s_mov_b32 s50, 10240
    s_mov_b32 s51, 0x20000
    s_mov_b32 s36, s10
    s_mov_b32 s37, s11
    s_mov_b32 s38, 5242880
    s_mov_b32 s39, 0x20000
    s_mul_i32 s14, s75, 1280
    v_mul_u32_u24 v56, 20, v1
    s_mul_i32 s15, s75, 5
    s_mul_i32 s81, s3, 320
    s_add_u32 s81, s81, s14
    v_lshlrev_b32 v57, 1, v46
    s_mul_i32 s14, s75, 1280
    buffer_load_dwordx4 v[24:27], v56, s[48:51], s14 offen
    buffer_load_dword v28, v56, s[48:51], s14 offen offset:16
    v_add_u32 v58, s15, v47
    v_subrev_u32 v59, 40, v58
    v_min_u32 v58, v58, v59
    v_lshl_add_u32 v58, v58, 3, v57
    buffer_load_ushort v29, v58, s[48:51], s81 offen
    v_add_u32 v58, s15, v47
    v_add_u32 v58, 16, v58
    v_subrev_u32 v59, 40, v58
    v_min_u32 v58, v58, v59
    v_lshl_add_u32 v58, v58, 3, v57
    buffer_load_ushort v30, v58, s[48:51], s81 offen
    v_add_u32 v58, s15, v47
    v_add_u32 v58, 32, v58
    v_subrev_u32 v59, 40, v58
    v_min_u32 v58, v58, v59
    v_lshl_add_u32 v58, v58, 3, v57
    buffer_load_ushort v31, v58, s[48:51], s81 offen
    s_mul_i32 s14, s3, 160
    v_add_u32 v43, s14, v46
    v_lshlrev_b32 v43, 13, v43
    v_lshl_add_u32 v43, v47, 4, v43
    s_lshl_b32 s14, s74, 8
    v_add_u32 v43, s14, v43
    s_mul_i32 s82, s75, 163840
    buffer_load_dwordx4 a[192:195], v43, s[36:39], s82 offen
    s_add_u32 s82, s82, 32768
    s_cmp_eq_u32 s82, 1310720
    s_cselect_b32 s82, 0, s82
    buffer_load_dwordx4 a[196:199], v43, s[36:39], s82 offen
    s_add_u32 s82, s82, 32768
    s_cmp_eq_u32 s82, 1310720
    s_cselect_b32 s82, 0, s82
    buffer_load_dwordx4 a[200:203], v43, s[36:39], s82 offen
    s_add_u32 s82, s82, 32768
    s_cmp_eq_u32 s82, 1310720
    s_cselect_b32 s82, 0, s82
    buffer_load_dwordx4 a[204:207], v43, s[36:39], s82 offen
    s_add_u32 s82, s82, 32768
    s_cmp_eq_u32 s82, 1310720
    s_cselect_b32 s82, 0, s82
    buffer_load_dwordx4 a[208:211], v43, s[36:39], s82 offen
    s_add_u32 s82, s82, 32768
    s_cmp_eq_u32 s82, 1310720
    s_cselect_b32 s82, 0, s82
    v_xor_b32 v45, s80, v2
    buffer_load_dwordx4 v[84:87], v45, s[28:31], 0 offen nt
    s_xor_b32 s80, s101, 0x800
    v_mov_b32 v58, 43
    v_mov_b32 v59, 96
    v_mov_b32 v50, 0
    ds_write_b64 v50, v[58:59] offset:21248
    s_lshl_b32 s14, s2, 2
    s_add_u32 s83, s14, s3
    s_cmp_lg_u32 s83, 1
    s_cbranch_scc1 L_nofz
    s_mov_b32 s44, s26
    s_mov_b32 s45, s27
    s_mov_b32 s46, 1552384
    s_mov_b32 s47, 0x20000
    v_lshrrev_b32 v48, 1, v1
    v_mul_u32_u24 v48, 4224, v48
    v_and_b32 v49, 1, v1
    v_lshl_add_u32 v48, v49, 4, v48
    s_mov_b32 s14, 1388544
    v_mov_b32 v52, 0
    v_mov_b32 v53, 0
    v_mov_b32 v54, 0
    v_mov_b32 v55, 0
    buffer_store_dwordx4 v[52:55], v48, s[44:47], s14 offen sc1
L_nofz:
    s_mov_b32 s44, s26
    s_mov_b32 s45, s27
    s_mov_b32 s46, 1552384
    s_mov_b32 s47, 0x20000
    s_add_u32 s8, s8, s78
    s_addc_u32 s9, s9, s79
    s_mov_b32 s40, s12
    s_mov_b32 s41, s13
    s_mov_b32 s42, 5242880
    s_mov_b32 s43, 0x20000
    s_mov_b32 s64, s22
    s_mov_b32 s65, s23
    s_mov_b32 s66, 10240
    s_mov_b32 s67, 0x20000
    s_mov_b32 s68, s24
    s_mov_b32 s69, s25
    s_mov_b32 s70, 256
    s_mov_b32 s71, 0x20000
    s_lshr_b32 s14, s73, 1
    s_lshl_b32 s15, s14, 3
    s_add_u32 s15, s15, s72
    s_mov_b32 s14, s15
    s_cmp_lt_u32 s15, 27
    s_cselect_b32 s15, 1, 0
    s_cmp_lt_u32 s73, 24
    s_cselect_b32 s52, s16, s20
    s_cselect_b32 s53, s17, s21
    s_mov_b32 s56, s18
    s_mov_b32 s57, s19
    s_mov_b32 s54, 2211840
    s_mov_b32 s55, 0x20000
    s_mov_b32 s58, 2211840
    s_mov_b32 s59, 0x20000
    s_lshl_b32 s14, s14, 1
    s_and_b32 s81, s73, 1
    s_add_u32 s18, s14, s81
    s_sub_u32 s81, s73, 8
    s_cmp_lt_u32 s81, 5
    s_cselect_b32 s15, 2, s15
    s_lshl_b32 s81, s81, 2
    s_add_u32 s81, s81, s3
    s_lshl_b32 s81, s81, 6
    s_mul_i32 s20, s72, 1280
    s_add_u32 s20, s20, s81
    s_cmp_eq_u32 s15, 2
    s_cselect_b32 s20, s20, 2130706432
    s_lshl_b32 s14, s72, 2
    s_and_b32 s81, s73, 3
    s_add_u32 s14, s14, s81
    s_add_u32 s81, s14, 32
    s_cmp_ge_u32 s73, 28
    s_cselect_b32 s14, s14, s81
    s_cmp_ge_u32 s73, 24
    s_cselect_b32 s14, s14, 64
    s_cmp_lt_u32 s14, 40
    s_cselect_b32 s15, 3, s15
    s_cselect_b32 s18, s14, s18
    s_mov_b32 s19, s15
    s_lshr_b32 s14, s18, 2
    s_and_b32 s14, s14, 3
    s_mul_i32 s14, s14, 27648
    s_cmp_eq_u32 s15, 3
    s_cselect_b32 s14, s14, 0
    s_mov_b32 s34, 110592
    s_cselect_b32 s34, 27648, s34
    s_add_u32 s14, s14, 752128
    s_add_u32 s32, s26, s14
    s_addc_u32 s33, s27, 0
    s_mov_b32 s35, 0x20000
    s_mov_b32 s10, 0xcccccccc
    s_mov_b32 s11, 0xcccccccc
    s_mov_b32 s12, 0xaaaaaaaa
    s_mov_b32 s13, 0xaaaaaaaa
    v_and_b32 v58, 1, v47
    v_lshlrev_b32 v58, 4, v58
    v_mov_b32 v59, 0xffff
    v_lshlrev_b32 v58, v58, v59
    v_lshrrev_b32 v59, 1, v47
    v_cmp_eq_u32 vcc, 0, v59
    s_nop 1
    v_cndmask_b32 v4, 0, v58, vcc
    v_cmp_eq_u32 vcc, 1, v59
    s_nop 1
    v_cndmask_b32 v5, 0, v58, vcc
    v_cmp_eq_u32 vcc, 2, v59
    s_nop 1
    v_cndmask_b32 v6, 0, v58, vcc
    v_cmp_eq_u32 vcc, 3, v59
    s_nop 1
    v_cndmask_b32 v7, 0, v58, vcc
    s_lshl_b32 s14, s74, 7
    s_lshl_b32 s15, s3, 8
    v_add_u32 v60, s14, v46
    v_mul_u32_u24 v60, 1280, v60
    v_lshl_add_u32 v60, v47, 4, v60
    v_add_u32 v60, s15, v60
    v_lshlrev_b32 v63, 9, v46
    v_lshl_add_u32 v63, v47, 5, v63
    s_lshl_b32 s22, s74, 3
    s_add_u32 s21, s22, s75
    s_lshl_b32 s21, s21, 11
    s_add_u32 s21, s21, 864256
    s_mul_i32 s22, s74, 4224
    s_lshl_b32 s14, s75, 2
    s_add_u32 s22, s22, s14
    s_add_u32 s22, s22, 1388544
    s_mul_i32 s24, s72, 10752
    s_add_u32 s24, s24, 665600
    s_lshl_b32 s25, s73, 2
    s_add_u32 s25, s25, s24
    s_add_u32 s6, s24, 128
    s_add_u32 s27, s24, 256
    s_lshl_b32 s14, s3, 12
    s_add_u32 s14, s14, 4096
    v_lshlrev_b32 v44, 2, v1
    v_add_u32 v44, s14, v44
    s_mov_b32 s16, 0x3db504f3
    s_waitcnt vmcnt(6)
    s_lshl_b32 s14, s74, 3
    s_add_u32 s14, s14, s75
    s_mul_i32 s77, s14, 20480
    v_cmp_gt_u32 vcc, 160, v0
    v_lshlrev_b32 v63, 7, v0
    v_mov_b32 v62, 2130706432
    v_cndmask_b32 v63, v62, v63, vcc
    s_and_b32 s81, s73, 0
    s_cmp_eq_u32 s3, 3
    s_cselect_b32 s81, 99, s81
    s_mov_b32 s14, 0x3f803f80
    v_dot2_f32_bf16 v32, v24, s14, 0
    v_dot2_f32_bf16 v33, v25, s14, 0
    v_dot2_f32_bf16 v32, v26, s14, v32
    v_dot2_f32_bf16 v33, v27, s14, v33
    v_dot2_f32_bf16 v32, v28, s14, v32
    s_nop 2
    v_add_f32 v32, v32, v33
    s_nop 1
    v_add_f32_dpp v32, v32, v32 quad_perm:[1,0,3,2] row_mask:0xf bank_mask:0xf
    s_nop 1
    v_add_f32_dpp v32, v32, v32 quad_perm:[2,3,0,1] row_mask:0xf bank_mask:0xf
    s_nop 1
    v_add_f32_dpp v32, v32, v32 row_half_mirror row_mask:0xf bank_mask:0xf
    s_nop 1
    v_add_f32_dpp v32, v32, v32 row_ror:8 row_mask:0xf bank_mask:0xf
    v_mov_b32 v33, v32
    s_nop 1
    v_permlane16_swap_b32 v32, v33
    v_add_f32 v32, v32, v33
    v_mov_b32 v33, v32
    s_nop 1
    v_permlane32_swap_b32 v32, v33
    v_add_f32 v32, v32, v33
    v_mul_f32 v34, 0xbacccccd, v32
    v_mov_b32 v35, v34
    v_lshlrev_b32 v48, 16, v24
    v_and_b32 v49, 0xffff0000, v24
    v_pk_add_f32 v[48:49], v[48:49], v[34:35]
    v_pk_mul_f32 v[36:37], v[48:49], v[48:49]
    v_lshlrev_b32 v50, 16, v25
    v_and_b32 v51, 0xffff0000, v25
    v_pk_add_f32 v[50:51], v[50:51], v[34:35]
    v_pk_fma_f32 v[36:37], v[50:51], v[50:51], v[36:37]
    v_lshlrev_b32 v52, 16, v26
    v_and_b32 v53, 0xffff0000, v26
    v_pk_add_f32 v[52:53], v[52:53], v[34:35]
    v_xor_b32 v45, s80, v2
    buffer_load_dwordx4 v[88:91], v45, s[28:31], 0 offen nt
    s_xor_b32 s80, s101, 0x10900
    s_cmp_lg_u32 s81, 0
    s_cbranch_scc1 L_wt0
    buffer_load_dword v62, v63, s[40:43], s77 offen
L_wt0:
    buffer_load_dwordx4 a[212:215], v43, s[36:39], s82 offen
    s_add_u32 s82, s82, 32768
    s_cmp_eq_u32 s82, 1310720
    s_cselect_b32 s82, 0, s82
    v_pk_fma_f32 v[36:37], v[52:53], v[52:53], v[36:37]
    v_lshlrev_b32 v54, 16, v27
    v_and_b32 v55, 0xffff0000, v27
    v_pk_add_f32 v[54:55], v[54:55], v[34:35]
    v_pk_fma_f32 v[36:37], v[54:55], v[54:55], v[36:37]
    v_lshlrev_b32 v48, 16, v28
    v_and_b32 v49, 0xffff0000, v28
    v_pk_add_f32 v[48:49], v[48:49], v[34:35]
    v_pk_fma_f32 v[36:37], v[48:49], v[48:49], v[36:37]
    v_add_f32 v33, v36, v37
    s_nop 1
    v_add_f32_dpp v33, v33, v33 quad_perm:[1,0,3,2] row_mask:0xf bank_mask:0xf
    s_nop 1
    v_add_f32_dpp v33, v33, v33 quad_perm:[2,3,0,1] row_mask:0xf bank_mask:0xf
    s_nop 1
    v_add_f32_dpp v33, v33, v33 row_half_mirror row_mask:0xf bank_mask:0xf
    s_nop 1
    v_add_f32_dpp v33, v33, v33 row_ror:8 row_mask:0xf bank_mask:0xf
    v_mov_b32 v34, v33
    s_nop 1
    v_permlane16_swap_b32 v33, v34
    v_add_f32 v33, v33, v34
    v_mov_b32 v34, v33
    s_nop 1
    v_permlane32_swap_b32 v33, v34
    v_add_f32 v33, v33, v34
    v_mul_f32 v32, 0x3acccccd, v32
    v_mul_f32 v33, 0x3acccccd, v33
    v_cvt_pk_bf16_f32 v35, v32, v32
    v_lshlrev_b32 v32, 16, v35
    v_cvt_pk_bf16_f32 v35, v33, v33
    v_lshlrev_b32 v33, 16, v35
    v_add_f32 v33, 0x3727c5ac, v33
    v_cvt_pk_bf16_f32 v35, v33, v33
    v_lshlrev_b32 v33, 16, v35
    v_sqrt_f32 v33, v33
    v_xor_b32 v45, s80, v2
    buffer_load_dwordx4 v[92:95], v45, s[28:31], 0 offen nt
    s_add_u32 s100, s100, 1
    v_readlane_b32 s101, v61, s100
    s_mov_b32 s80, s101
    buffer_load_dwordx4 a[216:219], v43, s[36:39], s82 offen
    s_add_u32 s82, s82, 32768
    s_cmp_eq_u32 s82, 1310720
    s_cselect_b32 s82, 0, s82
    v_cvt_pk_bf16_f32 v35, v33, v33
    v_lshlrev_b32 v33, 16, v35
    v_rcp_f32 v34, v33
    v_lshlrev_b32 v29, 16, v29
    v_lshlrev_b32 v30, 16, v30
    v_lshlrev_b32 v31, 16, v31
    v_sub_f32 v29, v29, v32
    v_sub_f32 v30, v30, v32
    v_sub_f32 v31, v31, v32
    v_cvt_pk_bf16_f32 v36, v29, v29
    v_lshlrev_b32 v29, 16, v36
    v_cvt_pk_bf16_f32 v37, v30, v30
    v_lshlrev_b32 v30, 16, v37
    v_cvt_pk_bf16_f32 v38, v31, v31
    v_lshlrev_b32 v31, 16, v38
    v_mul_f32 v29, v29, v34
    v_mul_f32 v30, v30, v34
    v_mul_f32 v31, v31, v34
    v_cvt_pk_bf16_f32 v24, v29, v29
    v_cvt_pk_bf16_f32 v25, v30, v30
    v_cvt_pk_bf16_f32 v26, v31, v31
    s_cmp_lg_u32 s83, 1
    s_cbranch_scc1 L_nofi
    s_waitcnt vmcnt(0)
    v_mov_b32 v51, 1
    v_mov_b32 v54, 0
    s_mov_b64 exec, 1
    buffer_store_dword v51, v54, s[68:71], 0 offen sc1
    s_mov_b64 exec, -1
L_nofi:
    v_and_b32_dpp v16, v24, v4 row_newbcast:0 row_mask:0xf bank_mask:0xf
    v_and_b32_dpp v17, v24, v5 row_newbcast:0 row_mask:0xf bank_mask:0xf
    v_and_b32_dpp v18, v24, v6 row_newbcast:0 row_mask:0xf bank_mask:0xf
    v_and_b32_dpp v19, v24, v7 row_newbcast:0 row_mask:0xf bank_mask:0xf
    s_waitcnt vmcnt(9)
    s_nop 0
    v_mfma_f32_16x16x32_bf16 v[12:15], v[16:19], a[192:195], 0
    v_and_b32_dpp v20, v24, v4 row_newbcast:1 row_mask:0xf bank_mask:0xf
    v_and_b32_dpp v21, v24, v5 row_newbcast:1 row_mask:0xf bank_mask:0xf
    v_and_b32_dpp v22, v24, v6 row_newbcast:1 row_mask:0xf bank_mask:0xf
    v_and_b32_dpp v23, v24, v7 row_newbcast:1 row_mask:0xf bank_mask:0xf
    v_xor_b32 v45, s80, v2
    buffer_load_dwordx4 v[96:99], v45, s[28:31], 0 offen nt
    s_xor_b32 s80, s101, 0x10100
    s_waitcnt vmcnt(9)
    v_mfma_f32_16x16x32_bf16 v[12:15], v[20:23], a[196:199], v[12:15]
    v_and_b32_dpp v16, v24, v4 row_newbcast:2 row_mask:0xf bank_mask:0xf
    v_and_b32_dpp v17, v24, v5 row_newbcast:2 row_mask:0xf bank_mask:0xf
    v_and_b32_dpp v18, v24, v6 row_newbcast:2 row_mask:0xf bank_mask:0xf
    v_and_b32_dpp v19, v24, v7 row_newbcast:2 row_mask:0xf bank_mask:0xf
    v_xor_b32 v45, s80, v2
    buffer_load_dwordx4 v[100:103], v45, s[28:31], 0 offen nt
    s_xor_b32 s80, s101, 0x800
    s_waitcnt vmcnt(6)
    v_xor_b32 v45, s80, v2
    buffer_load_dwordx4 v[104:107], v45, s[28:31], 0 offen nt
    s_xor_b32 s80, s101, 0x10900
    buffer_load_dwordx4 a[220:223], v43, s[36:39], s82 offen
    s_add_u32 s82, s82, 32768
    s_cmp_eq_u32 s82, 1310720
    s_cselect_b32 s82, 0, s82
    v_mfma_f32_16x16x32_bf16 v[12:15], v[16:19], a[200:203], v[12:15]
    v_and_b32_dpp v20, v24, v4 row_newbcast:3 row_mask:0xf bank_mask:0xf
    v_and_b32_dpp v21, v24, v5 row_newbcast:3 row_mask:0xf bank_mask:0xf
    v_and_b32_dpp v22, v24, v6 row_newbcast:3 row_mask:0xf bank_mask:0xf
    v_and_b32_dpp v23, v24, v7 row_newbcast:3 row_mask:0xf bank_mask:0xf
    s_waitcnt vmcnt(7)
    v_xor_b32 v45, s80, v2
    buffer_load_dwordx4 v[108:111], v45, s[28:31], 0 offen nt
    s_add_u32 s100, s100, 1
    v_readlane_b32 s101, v61, s100
    s_mov_b32 s80, s101
    s_waitcnt vmcnt(6)
    v_xor_b32 v45, s80, v2
    buffer_load_dwordx4 v[112:115], v45, s[28:31], 0 offen nt
    s_xor_b32 s80, s101, 0x10100
    buffer_load_dwordx4 a[224:227], v43, s[36:39], s82 offen
    s_add_u32 s82, s82, 32768
    s_cmp_eq_u32 s82, 1310720
    s_cselect_b32 s82, 0, s82
    v_mfma_f32_16x16x32_bf16 v[12:15], v[20:23], a[204:207], v[12:15]
    v_and_b32_dpp v16, v24, v4 row_newbcast:4 row_mask:0xf bank_mask:0xf
    v_and_b32_dpp v17, v24, v5 row_newbcast:4 row_mask:0xf bank_mask:0xf
    v_and_b32_dpp v18, v24, v6 row_newbcast:4 row_mask:0xf bank_mask:0xf
    v_and_b32_dpp v19, v24, v7 row_newbcast:4 row_mask:0xf bank_mask:0xf
    s_waitcnt vmcnt(6)
    v_xor_b32 v45, s80, v2
    buffer_load_dwordx4 v[116:119], v45, s[28:31], 0 offen nt
    s_xor_b32 s80, s101, 0x800
    s_waitcnt vmcnt(6)
    v_xor_b32 v45, s80, v2
    buffer_load_dwordx4 v[120:123], v45, s[28:31], 0 offen nt
    s_xor_b32 s80, s101, 0x10900
    buffer_load_dwordx4 a[228:231], v43, s[36:39], s82 offen
    s_add_u32 s82, s82, 32768
    s_cmp_eq_u32 s82, 1310720
    s_cselect_b32 s82, 0, s82
    v_mfma_f32_16x16x32_bf16 v[12:15], v[16:19], a[208:211], v[12:15]
    v_and_b32_dpp v20, v24, v4 row_newbcast:5 row_mask:0xf bank_mask:0xf
    v_and_b32_dpp v21, v24, v5 row_newbcast:5 row_mask:0xf bank_mask:0xf
    v_and_b32_dpp v22, v24, v6 row_newbcast:5 row_mask:0xf bank_mask:0xf
    v_and_b32_dpp v23, v24, v7 row_newbcast:5 row_mask:0xf bank_mask:0xf
    s_waitcnt vmcnt(7)
    v_xor_b32 v45, s80, v2
    buffer_load_dwordx4 v[124:127], v45, s[28:31], 0 offen nt
    s_add_u32 s100, s100, 1
    v_readlane_b32 s101, v61, s100
    s_mov_b32 s80, s101
    buffer_load_dwordx4 a[232:235], v43, s[36:39], s82 offen
    s_add_u32 s82, s82, 32768
    s_cmp_eq_u32 s82, 1310720
    s_cselect_b32 s82, 0, s82
    v_mfma_f32_16x16x32_bf16 v[12:15], v[20:23], a[212:215], v[12:15]
    v_and_b32_dpp v16, v24, v4 row_newbcast:6 row_mask:0xf bank_mask:0xf
    v_and_b32_dpp v17, v24, v5 row_newbcast:6 row_mask:0xf bank_mask:0xf
    v_and_b32_dpp v18, v24, v6 row_newbcast:6 row_mask:0xf bank_mask:0xf
    v_and_b32_dpp v19, v24, v7 row_newbcast:6 row_mask:0xf bank_mask:0xf
    s_waitcnt vmcnt(7)
    v_xor_b32 v45, s80, v2
    buffer_load_dwordx4 v[128:131], v45, s[28:31], 0 offen nt
    s_xor_b32 s80, s101, 0x10100
    s_waitcnt vmcnt(7)
    v_xor_b32 v45, s80, v2
    buffer_load_dwordx4 v[132:135], v45, s[28:31], 0 offen nt
    s_xor_b32 s80, s101, 0x800
    buffer_load_dwordx4 a[236:239], v43, s[36:39], s82 offen
    s_add_u32 s82, s82, 32768
    s_cmp_eq_u32 s82, 1310720
    s_cselect_b32 s82, 0, s82
    v_mfma_f32_16x16x32_bf16 v[12:15], v[16:19], a[216:219], v[12:15]
    v_and_b32_dpp v20, v24, v4 row_newbcast:7 row_mask:0xf bank_mask:0xf
    v_and_b32_dpp v21, v24, v5 row_newbcast:7 row_mask:0xf bank_mask:0xf
    v_and_b32_dpp v22, v24, v6 row_newbcast:7 row_mask:0xf bank_mask:0xf
    v_and_b32_dpp v23, v24, v7 row_newbcast:7 row_mask:0xf bank_mask:0xf
    s_waitcnt vmcnt(7)
    v_xor_b32 v45, s80, v2
    buffer_load_dwordx4 v[136:139], v45, s[28:31], 0 offen nt
    s_xor_b32 s80, s101, 0x10900
    s_waitcnt vmcnt(7)
    v_xor_b32 v45, s80, v2
    buffer_load_dwordx4 v[140:143], v45, s[28:31], 0 offen nt
    s_add_u32 s100, s100, 1
    v_readlane_b32 s101, v61, s100
    s_mov_b32 s80, s101
    buffer_load_dwordx4 a[240:243], v43, s[36:39], s82 offen
    s_add_u32 s82, s82, 32768
    s_cmp_eq_u32 s82, 1310720
    s_cselect_b32 s82, 0, s82
    v_mfma_f32_16x16x32_bf16 v[12:15], v[20:23], a[220:223], v[12:15]
    v_and_b32_dpp v16, v24, v4 row_newbcast:8 row_mask:0xf bank_mask:0xf
    v_and_b32_dpp v17, v24, v5 row_newbcast:8 row_mask:0xf bank_mask:0xf
    v_and_b32_dpp v18, v24, v6 row_newbcast:8 row_mask:0xf bank_mask:0xf
    v_and_b32_dpp v19, v24, v7 row_newbcast:8 row_mask:0xf bank_mask:0xf
    s_waitcnt vmcnt(7)
    v_xor_b32 v45, s80, v2
    buffer_load_dwordx4 v[144:147], v45, s[28:31], 0 offen nt
    s_xor_b32 s80, s101, 0x10100
    s_waitcnt vmcnt(6)
    v_xor_b32 v45, s80, v2
    buffer_load_dwordx4 v[148:151], v45, s[28:31], 0 offen nt
    s_xor_b32 s80, s101, 0x800
    buffer_load_dwordx4 a[244:247], v43, s[36:39], s82 offen
    s_add_u32 s82, s82, 32768
    s_cmp_eq_u32 s82, 1310720
    s_cselect_b32 s82, 0, s82
    v_mfma_f32_16x16x32_bf16 v[12:15], v[16:19], a[224:227], v[12:15]
    v_and_b32_dpp v20, v24, v4 row_newbcast:9 row_mask:0xf bank_mask:0xf
    v_and_b32_dpp v21, v24, v5 row_newbcast:9 row_mask:0xf bank_mask:0xf
    v_and_b32_dpp v22, v24, v6 row_newbcast:9 row_mask:0xf bank_mask:0xf
    v_and_b32_dpp v23, v24, v7 row_newbcast:9 row_mask:0xf bank_mask:0xf
    s_waitcnt vmcnt(7)
    v_xor_b32 v45, s80, v2
    buffer_load_dwordx4 v[152:155], v45, s[28:31], 0 offen nt
    s_xor_b32 s80, s101, 0x10900
    buffer_load_dwordx4 a[248:251], v43, s[36:39], s82 offen
    s_add_u32 s82, s82, 32768
    s_cmp_eq_u32 s82, 1310720
    s_cselect_b32 s82, 0, s82
    v_mfma_f32_16x16x32_bf16 v[12:15], v[20:23], a[228:231], v[12:15]
    v_and_b32_dpp v16, v24, v4 row_newbcast:10 row_mask:0xf bank_mask:0xf
    v_and_b32_dpp v17, v24, v5 row_newbcast:10 row_mask:0xf bank_mask:0xf
    v_and_b32_dpp v18, v24, v6 row_newbcast:10 row_mask:0xf bank_mask:0xf
    v_and_b32_dpp v19, v24, v7 row_newbcast:10 row_mask:0xf bank_mask:0xf
    s_waitcnt vmcnt(7)
    v_xor_b32 v45, s80, v2
    buffer_load_dwordx4 v[156:159], v45, s[28:31], 0 offen nt
    s_add_u32 s100, s100, 1
    v_readlane_b32 s101, v61, s100
    s_mov_b32 s80, s101
    s_waitcnt vmcnt(7)
    v_xor_b32 v45, s80, v2
    buffer_load_dwordx4 v[160:163], v45, s[28:31], 0 offen nt
    s_xor_b32 s80, s101, 0x10100
    buffer_load_dwordx4 a[252:255], v43, s[36:39], s82 offen
    s_add_u32 s82, s82, 32768
    s_cmp_eq_u32 s82, 1310720
    s_cselect_b32 s82, 0, s82
    v_mfma_f32_16x16x32_bf16 v[12:15], v[16:19], a[232:235], v[12:15]
    v_and_b32_dpp v20, v24, v4 row_newbcast:11 row_mask:0xf bank_mask:0xf
    v_and_b32_dpp v21, v24, v5 row_newbcast:11 row_mask:0xf bank_mask:0xf
    v_and_b32_dpp v22, v24, v6 row_newbcast:11 row_mask:0xf bank_mask:0xf
    v_and_b32_dpp v23, v24, v7 row_newbcast:11 row_mask:0xf bank_mask:0xf
    s_waitcnt vmcnt(7)
    v_xor_b32 v45, s80, v2
    buffer_load_dwordx4 v[164:167], v45, s[28:31], 0 offen nt
    s_xor_b32 s80, s101, 0x800
    s_waitcnt vmcnt(7)
    v_xor_b32 v45, s80, v2
    buffer_load_dwordx4 v[168:171], v45, s[28:31], 0 offen nt
    s_xor_b32 s80, s101, 0x10900
    buffer_load_dwordx4 a[192:195], v43, s[36:39], s82 offen
    s_add_u32 s82, s82, 32768
    s_cmp_eq_u32 s82, 1310720
    s_cselect_b32 s82, 0, s82
    v_mfma_f32_16x16x32_bf16 v[12:15], v[20:23], a[236:239], v[12:15]
    v_and_b32_dpp v16, v24, v4 row_newbcast:12 row_mask:0xf bank_mask:0xf
    v_and_b32_dpp v17, v24, v5 row_newbcast:12 row_mask:0xf bank_mask:0xf
    v_and_b32_dpp v18, v24, v6 row_newbcast:12 row_mask:0xf bank_mask:0xf
    v_and_b32_dpp v19, v24, v7 row_newbcast:12 row_mask:0xf bank_mask:0xf
    s_waitcnt vmcnt(7)
    v_xor_b32 v45, s80, v2
    buffer_load_dwordx4 v[172:175], v45, s[28:31], 0 offen nt
    s_add_u32 s100, s100, 1
    v_readlane_b32 s101, v61, s100
    s_mov_b32 s80, s101
    s_waitcnt vmcnt(6)
    v_xor_b32 v45, s80, v2
    buffer_load_dwordx4 v[176:179], v45, s[28:31], 0 offen nt
    s_xor_b32 s80, s101, 0x10100
    buffer_load_dwordx4 a[196:199], v43, s[36:39], s82 offen
    s_add_u32 s82, s82, 32768
    s_cmp_eq_u32 s82, 1310720
    s_cselect_b32 s82, 0, s82
    v_mfma_f32_16x16x32_bf16 v[12:15], v[16:19], a[240:243], v[12:15]
    v_and_b32_dpp v20, v24, v4 row_newbcast:13 row_mask:0xf bank_mask:0xf
    v_and_b32_dpp v21, v24, v5 row_newbcast:13 row_mask:0xf bank_mask:0xf
    v_and_b32_dpp v22, v24, v6 row_newbcast:13 row_mask:0xf bank_mask:0xf
    v_and_b32_dpp v23, v24, v7 row_newbcast:13 row_mask:0xf bank_mask:0xf
    s_waitcnt vmcnt(7)
    v_xor_b32 v45, s80, v2
    buffer_load_dwordx4 v[180:183], v45, s[28:31], 0 offen nt
    s_xor_b32 s80, s101, 0x800
    buffer_load_dwordx4 a[200:203], v43, s[36:39], s82 offen
    s_add_u32 s82, s82, 32768
    s_cmp_eq_u32 s82, 1310720
    s_cselect_b32 s82, 0, s82
    v_mfma_f32_16x16x32_bf16 v[12:15], v[20:23], a[244:247], v[12:15]
    v_and_b32_dpp v16, v24, v4 row_newbcast:14 row_mask:0xf bank_mask:0xf
    v_and_b32_dpp v17, v24, v5 row_newbcast:14 row_mask:0xf bank_mask:0xf
    v_and_b32_dpp v18, v24, v6 row_newbcast:14 row_mask:0xf bank_mask:0xf
    v_and_b32_dpp v19, v24, v7 row_newbcast:14 row_mask:0xf bank_mask:0xf
    s_waitcnt vmcnt(7)
    v_xor_b32 v45, s80, v2
    buffer_load_dwordx4 v[184:187], v45, s[28:31], 0 offen nt
    s_xor_b32 s80, s101, 0x10900
    s_waitcnt vmcnt(7)
    v_xor_b32 v45, s80, v2
    buffer_load_dwordx4 v[188:191], v45, s[28:31], 0 offen nt
    s_add_u32 s100, s100, 1
    v_readlane_b32 s101, v61, s100
    s_mov_b32 s80, s101
    buffer_load_dwordx4 a[204:207], v43, s[36:39], s82 offen
    s_add_u32 s82, s82, 32768
    s_cmp_eq_u32 s82, 1310720
    s_cselect_b32 s82, 0, s82
    v_mfma_f32_16x16x32_bf16 v[12:15], v[16:19], a[248:251], v[12:15]
    v_and_b32_dpp v20, v24, v4 row_newbcast:15 row_mask:0xf bank_mask:0xf
    v_and_b32_dpp v21, v24, v5 row_newbcast:15 row_mask:0xf bank_mask:0xf
    v_and_b32_dpp v22, v24, v6 row_newbcast:15 row_mask:0xf bank_mask:0xf
    v_and_b32_dpp v23, v24, v7 row_newbcast:15 row_mask:0xf bank_mask:0xf
    s_waitcnt vmcnt(7)
    v_xor_b32 v45, s80, v2
    buffer_load_dwordx4 v[192:195], v45, s[28:31], 0 offen nt
    s_xor_b32 s80, s101, 0x10100
    s_waitcnt vmcnt(7)
    v_xor_b32 v45, s80, v2
    buffer_load_dwordx4 v[196:199], v45, s[28:31], 0 offen nt
    s_xor_b32 s80, s101, 0x800
    buffer_load_dwordx4 a[208:211], v43, s[36:39], s82 offen
    s_add_u32 s82, s82, 32768
    s_cmp_eq_u32 s82, 1310720
    s_cselect_b32 s82, 0, s82
    v_mfma_f32_16x16x32_bf16 v[12:15], v[20:23], a[252:255], v[12:15]
    v_and_b32_dpp v16, v25, v4 row_newbcast:0 row_mask:0xf bank_mask:0xf
    v_and_b32_dpp v17, v25, v5 row_newbcast:0 row_mask:0xf bank_mask:0xf
    v_and_b32_dpp v18, v25, v6 row_newbcast:0 row_mask:0xf bank_mask:0xf
    v_and_b32_dpp v19, v25, v7 row_newbcast:0 row_mask:0xf bank_mask:0xf
    s_waitcnt vmcnt(7)
    v_xor_b32 v45, s80, v2
    buffer_load_dwordx4 v[200:203], v45, s[28:31], 0 offen nt
    s_xor_b32 s80, s101, 0x10900
    s_waitcnt vmcnt(6)
    v_xor_b32 v45, s80, v2
    buffer_load_dwordx4 v[204:207], v45, s[28:31], 0 offen nt
    s_add_u32 s100, s100, 1
    v_readlane_b32 s101, v61, s100
    s_mov_b32 s80, s101
    buffer_load_dwordx4 a[212:215], v43, s[36:39], s82 offen
    s_add_u32 s82, s82, 32768
    s_cmp_eq_u32 s82, 1310720
    s_cselect_b32 s82, 0, s82
    v_mfma_f32_16x16x32_bf16 v[12:15], v[16:19], a[192:195], v[12:15]
    v_and_b32_dpp v20, v25, v4 row_newbcast:1 row_mask:0xf bank_mask:0xf
    v_and_b32_dpp v21, v25, v5 row_newbcast:1 row_mask:0xf bank_mask:0xf
    v_and_b32_dpp v22, v25, v6 row_newbcast:1 row_mask:0xf bank_mask:0xf
    v_and_b32_dpp v23, v25, v7 row_newbcast:1 row_mask:0xf bank_mask:0xf
    s_waitcnt vmcnt(7)
    v_xor_b32 v45, s80, v2
    buffer_load_dwordx4 v[208:211], v45, s[28:31], 0 offen nt
    s_xor_b32 s80, s101, 0x10100
    buffer_load_dwordx4 a[216:219], v43, s[36:39], s82 offen
    s_add_u32 s82, s82, 32768
    s_cmp_eq_u32 s82, 1310720
    s_cselect_b32 s82, 0, s82
    v_mfma_f32_16x16x32_bf16 v[12:15], v[20:23], a[196:199], v[12:15]
    v_and_b32_dpp v16, v25, v4 row_newbcast:2 row_mask:0xf bank_mask:0xf
    v_and_b32_dpp v17, v25, v5 row_newbcast:2 row_mask:0xf bank_mask:0xf
    v_and_b32_dpp v18, v25, v6 row_newbcast:2 row_mask:0xf bank_mask:0xf
    v_and_b32_dpp v19, v25, v7 row_newbcast:2 row_mask:0xf bank_mask:0xf
    s_waitcnt vmcnt(7)
    v_xor_b32 v45, s80, v2
    buffer_load_dwordx4 v[212:215], v45, s[28:31], 0 offen nt
    s_xor_b32 s80, s101, 0x800
    s_waitcnt vmcnt(7)
    v_xor_b32 v45, s80, v2
    buffer_load_dwordx4 v[216:219], v45, s[28:31], 0 offen nt
    s_xor_b32 s80, s101, 0x10900
    buffer_load_dwordx4 a[220:223], v43, s[36:39], s82 offen
    s_add_u32 s82, s82, 32768
    s_cmp_eq_u32 s82, 1310720
    s_cselect_b32 s82, 0, s82
    v_mfma_f32_16x16x32_bf16 v[12:15], v[16:19], a[200:203], v[12:15]
    v_and_b32_dpp v20, v25, v4 row_newbcast:3 row_mask:0xf bank_mask:0xf
    v_and_b32_dpp v21, v25, v5 row_newbcast:3 row_mask:0xf bank_mask:0xf
    v_and_b32_dpp v22, v25, v6 row_newbcast:3 row_mask:0xf bank_mask:0xf
    v_and_b32_dpp v23, v25, v7 row_newbcast:3 row_mask:0xf bank_mask:0xf
    s_waitcnt vmcnt(7)
    v_xor_b32 v45, s80, v2
    buffer_load_dwordx4 v[220:223], v45, s[28:31], 0 offen nt
    s_add_u32 s100, s100, 1
    v_readlane_b32 s101, v61, s100
    s_mov_b32 s80, s101
    s_waitcnt vmcnt(7)
    v_xor_b32 v45, s80, v2
    buffer_load_dwordx4 v[224:227], v45, s[28:31], 0 offen nt
    s_xor_b32 s80, s101, 0x10100
    buffer_load_dwordx4 a[224:227], v43, s[36:39], s82 offen
    s_add_u32 s82, s82, 32768
    s_cmp_eq_u32 s82, 1310720
    s_cselect_b32 s82, 0, s82
    v_mfma_f32_16x16x32_bf16 v[12:15], v[20:23], a[204:207], v[12:15]
    v_and_b32_dpp v16, v25, v4 row_newbcast:4 row_mask:0xf bank_mask:0xf
    v_and_b32_dpp v17, v25, v5 row_newbcast:4 row_mask:0xf bank_mask:0xf
    v_and_b32_dpp v18, v25, v6 row_newbcast:4 row_mask:0xf bank_mask:0xf
    v_and_b32_dpp v19, v25, v7 row_newbcast:4 row_mask:0xf bank_mask:0xf
    s_waitcnt vmcnt(7)
    v_xor_b32 v45, s80, v2
    buffer_load_dwordx4 v[228:231], v45, s[28:31], 0 offen nt
    s_xor_b32 s80, s101, 0x800
    s_waitcnt vmcnt(6)
    v_xor_b32 v45, s80, v2
    buffer_load_dwordx4 v[232:235], v45, s[28:31], 0 offen nt
    s_xor_b32 s80, s101, 0x10900
    buffer_load_dwordx4 a[228:231], v43, s[36:39], s82 offen
    s_add_u32 s82, s82, 32768
    s_cmp_eq_u32 s82, 1310720
    s_cselect_b32 s82, 0, s82
    v_mfma_f32_16x16x32_bf16 v[12:15], v[16:19], a[208:211], v[12:15]
    v_and_b32_dpp v20, v25, v4 row_newbcast:5 row_mask:0xf bank_mask:0xf
    v_and_b32_dpp v21, v25, v5 row_newbcast:5 row_mask:0xf bank_mask:0xf
    v_and_b32_dpp v22, v25, v6 row_newbcast:5 row_mask:0xf bank_mask:0xf
    v_and_b32_dpp v23, v25, v7 row_newbcast:5 row_mask:0xf bank_mask:0xf
    s_waitcnt vmcnt(7)
    v_xor_b32 v45, s80, v2
    buffer_load_dwordx4 v[236:239], v45, s[28:31], 0 offen nt
    s_add_u32 s100, s100, 1
    v_readlane_b32 s101, v61, s100
    s_mov_b32 s80, s101
    buffer_load_dwordx4 a[232:235], v43, s[36:39], s82 offen
    s_add_u32 s82, s82, 32768
    s_cmp_eq_u32 s82, 1310720
    s_cselect_b32 s82, 0, s82
    v_mfma_f32_16x16x32_bf16 v[12:15], v[20:23], a[212:215], v[12:15]
    v_and_b32_dpp v16, v25, v4 row_newbcast:6 row_mask:0xf bank_mask:0xf
    v_and_b32_dpp v17, v25, v5 row_newbcast:6 row_mask:0xf bank_mask:0xf
    v_and_b32_dpp v18, v25, v6 row_newbcast:6 row_mask:0xf bank_mask:0xf
    v_and_b32_dpp v19, v25, v7 row_newbcast:6 row_mask:0xf bank_mask:0xf
    s_waitcnt vmcnt(7)
    v_xor_b32 v45, s80, v2
    buffer_load_dwordx4 v[240:243], v45, s[28:31], 0 offen nt
    s_xor_b32 s80, s101, 0x10100
    s_waitcnt vmcnt(7)
    v_xor_b32 v45, s80, v2
    buffer_load_dwordx4 v[244:247], v45, s[28:31], 0 offen nt
    s_xor_b32 s80, s101, 0x800
    buffer_load_dwordx4 a[236:239], v43, s[36:39], s82 offen
    s_add_u32 s82, s82, 32768
    s_cmp_eq_u32 s82, 1310720
    s_cselect_b32 s82, 0, s82
    v_mfma_f32_16x16x32_bf16 v[12:15], v[16:19], a[216:219], v[12:15]
    v_and_b32_dpp v20, v25, v4 row_newbcast:7 row_mask:0xf bank_mask:0xf
    v_and_b32_dpp v21, v25, v5 row_newbcast:7 row_mask:0xf bank_mask:0xf
    v_and_b32_dpp v22, v25, v6 row_newbcast:7 row_mask:0xf bank_mask:0xf
    v_and_b32_dpp v23, v25, v7 row_newbcast:7 row_mask:0xf bank_mask:0xf
    s_waitcnt vmcnt(7)
    v_xor_b32 v45, s80, v2
    buffer_load_dwordx4 v[248:251], v45, s[28:31], 0 offen nt
    s_xor_b32 s80, s101, 0x10900
    s_waitcnt vmcnt(7)
    v_xor_b32 v45, s80, v2
    buffer_load_dwordx4 v[252:255], v45, s[28:31], 0 offen nt
    s_add_u32 s100, s100, 1
    v_readlane_b32 s101, v61, s100
    s_mov_b32 s80, s101
    buffer_load_dwordx4 a[240:243], v43, s[36:39], s82 offen
    s_add_u32 s82, s82, 32768
    s_cmp_eq_u32 s82, 1310720
    s_cselect_b32 s82, 0, s82
    v_mfma_f32_16x16x32_bf16 v[12:15], v[20:23], a[220:223], v[12:15]
    v_and_b32_dpp v16, v25, v4 row_newbcast:8 row_mask:0xf bank_mask:0xf
    v_and_b32_dpp v17, v25, v5 row_newbcast:8 row_mask:0xf bank_mask:0xf
    v_and_b32_dpp v18, v25, v6 row_newbcast:8 row_mask:0xf bank_mask:0xf
    v_and_b32_dpp v19, v25, v7 row_newbcast:8 row_mask:0xf bank_mask:0xf
    s_waitcnt vmcnt(7)
    v_xor_b32 v45, s80, v2
    buffer_load_dwordx4 a[0:3], v45, s[28:31], 0 offen nt
    s_xor_b32 s80, s101, 0x10100
    s_waitcnt vmcnt(6)
    v_xor_b32 v45, s80, v2
    buffer_load_dwordx4 a[4:7], v45, s[28:31], 0 offen nt
    s_xor_b32 s80, s101, 0x800
    buffer_load_dwordx4 a[244:247], v43, s[36:39], s82 offen
    s_add_u32 s82, s82, 32768
    s_cmp_eq_u32 s82, 1310720
    s_cselect_b32 s82, 0, s82
    v_mfma_f32_16x16x32_bf16 v[12:15], v[16:19], a[224:227], v[12:15]
    v_and_b32_dpp v20, v25, v4 row_newbcast:9 row_mask:0xf bank_mask:0xf
    v_and_b32_dpp v21, v25, v5 row_newbcast:9 row_mask:0xf bank_mask:0xf
    v_and_b32_dpp v22, v25, v6 row_newbcast:9 row_mask:0xf bank_mask:0xf
    v_and_b32_dpp v23, v25, v7 row_newbcast:9 row_mask:0xf bank_mask:0xf
    s_waitcnt vmcnt(7)
    v_xor_b32 v45, s80, v2
    buffer_load_dwordx4 a[8:11], v45, s[28:31], 0 offen nt
    s_xor_b32 s80, s101, 0x10900
    buffer_load_dwordx4 a[248:251], v43, s[36:39], s82 offen
    s_add_u32 s82, s82, 32768
    s_cmp_eq_u32 s82, 1310720
    s_cselect_b32 s82, 0, s82
    v_mfma_f32_16x16x32_bf16 v[12:15], v[20:23], a[228:231], v[12:15]
    v_and_b32_dpp v16, v25, v4 row_newbcast:10 row_mask:0xf bank_mask:0xf
    v_and_b32_dpp v17, v25, v5 row_newbcast:10 row_mask:0xf bank_mask:0xf
    v_and_b32_dpp v18, v25, v6 row_newbcast:10 row_mask:0xf bank_mask:0xf
    v_and_b32_dpp v19, v25, v7 row_newbcast:10 row_mask:0xf bank_mask:0xf
    s_waitcnt vmcnt(7)
    v_xor_b32 v45, s80, v2
    buffer_load_dwordx4 a[12:15], v45, s[28:31], 0 offen nt
    s_add_u32 s100, s100, 1
    v_readlane_b32 s101, v61, s100
    s_mov_b32 s80, s101
    s_waitcnt vmcnt(7)
    v_xor_b32 v45, s80, v2
    buffer_load_dwordx4 a[16:19], v45, s[28:31], 0 offen nt
    s_xor_b32 s80, s101, 0x10100
    buffer_load_dwordx4 a[252:255], v43, s[36:39], s82 offen
    s_add_u32 s82, s82, 32768
    s_cmp_eq_u32 s82, 1310720
    s_cselect_b32 s82, 0, s82
    v_mfma_f32_16x16x32_bf16 v[12:15], v[16:19], a[232:235], v[12:15]
    v_and_b32_dpp v20, v25, v4 row_newbcast:11 row_mask:0xf bank_mask:0xf
    v_and_b32_dpp v21, v25, v5 row_newbcast:11 row_mask:0xf bank_mask:0xf
    v_and_b32_dpp v22, v25, v6 row_newbcast:11 row_mask:0xf bank_mask:0xf
    v_and_b32_dpp v23, v25, v7 row_newbcast:11 row_mask:0xf bank_mask:0xf
    s_waitcnt vmcnt(7)
    v_xor_b32 v45, s80, v2
    buffer_load_dwordx4 a[20:23], v45, s[28:31], 0 offen nt
    s_xor_b32 s80, s101, 0x800
    s_waitcnt vmcnt(7)
    v_xor_b32 v45, s80, v2
    buffer_load_dwordx4 a[24:27], v45, s[28:31], 0 offen nt
    s_xor_b32 s80, s101, 0x10900
    buffer_load_dwordx4 a[192:195], v43, s[36:39], s82 offen
    s_add_u32 s82, s82, 32768
    s_cmp_eq_u32 s82, 1310720
    s_cselect_b32 s82, 0, s82
    v_mfma_f32_16x16x32_bf16 v[12:15], v[20:23], a[236:239], v[12:15]
    v_and_b32_dpp v16, v25, v4 row_newbcast:12 row_mask:0xf bank_mask:0xf
    v_and_b32_dpp v17, v25, v5 row_newbcast:12 row_mask:0xf bank_mask:0xf
    v_and_b32_dpp v18, v25, v6 row_newbcast:12 row_mask:0xf bank_mask:0xf
    v_and_b32_dpp v19, v25, v7 row_newbcast:12 row_mask:0xf bank_mask:0xf
    s_waitcnt vmcnt(7)
    v_xor_b32 v45, s80, v2
    buffer_load_dwordx4 a[28:31], v45, s[28:31], 0 offen nt
    s_add_u32 s100, s100, 1
    v_readlane_b32 s101, v61, s100
    s_mov_b32 s80, s101
    s_waitcnt vmcnt(6)
    v_xor_b32 v45, s80, v2
    buffer_load_dwordx4 a[32:35], v45, s[28:31], 0 offen nt
    s_xor_b32 s80, s101, 0x10100
    buffer_load_dwordx4 a[196:199], v43, s[36:39], s82 offen
    s_add_u32 s82, s82, 32768
    s_cmp_eq_u32 s82, 1310720
    s_cselect_b32 s82, 0, s82
    v_mfma_f32_16x16x32_bf16 v[12:15], v[16:19], a[240:243], v[12:15]
    v_and_b32_dpp v20, v25, v4 row_newbcast:13 row_mask:0xf bank_mask:0xf
    v_and_b32_dpp v21, v25, v5 row_newbcast:13 row_mask:0xf bank_mask:0xf
    v_and_b32_dpp v22, v25, v6 row_newbcast:13 row_mask:0xf bank_mask:0xf
    v_and_b32_dpp v23, v25, v7 row_newbcast:13 row_mask:0xf bank_mask:0xf
    s_waitcnt vmcnt(7)
    v_xor_b32 v45, s80, v2
    buffer_load_dwordx4 a[36:39], v45, s[28:31], 0 offen nt
    s_xor_b32 s80, s101, 0x800
    buffer_load_dwordx4 a[200:203], v43, s[36:39], s82 offen
    s_add_u32 s82, s82, 32768
    s_cmp_eq_u32 s82, 1310720
    s_cselect_b32 s82, 0, s82
    v_mfma_f32_16x16x32_bf16 v[12:15], v[20:23], a[244:247], v[12:15]
    v_and_b32_dpp v16, v25, v4 row_newbcast:14 row_mask:0xf bank_mask:0xf
    v_and_b32_dpp v17, v25, v5 row_newbcast:14 row_mask:0xf bank_mask:0xf
    v_and_b32_dpp v18, v25, v6 row_newbcast:14 row_mask:0xf bank_mask:0xf
    v_and_b32_dpp v19, v25, v7 row_newbcast:14 row_mask:0xf bank_mask:0xf
    s_waitcnt vmcnt(7)
    v_xor_b32 v45, s80, v2
    buffer_load_dwordx4 a[40:43], v45, s[28:31], 0 offen nt
    s_xor_b32 s80, s101, 0x10900
    s_waitcnt vmcnt(7)
    v_xor_b32 v45, s80, v2
    buffer_load_dwordx4 a[44:47], v45, s[28:31], 0 offen nt
    s_add_u32 s100, s100, 1
    v_readlane_b32 s101, v61, s100
    s_mov_b32 s80, s101
    buffer_load_dwordx4 a[204:207], v43, s[36:39], s82 offen
    s_add_u32 s82, s82, 32768
    s_cmp_eq_u32 s82, 1310720
    s_cselect_b32 s82, 0, s82
    v_mfma_f32_16x16x32_bf16 v[12:15], v[16:19], a[248:251], v[12:15]
    v_and_b32_dpp v20, v25, v4 row_newbcast:15 row_mask:0xf bank_mask:0xf
    v_and_b32_dpp v21, v25, v5 row_newbcast:15 row_mask:0xf bank_mask:0xf
    v_and_b32_dpp v22, v25, v6 row_newbcast:15 row_mask:0xf bank_mask:0xf
    v_and_b32_dpp v23, v25, v7 row_newbcast:15 row_mask:0xf bank_mask:0xf
    s_waitcnt vmcnt(7)
    v_xor_b32 v45, s80, v2
    buffer_load_dwordx4 a[48:51], v45, s[28:31], 0 offen nt
    s_xor_b32 s80, s101, 0x10100
    s_waitcnt vmcnt(7)
    v_xor_b32 v45, s80, v2
    buffer_load_dwordx4 a[52:55], v45, s[28:31], 0 offen nt
    s_xor_b32 s80, s101, 0x800
    buffer_load_dwordx4 a[208:211], v43, s[36:39], s82 offen
    s_add_u32 s82, s82, 32768
    s_cmp_eq_u32 s82, 1310720
    s_cselect_b32 s82, 0, s82
    v_mfma_f32_16x16x32_bf16 v[12:15], v[20:23], a[252:255], v[12:15]
    v_and_b32_dpp v16, v26, v4 row_newbcast:0 row_mask:0xf bank_mask:0xf
    v_and_b32_dpp v17, v26, v5 row_newbcast:0 row_mask:0xf bank_mask:0xf
    v_and_b32_dpp v18, v26, v6 row_newbcast:0 row_mask:0xf bank_mask:0xf
    v_and_b32_dpp v19, v26, v7 row_newbcast:0 row_mask:0xf bank_mask:0xf
    s_waitcnt vmcnt(7)
    v_xor_b32 v45, s80, v2
    buffer_load_dwordx4 a[56:59], v45, s[28:31], 0 offen nt
    s_xor_b32 s80, s101, 0x10900
    s_waitcnt vmcnt(6)
    v_xor_b32 v45, s80, v2
    buffer_load_dwordx4 a[60:63], v45, s[28:31], 0 offen nt
    s_add_u32 s100, s100, 1
    v_readlane_b32 s101, v61, s100
    s_mov_b32 s80, s101
    buffer_load_dwordx4 a[212:215], v43, s[36:39], s82 offen
    s_add_u32 s82, s82, 32768
    s_cmp_eq_u32 s82, 1310720
    s_cselect_b32 s82, 0, s82
    v_mfma_f32_16x16x32_bf16 v[12:15], v[16:19], a[192:195], v[12:15]
    v_and_b32_dpp v20, v26, v4 row_newbcast:1 row_mask:0xf bank_mask:0xf
    v_and_b32_dpp v21, v26, v5 row_newbcast:1 row_mask:0xf bank_mask:0xf
    v_and_b32_dpp v22, v26, v6 row_newbcast:1 row_mask:0xf bank_mask:0xf
    v_and_b32_dpp v23, v26, v7 row_newbcast:1 row_mask:0xf bank_mask:0xf
    s_waitcnt vmcnt(7)
    v_xor_b32 v45, s80, v2
    buffer_load_dwordx4 a[64:67], v45, s[28:31], 0 offen nt
    s_xor_b32 s80, s101, 0x10100
    buffer_load_dwordx4 a[216:219], v43, s[36:39], s82 offen
    s_add_u32 s82, s82, 32768
    s_cmp_eq_u32 s82, 1310720
    s_cselect_b32 s82, 0, s82
    v_mfma_f32_16x16x32_bf16 v[12:15], v[20:23], a[196:199], v[12:15]
    v_and_b32_dpp v16, v26, v4 row_newbcast:2 row_mask:0xf bank_mask:0xf
    v_and_b32_dpp v17, v26, v5 row_newbcast:2 row_mask:0xf bank_mask:0xf
    v_and_b32_dpp v18, v26, v6 row_newbcast:2 row_mask:0xf bank_mask:0xf
    v_and_b32_dpp v19, v26, v7 row_newbcast:2 row_mask:0xf bank_mask:0xf
    s_waitcnt vmcnt(7)
    v_xor_b32 v45, s80, v2
    buffer_load_dwordx4 a[68:71], v45, s[28:31], 0 offen nt
    s_xor_b32 s80, s101, 0x800
    s_waitcnt vmcnt(7)
    v_xor_b32 v45, s80, v2
    buffer_load_dwordx4 a[72:75], v45, s[28:31], 0 offen nt
    s_xor_b32 s80, s101, 0x10900
    buffer_load_dwordx4 a[220:223], v43, s[36:39], s82 offen
    v_mfma_f32_16x16x32_bf16 v[12:15], v[16:19], a[200:203], v[12:15]
    v_and_b32_dpp v20, v26, v4 row_newbcast:3 row_mask:0xf bank_mask:0xf
    v_and_b32_dpp v21, v26, v5 row_newbcast:3 row_mask:0xf bank_mask:0xf
    v_and_b32_dpp v22, v26, v6 row_newbcast:3 row_mask:0xf bank_mask:0xf
    v_and_b32_dpp v23, v26, v7 row_newbcast:3 row_mask:0xf bank_mask:0xf
    s_waitcnt vmcnt(7)
    v_xor_b32 v45, s80, v2
    buffer_load_dwordx4 a[76:79], v45, s[28:31], 0 offen nt
    s_add_u32 s100, s100, 1
    v_readlane_b32 s101, v61, s100
    s_mov_b32 s80, s101
    s_waitcnt vmcnt(7)
    v_xor_b32 v45, s80, v2
    buffer_load_dwordx4 a[80:83], v45, s[28:31], 0 offen nt
    s_xor_b32 s80, s101, 0x10100
    v_mfma_f32_16x16x32_bf16 v[12:15], v[20:23], a[204:207], v[12:15]
    v_and_b32_dpp v16, v26, v4 row_newbcast:4 row_mask:0xf bank_mask:0xf
    v_and_b32_dpp v17, v26, v5 row_newbcast:4 row_mask:0xf bank_mask:0xf
    v_and_b32_dpp v18, v26, v6 row_newbcast:4 row_mask:0xf bank_mask:0xf
    v_and_b32_dpp v19, v26, v7 row_newbcast:4 row_mask:0xf bank_mask:0xf
    s_waitcnt vmcnt(6)
    v_xor_b32 v45, s80, v2
    buffer_load_dwordx4 a[84:87], v45, s[28:31], 0 offen nt
    s_xor_b32 s80, s101, 0x800
    s_waitcnt vmcnt(5)
    v_xor_b32 v45, s80, v2
    buffer_load_dwordx4 a[88:91], v45, s[28:31], 0 offen nt
    s_xor_b32 s80, s101, 0x10900
    v_mfma_f32_16x16x32_bf16 v[12:15], v[16:19], a[208:211], v[12:15]
    v_and_b32_dpp v20, v26, v4 row_newbcast:5 row_mask:0xf bank_mask:0xf
    v_and_b32_dpp v21, v26, v5 row_newbcast:5 row_mask:0xf bank_mask:0xf
    v_and_b32_dpp v22, v26, v6 row_newbcast:5 row_mask:0xf bank_mask:0xf
    v_and_b32_dpp v23, v26, v7 row_newbcast:5 row_mask:0xf bank_mask:0xf
    s_waitcnt vmcnt(5)
    v_xor_b32 v45, s80, v2
    buffer_load_dwordx4 a[92:95], v45, s[28:31], 0 offen nt
    s_add_u32 s100, s100, 1
    v_readlane_b32 s101, v61, s100
    s_mov_b32 s80, s101
    v_mfma_f32_16x16x32_bf16 v[12:15], v[20:23], a[212:215], v[12:15]
    v_and_b32_dpp v16, v26, v4 row_newbcast:6 row_mask:0xf bank_mask:0xf
    v_and_b32_dpp v17, v26, v5 row_newbcast:6 row_mask:0xf bank_mask:0xf
    v_and_b32_dpp v18, v26, v6 row_newbcast:6 row_mask:0xf bank_mask:0xf
    v_and_b32_dpp v19, v26, v7 row_newbcast:6 row_mask:0xf bank_mask:0xf
    s_waitcnt vmcnt(4)
    v_xor_b32 v45, s80, v2
    buffer_load_dwordx4 a[96:99], v45, s[28:31], 0 offen nt
    s_xor_b32 s80, s101, 0x10100
    s_waitcnt vmcnt(4)
    v_xor_b32 v45, s80, v2
    buffer_load_dwordx4 a[100:103], v45, s[28:31], 0 offen nt
    s_xor_b32 s80, s101, 0x800
    v_mfma_f32_16x16x32_bf16 v[12:15], v[16:19], a[216:219], v[12:15]
    v_and_b32_dpp v20, v26, v4 row_newbcast:7 row_mask:0xf bank_mask:0xf
    v_and_b32_dpp v21, v26, v5 row_newbcast:7 row_mask:0xf bank_mask:0xf
    v_and_b32_dpp v22, v26, v6 row_newbcast:7 row_mask:0xf bank_mask:0xf
    v_and_b32_dpp v23, v26, v7 row_newbcast:7 row_mask:0xf bank_mask:0xf
    s_waitcnt vmcnt(4)
    v_xor_b32 v45, s80, v2
    buffer_load_dwordx4 a[104:107], v45, s[28:31], 0 offen nt
    s_xor_b32 s80, s101, 0x10900
    s_waitcnt vmcnt(4)
    v_xor_b32 v45, s80, v2
    buffer_load_dwordx4 a[108:111], v45, s[28:31], 0 offen nt
    s_add_u32 s100, s100, 1
    v_readlane_b32 s101, v61, s100
    s_mov_b32 s80, s101
    v_mfma_f32_16x16x32_bf16 v[12:15], v[20:23], a[220:223], v[12:15]
    s_waitcnt vmcnt(4)
    v_xor_b32 v45, s80, v2
    buffer_load_dwordx4 a[112:115], v45, s[28:31], 0 offen nt
    s_xor_b32 s80, s101, 0x10100
    s_waitcnt vmcnt(4)
    v_xor_b32 v45, s80, v2
    buffer_load_dwordx4 a[116:119], v45, s[28:31], 0 offen nt
    s_xor_b32 s80, s101, 0x800
    v_lshlrev_b32 v57, 5, v47
    v_and_b32 v59, 1, v46
    v_lshl_add_u32 v58, v59, 4, v57
    v_lshrrev_b32 v59, 1, v46
    v_lshl_add_u32 v58, v59, 9, v58
    s_lshl_b32 s14, s3, 10
    v_add_u32 v58, s14, v58
    ds_write_b128 v58, v[12:15] offset:0
    v_xor_b32 v45, s80, v2
    buffer_load_dwordx4 a[120:123], v45, s[28:31], 0 offen nt
    s_xor_b32 s80, s101, 0x10900
    s_waitcnt lgkmcnt(0)
    s_barrier
    ds_read_b128 v[24:27], v57 offset:0
    ds_read_b128 v[28:31], v57 offset:16
    ds_read_b128 v[32:35], v57 offset:1024
    ds_read_b128 v[36:39], v57 offset:1040
    ds_read_b128 v[48:51], v57 offset:2048
    ds_read_b128 v[52:55], v57 offset:2064
    ds_read_b128 v[12:15], v57 offset:3072
    ds_read_b128 v[16:19], v57 offset:3088
    s_waitcnt vmcnt(5)
    v_xor_b32 v45, s80, v2
    buffer_load_dwordx4 a[124:127], v45, s[28:31], 0 offen nt
    s_add_u32 s100, s100, 1
    v_readlane_b32 s101, v61, s100
    s_mov_b32 s80, s101
    s_waitcnt lgkmcnt(0)
    v_pk_add_f32 v[24:25], v[24:25], v[32:33]
    v_pk_add_f32 v[48:49], v[48:49], v[12:13]
    v_pk_add_f32 v[26:27], v[26:27], v[34:35]
    v_pk_add_f32 v[50:51], v[50:51], v[14:15]
    v_pk_add_f32 v[28:29], v[28:29], v[36:37]
    v_pk_add_f32 v[52:53], v[52:53], v[16:17]
    v_pk_add_f32 v[30:31], v[30:31], v[38:39]
    v_pk_add_f32 v[54:55], v[54:55], v[18:19]
    v_pk_add_f32 v[24:25], v[24:25], v[48:49]
    v_pk_add_f32 v[26:27], v[26:27], v[50:51]
    v_pk_add_f32 v[28:29], v[28:29], v[52:53]
    v_pk_add_f32 v[30:31], v[30:31], v[54:55]
    v_cvt_pk_bf16_f32 v8, v24, v25
    v_cvt_pk_bf16_f32 v9, v26, v27
    v_cvt_pk_bf16_f32 v10, v28, v29
    v_cvt_pk_bf16_f32 v11, v30, v31
    v_dot2_f32_bf16 v24, v64, v8, 0
    v_dot2_f32_bf16 v24, v65, v9, v24
    v_dot2_f32_bf16 v24, v66, v10, v24
    v_dot2_f32_bf16 v24, v67, v11, v24
    v_dot2_f32_bf16 v25, v68, v8, 0
    v_dot2_f32_bf16 v25, v69, v9, v25
    v_dot2_f32_bf16 v25, v70, v10, v25
    v_dot2_f32_bf16 v25, v71, v11, v25
    v_dot2_f32_bf16 v26, v72, v8, 0
    v_dot2_f32_bf16 v26, v73, v9, v26
    v_dot2_f32_bf16 v26, v74, v10, v26
    v_dot2_f32_bf16 v26, v75, v11, v26
    v_add_f32_dpp v24, v24, v24 row_ror:8 row_mask:0xf bank_mask:0x3
    s_nop 1
    v_add_f32_dpp v24, v25, v25 row_ror:8 row_mask:0xf bank_mask:0xc
    v_dot2_f32_bf16 v27, v76, v8, 0
    v_dot2_f32_bf16 v27, v77, v9, v27
    v_dot2_f32_bf16 v27, v78, v10, v27
    v_dot2_f32_bf16 v27, v79, v11, v27
    v_dot2_f32_bf16 v28, v80, v8, 0
    v_dot2_f32_bf16 v28, v81, v9, v28
    v_dot2_f32_bf16 v28, v82, v10, v28
    v_dot2_f32_bf16 v28, v83, v11, v28
    s_waitcnt vmcnt(5)
    v_xor_b32 v45, s80, v2
    buffer_load_dwordx4 a[128:131], v45, s[28:31], 0 offen nt
    s_xor_b32 s80, s101, 0x10100
    v_add_f32_dpp v26, v26, v26 row_ror:8 row_mask:0xf bank_mask:0x3
    s_nop 1
    v_add_f32_dpp v26, v27, v27 row_ror:8 row_mask:0xf bank_mask:0xc
    v_dot2_f32_bf16 v29, v84, v8, 0
    v_dot2_f32_bf16 v29, v85, v9, v29
    v_dot2_f32_bf16 v29, v86, v10, v29
    v_dot2_f32_bf16 v29, v87, v11, v29
    v_add_f32_dpp v24, v24, v24 row_shl:4 row_mask:0xf bank_mask:0x5
    s_nop 1
    v_add_f32_dpp v24, v26, v26 row_shr:4 row_mask:0xf bank_mask:0xa
    v_dot2_f32_bf16 v30, v88, v8, 0
    v_dot2_f32_bf16 v30, v89, v9, v30
    v_dot2_f32_bf16 v30, v90, v10, v30
    v_dot2_f32_bf16 v30, v91, v11, v30
    v_add_f32_dpp v28, v28, v28 row_ror:8 row_mask:0xf bank_mask:0x3
    s_nop 1
    v_add_f32_dpp v28, v29, v29 row_ror:8 row_mask:0xf bank_mask:0xc
    v_dot2_f32_bf16 v31, v92, v8, 0
    v_dot2_f32_bf16 v31, v93, v9, v31
    v_dot2_f32_bf16 v31, v94, v10, v31
    v_dot2_f32_bf16 v31, v95, v11, v31
    v_dot2_f32_bf16 v32, v96, v8, 0
    v_dot2_f32_bf16 v32, v97, v9, v32
    v_dot2_f32_bf16 v32, v98, v10, v32
    v_dot2_f32_bf16 v32, v99, v11, v32
    s_waitcnt vmcnt(5)
    v_xor_b32 v45, s80, v2
    buffer_load_dwordx4 a[132:135], v45, s[28:31], 0 offen nt
    s_xor_b32 s80, s101, 0x800
    v_add_f32_dpp v30, v30, v30 row_ror:8 row_mask:0xf bank_mask:0x3
    s_nop 1
    v_add_f32_dpp v30, v31, v31 row_ror:8 row_mask:0xf bank_mask:0xc
    v_dot2_f32_bf16 v33, v100, v8, 0
    v_dot2_f32_bf16 v33, v101, v9, v33
    v_dot2_f32_bf16 v33, v102, v10, v33
    v_dot2_f32_bf16 v33, v103, v11, v33
    v_add_f32_dpp v28, v28, v28 row_shl:4 row_mask:0xf bank_mask:0x5
    s_nop 1
    v_add_f32_dpp v28, v30, v30 row_shr:4 row_mask:0xf bank_mask:0xa
    v_dot2_f32_bf16 v34, v104, v8, 0
    v_dot2_f32_bf16 v34, v105, v9, v34
    v_dot2_f32_bf16 v34, v106, v10, v34
    v_dot2_f32_bf16 v34, v107, v11, v34
    v_add_f32_dpp v32, v32, v32 row_ror:8 row_mask:0xf bank_mask:0x3
    s_nop 1
    v_add_f32_dpp v32, v33, v33 row_ror:8 row_mask:0xf bank_mask:0xc
    v_cndmask_b32 v42, v24, v28, s[10:11]
    v_cndmask_b32 v43, v28, v24, s[10:11]
    s_nop 1
    v_add_f32_dpp v40, v43, v42 quad_perm:[2,3,0,1] row_mask:0xf bank_mask:0xf
    v_dot2_f32_bf16 v35, v108, v8, 0
    v_dot2_f32_bf16 v35, v109, v9, v35
    v_dot2_f32_bf16 v35, v110, v10, v35
    v_dot2_f32_bf16 v35, v111, v11, v35
    v_dot2_f32_bf16 v36, v112, v8, 0
    v_dot2_f32_bf16 v36, v113, v9, v36
    v_dot2_f32_bf16 v36, v114, v10, v36
    v_dot2_f32_bf16 v36, v115, v11, v36
    s_waitcnt vmcnt(5)
    v_xor_b32 v45, s80, v2
    buffer_load_dwordx4 a[136:139], v45, s[28:31], 0 offen nt
    s_xor_b32 s80, s101, 0x10900
    v_add_f32_dpp v34, v34, v34 row_ror:8 row_mask:0xf bank_mask:0x3
    s_nop 1
    v_add_f32_dpp v34, v35, v35 row_ror:8 row_mask:0xf bank_mask:0xc
    v_dot2_f32_bf16 v37, v116, v8, 0
    v_dot2_f32_bf16 v37, v117, v9, v37
    v_dot2_f32_bf16 v37, v118, v10, v37
    v_dot2_f32_bf16 v37, v119, v11, v37
    v_add_f32_dpp v32, v32, v32 row_shl:4 row_mask:0xf bank_mask:0x5
    s_nop 1
    v_add_f32_dpp v32, v34, v34 row_shr:4 row_mask:0xf bank_mask:0xa
    v_dot2_f32_bf16 v38, v120, v8, 0
    v_dot2_f32_bf16 v38, v121, v9, v38
    v_dot2_f32_bf16 v38, v122, v10, v38
    v_dot2_f32_bf16 v38, v123, v11, v38
    v_add_f32_dpp v36, v36, v36 row_ror:8 row_mask:0xf bank_mask:0x3
    s_nop 1
    v_add_f32_dpp v36, v37, v37 row_ror:8 row_mask:0xf bank_mask:0xc
    v_dot2_f32_bf16 v39, v124, v8, 0
    v_dot2_f32_bf16 v39, v125, v9, v39
    v_dot2_f32_bf16 v39, v126, v10, v39
    v_dot2_f32_bf16 v39, v127, v11, v39
    v_dot2_f32_bf16 v24, v128, v8, 0
    v_dot2_f32_bf16 v24, v129, v9, v24
    v_dot2_f32_bf16 v24, v130, v10, v24
    v_dot2_f32_bf16 v24, v131, v11, v24
    s_waitcnt vmcnt(5)
    v_xor_b32 v45, s80, v2
    buffer_load_dwordx4 a[140:143], v45, s[28:31], 0 offen nt
    s_add_u32 s100, s100, 1
    v_readlane_b32 s101, v61, s100
    s_mov_b32 s80, s101
    v_add_f32_dpp v38, v38, v38 row_ror:8 row_mask:0xf bank_mask:0x3
    s_nop 1
    v_add_f32_dpp v38, v39, v39 row_ror:8 row_mask:0xf bank_mask:0xc
    v_dot2_f32_bf16 v25, v132, v8, 0
    v_dot2_f32_bf16 v25, v133, v9, v25
    v_dot2_f32_bf16 v25, v134, v10, v25
    v_dot2_f32_bf16 v25, v135, v11, v25
    v_add_f32_dpp v36, v36, v36 row_shl:4 row_mask:0xf bank_mask:0x5
    s_nop 1
    v_add_f32_dpp v36, v38, v38 row_shr:4 row_mask:0xf bank_mask:0xa
    v_dot2_f32_bf16 v26, v136, v8, 0
    v_dot2_f32_bf16 v26, v137, v9, v26
    v_dot2_f32_bf16 v26, v138, v10, v26
    v_dot2_f32_bf16 v26, v139, v11, v26
    v_add_f32_dpp v24, v24, v24 row_ror:8 row_mask:0xf bank_mask:0x3
    s_nop 1
    v_add_f32_dpp v24, v25, v25 row_ror:8 row_mask:0xf bank_mask:0xc
    v_cndmask_b32 v42, v32, v36, s[10:11]
    v_cndmask_b32 v43, v36, v32, s[10:11]
    s_nop 1
    v_add_f32_dpp v41, v43, v42 quad_perm:[2,3,0,1] row_mask:0xf bank_mask:0xf
    v_dot2_f32_bf16 v27, v140, v8, 0
    v_dot2_f32_bf16 v27, v141, v9, v27
    v_dot2_f32_bf16 v27, v142, v10, v27
    v_dot2_f32_bf16 v27, v143, v11, v27
    v_cndmask_b32 v42, v40, v41, s[12:13]
    v_cndmask_b32 v43, v41, v40, s[12:13]
    s_nop 1
    v_add_f32_dpp v42, v43, v42 quad_perm:[1,0,3,2] row_mask:0xf bank_mask:0xf
    v_dot2_f32_bf16 v28, v144, v8, 0
    v_dot2_f32_bf16 v28, v145, v9, v28
    v_dot2_f32_bf16 v28, v146, v10, v28
    v_dot2_f32_bf16 v28, v147, v11, v28
    s_waitcnt vmcnt(5)
    v_xor_b32 v45, s80, v2
    buffer_load_dwordx4 a[144:147], v45, s[28:31], 0 offen nt
    s_xor_b32 s80, s101, 0x10100
    v_add_f32_dpp v26, v26, v26 row_ror:8 row_mask:0xf bank_mask:0x3
    s_nop 1
    v_add_f32_dpp v26, v27, v27 row_ror:8 row_mask:0xf bank_mask:0xc
    v_cvt_pk_bf16_f32 v43, v42, v42
    v_lshlrev_b32 v42, 16, v43
    v_mul_f32 v42, s16, v42
    v_cvt_pk_bf16_f32 v43, v42, v42
    v_lshlrev_b32 v42, 16, v43
    ds_write_b32 v44, v42
    v_add_u32 v44, 256, v44
    v_dot2_f32_bf16 v29, v148, v8, 0
    v_dot2_f32_bf16 v29, v149, v9, v29
    v_dot2_f32_bf16 v29, v150, v10, v29
    v_dot2_f32_bf16 v29, v151, v11, v29
    v_add_f32_dpp v24, v24, v24 row_shl:4 row_mask:0xf bank_mask:0x5
    s_nop 1
    v_add_f32_dpp v24, v26, v26 row_shr:4 row_mask:0xf bank_mask:0xa
    v_dot2_f32_bf16 v30, v152, v8, 0
    v_dot2_f32_bf16 v30, v153, v9, v30
    v_dot2_f32_bf16 v30, v154, v10, v30
    v_dot2_f32_bf16 v30, v155, v11, v30
    v_add_f32_dpp v28, v28, v28 row_ror:8 row_mask:0xf bank_mask:0x3
    s_nop 1
    v_add_f32_dpp v28, v29, v29 row_ror:8 row_mask:0xf bank_mask:0xc
    v_dot2_f32_bf16 v31, v156, v8, 0
    v_dot2_f32_bf16 v31, v157, v9, v31
    v_dot2_f32_bf16 v31, v158, v10, v31
    v_dot2_f32_bf16 v31, v159, v11, v31
    v_dot2_f32_bf16 v32, v160, v8, 0
    v_dot2_f32_bf16 v32, v161, v9, v32
    v_dot2_f32_bf16 v32, v162, v10, v32
    v_dot2_f32_bf16 v32, v163, v11, v32
    v_add_f32_dpp v30, v30, v30 row_ror:8 row_mask:0xf bank_mask:0x3
    s_nop 1
    v_add_f32_dpp v30, v31, v31 row_ror:8 row_mask:0xf bank_mask:0xc
    v_dot2_f32_bf16 v33, v164, v8, 0
    v_dot2_f32_bf16 v33, v165, v9, v33
    v_dot2_f32_bf16 v33, v166, v10, v33
    v_dot2_f32_bf16 v33, v167, v11, v33
    s_waitcnt vmcnt(5)
    v_xor_b32 v45, s80, v2
    buffer_load_dwordx4 a[148:151], v45, s[28:31], 0 offen nt
    s_xor_b32 s80, s101, 0x800
    v_add_f32_dpp v28, v28, v28 row_shl:4 row_mask:0xf bank_mask:0x5
    s_nop 1
    v_add_f32_dpp v28, v30, v30 row_shr:4 row_mask:0xf bank_mask:0xa
    v_dot2_f32_bf16 v34, v168, v8, 0
    v_dot2_f32_bf16 v34, v169, v9, v34
    v_dot2_f32_bf16 v34, v170, v10, v34
    v_dot2_f32_bf16 v34, v171, v11, v34
    v_add_f32_dpp v32, v32, v32 row_ror:8 row_mask:0xf bank_mask:0x3
    s_nop 1
    v_add_f32_dpp v32, v33, v33 row_ror:8 row_mask:0xf bank_mask:0xc
    v_cndmask_b32 v42, v24, v28, s[10:11]
    v_cndmask_b32 v43, v28, v24, s[10:11]
    s_nop 1
    v_add_f32_dpp v40, v43, v42 quad_perm:[2,3,0,1] row_mask:0xf bank_mask:0xf
    v_dot2_f32_bf16 v35, v172, v8, 0
    v_dot2_f32_bf16 v35, v173, v9, v35
    v_dot2_f32_bf16 v35, v174, v10, v35
    v_dot2_f32_bf16 v35, v175, v11, v35
    v_dot2_f32_bf16 v36, v176, v8, 0
    v_dot2_f32_bf16 v36, v177, v9, v36
    v_dot2_f32_bf16 v36, v178, v10, v36
    v_dot2_f32_bf16 v36, v179, v11, v36
    v_add_f32_dpp v34, v34, v34 row_ror:8 row_mask:0xf bank_mask:0x3
    s_nop 1
    v_add_f32_dpp v34, v35, v35 row_ror:8 row_mask:0xf bank_mask:0xc
    v_dot2_f32_bf16 v37, v180, v8, 0
    v_dot2_f32_bf16 v37, v181, v9, v37
    v_dot2_f32_bf16 v37, v182, v10, v37
    v_dot2_f32_bf16 v37, v183, v11, v37
    s_waitcnt vmcnt(5)
    v_xor_b32 v45, s80, v2
    buffer_load_dwordx4 a[152:155], v45, s[28:31], 0 offen nt
    s_xor_b32 s80, s101, 0x10900
    v_add_f32_dpp v32, v32, v32 row_shl:4 row_mask:0xf bank_mask:0x5
    s_nop 1
    v_add_f32_dpp v32, v34, v34 row_shr:4 row_mask:0xf bank_mask:0xa
    v_dot2_f32_bf16 v38, v184, v8, 0
    v_dot2_f32_bf16 v38, v185, v9, v38
    v_dot2_f32_bf16 v38, v186, v10, v38
    v_dot2_f32_bf16 v38, v187, v11, v38
    v_add_f32_dpp v36, v36, v36 row_ror:8 row_mask:0xf bank_mask:0x3
    s_nop 1
    v_add_f32_dpp v36, v37, v37 row_ror:8 row_mask:0xf bank_mask:0xc
    v_dot2_f32_bf16 v39, v188, v8, 0
    v_dot2_f32_bf16 v39, v189, v9, v39
    v_dot2_f32_bf16 v39, v190, v10, v39
    v_dot2_f32_bf16 v39, v191, v11, v39
    v_dot2_f32_bf16 v24, v192, v8, 0
    v_dot2_f32_bf16 v24, v193, v9, v24
    v_dot2_f32_bf16 v24, v194, v10, v24
    v_dot2_f32_bf16 v24, v195, v11, v24
    v_add_f32_dpp v38, v38, v38 row_ror:8 row_mask:0xf bank_mask:0x3
    s_nop 1
    v_add_f32_dpp v38, v39, v39 row_ror:8 row_mask:0xf bank_mask:0xc
    v_dot2_f32_bf16 v25, v196, v8, 0
    v_dot2_f32_bf16 v25, v197, v9, v25
    v_dot2_f32_bf16 v25, v198, v10, v25
    v_dot2_f32_bf16 v25, v199, v11, v25
    s_waitcnt vmcnt(5)
    v_xor_b32 v45, s80, v2
    buffer_load_dwordx4 a[156:159], v45, s[28:31], 0 offen nt
    s_add_u32 s100, s100, 1
    v_readlane_b32 s101, v61, s100
    s_mov_b32 s80, s101
    v_add_f32_dpp v36, v36, v36 row_shl:4 row_mask:0xf bank_mask:0x5
    s_nop 1
    v_add_f32_dpp v36, v38, v38 row_shr:4 row_mask:0xf bank_mask:0xa
    v_dot2_f32_bf16 v26, v200, v8, 0
    v_dot2_f32_bf16 v26, v201, v9, v26
    v_dot2_f32_bf16 v26, v202, v10, v26
    v_dot2_f32_bf16 v26, v203, v11, v26
    v_add_f32_dpp v24, v24, v24 row_ror:8 row_mask:0xf bank_mask:0x3
    s_nop 1
    v_add_f32_dpp v24, v25, v25 row_ror:8 row_mask:0xf bank_mask:0xc
    v_cndmask_b32 v42, v32, v36, s[10:11]
    v_cndmask_b32 v43, v36, v32, s[10:11]
    s_nop 1
    v_add_f32_dpp v41, v43, v42 quad_perm:[2,3,0,1] row_mask:0xf bank_mask:0xf
    v_dot2_f32_bf16 v27, v204, v8, 0
    v_dot2_f32_bf16 v27, v205, v9, v27
    v_dot2_f32_bf16 v27, v206, v10, v27
    v_dot2_f32_bf16 v27, v207, v11, v27
    v_cndmask_b32 v42, v40, v41, s[12:13]
    v_cndmask_b32 v43, v41, v40, s[12:13]
    s_nop 1
    v_add_f32_dpp v42, v43, v42 quad_perm:[1,0,3,2] row_mask:0xf bank_mask:0xf
    v_dot2_f32_bf16 v28, v208, v8, 0
    v_dot2_f32_bf16 v28, v209, v9, v28
    v_dot2_f32_bf16 v28, v210, v10, v28
    v_dot2_f32_bf16 v28, v211, v11, v28
    v_add_f32_dpp v26, v26, v26 row_ror:8 row_mask:0xf bank_mask:0x3
    s_nop 1
    v_add_f32_dpp v26, v27, v27 row_ror:8 row_mask:0xf bank_mask:0xc
    v_cvt_pk_bf16_f32 v43, v42, v42
    v_lshlrev_b32 v42, 16, v43
    v_mul_f32 v42, s16, v42
    v_cvt_pk_bf16_f32 v43, v42, v42
    v_lshlrev_b32 v42, 16, v43
    ds_write_b32 v44, v42
    v_add_u32 v44, 256, v44
    v_dot2_f32_bf16 v29, v212, v8, 0
    v_dot2_f32_bf16 v29, v213, v9, v29
    v_dot2_f32_bf16 v29, v214, v10, v29
    v_dot2_f32_bf16 v29, v215, v11, v29
    s_waitcnt vmcnt(5)
    v_xor_b32 v45, s80, v2
    buffer_load_dwordx4 a[160:163], v45, s[28:31], 0 offen nt
    s_xor_b32 s80, s101, 0x10100
    v_add_f32_dpp v24, v24, v24 row_shl:4 row_mask:0xf bank_mask:0x5
    s_nop 1
    v_add_f32_dpp v24, v26, v26 row_shr:4 row_mask:0xf bank_mask:0xa
    v_dot2_f32_bf16 v30, v216, v8, 0
    v_dot2_f32_bf16 v30, v217, v9, v30
    v_dot2_f32_bf16 v30, v218, v10, v30
    v_dot2_f32_bf16 v30, v219, v11, v30
    v_add_f32_dpp v28, v28, v28 row_ror:8 row_mask:0xf bank_mask:0x3
    s_nop 1
    v_add_f32_dpp v28, v29, v29 row_ror:8 row_mask:0xf bank_mask:0xc
    v_dot2_f32_bf16 v31, v220, v8, 0
    v_dot2_f32_bf16 v31, v221, v9, v31
    v_dot2_f32_bf16 v31, v222, v10, v31
    v_dot2_f32_bf16 v31, v223, v11, v31
    v_dot2_f32_bf16 v32, v224, v8, 0
    v_dot2_f32_bf16 v32, v225, v9, v32
    v_dot2_f32_bf16 v32, v226, v10, v32
    v_dot2_f32_bf16 v32, v227, v11, v32
    v_add_f32_dpp v30, v30, v30 row_ror:8 row_mask:0xf bank_mask:0x3
    s_nop 1
    v_add_f32_dpp v30, v31, v31 row_ror:8 row_mask:0xf bank_mask:0xc
    v_lshlrev_b32 v150, 2, v1
    v_mov_b32 v151, 2130706432
    v_cmp_gt_u32 vcc, 33, v1
    s_nop 1
    v_cndmask_b32 v150, v151, v150, vcc
    v_mul_u32_u24 v152, 10752, v1
    v_add_u32 v152, 665856, v152
    v_cmp_gt_u32 vcc, 8, v1
    s_nop 1
    v_cndmask_b32 v152, v151, v152, vcc
    v_mov_b32 v160, 0
    v_cmp_gt_u32 vcc, 1, v1
    s_nop 1
    v_cndmask_b32 v151, v151, v160, vcc
    v_mov_b32 v153, 12
    v_mov_b32 v157, 0
    v_mov_b32 v156, 0
    v_mov_b32 v158, 0
    v_mov_b32 v159, 96
    s_mov_b32 s77, 6
    s_mov_b32 s4, 21
    s_cmp_eq_u32 s19, 1
    s_cselect_b32 s38, 16, 0
    s_cmp_eq_u32 s19, 3
    s_cselect_b32 s38, 0, s38
    s_cmp_eq_u32 s19, 1
    s_cselect_b32 s38, 1600, 0
    s_cmp_eq_u32 s19, 3
    s_cselect_b32 s38, 0, s38
    s_cmp_eq_u32 s19, 2
    s_cselect_b32 s38, 640, s38
    v_mov_b32 v162, -1
    s_mov_b32 s97, 0
    s_mov_b32 s99, 0
    s_ashr_i32 s38, s38, 5
    s_sub_u32 s38, s38, 14
    v_mov_b32 v158, -1
    s_mov_b32 s98, 0
    s_mov_b32 s5, 0
    s_mov_b32 s36, -1
    s_mov_b32 s39, 24
    v_dot2_f32_bf16 v33, v228, v8, 0
    v_dot2_f32_bf16 v33, v229, v9, v33
    v_dot2_f32_bf16 v33, v230, v10, v33
    v_dot2_f32_bf16 v33, v231, v11, v33
    s_waitcnt vmcnt(5)
    v_xor_b32 v45, s80, v2
    buffer_load_dwordx4 a[164:167], v45, s[28:31], 0 offen nt
    s_xor_b32 s80, s101, 0x800
    v_add_f32_dpp v28, v28, v28 row_shl:4 row_mask:0xf bank_mask:0x5
    s_nop 1
    v_add_f32_dpp v28, v30, v30 row_shr:4 row_mask:0xf bank_mask:0xa
    v_dot2_f32_bf16 v34, v232, v8, 0
    v_dot2_f32_bf16 v34, v233, v9, v34
    v_dot2_f32_bf16 v34, v234, v10, v34
    v_dot2_f32_bf16 v34, v235, v11, v34
    v_add_f32_dpp v32, v32, v32 row_ror:8 row_mask:0xf bank_mask:0x3
    s_nop 1
    v_add_f32_dpp v32, v33, v33 row_ror:8 row_mask:0xf bank_mask:0xc
    v_cndmask_b32 v42, v24, v28, s[10:11]
    v_cndmask_b32 v43, v28, v24, s[10:11]
    s_nop 1
    v_add_f32_dpp v40, v43, v42 quad_perm:[2,3,0,1] row_mask:0xf bank_mask:0xf
    v_dot2_f32_bf16 v35, v236, v8, 0
    v_dot2_f32_bf16 v35, v237, v9, v35
    v_dot2_f32_bf16 v35, v238, v10, v35
    v_dot2_f32_bf16 v35, v239, v11, v35
    v_dot2_f32_bf16 v36, v240, v8, 0
    v_dot2_f32_bf16 v36, v241, v9, v36
    v_dot2_f32_bf16 v36, v242, v10, v36
    v_dot2_f32_bf16 v36, v243, v11, v36
    v_add_f32_dpp v34, v34, v34 row_ror:8 row_mask:0xf bank_mask:0x3
    s_nop 1
    v_add_f32_dpp v34, v35, v35 row_ror:8 row_mask:0xf bank_mask:0xc
    v_dot2_f32_bf16 v37, v244, v8, 0
    v_dot2_f32_bf16 v37, v245, v9, v37
    v_dot2_f32_bf16 v37, v246, v10, v37
    v_dot2_f32_bf16 v37, v247, v11, v37
    s_waitcnt vmcnt(5)
    v_xor_b32 v45, s80, v2
    buffer_load_dwordx4 a[168:171], v45, s[28:31], 0 offen nt
    s_xor_b32 s80, s101, 0x10900
    v_add_f32_dpp v32, v32, v32 row_shl:4 row_mask:0xf bank_mask:0x5
    s_nop 1
    v_add_f32_dpp v32, v34, v34 row_shr:4 row_mask:0xf bank_mask:0xa
    v_dot2_f32_bf16 v38, v248, v8, 0
    v_dot2_f32_bf16 v38, v249, v9, v38
    v_dot2_f32_bf16 v38, v250, v10, v38
    v_dot2_f32_bf16 v38, v251, v11, v38
    v_add_f32_dpp v36, v36, v36 row_ror:8 row_mask:0xf bank_mask:0x3
    s_nop 1
    v_add_f32_dpp v36, v37, v37 row_ror:8 row_mask:0xf bank_mask:0xc
    v_dot2_f32_bf16 v39, v252, v8, 0
    v_dot2_f32_bf16 v39, v253, v9, v39
    v_dot2_f32_bf16 v39, v254, v10, v39
    v_dot2_f32_bf16 v39, v255, v11, v39
    v_accvgpr_read_b32 v48, a0
    v_accvgpr_read_b32 v49, a1
    v_accvgpr_read_b32 v50, a2
    v_accvgpr_read_b32 v51, a3
    v_dot2_f32_bf16 v24, v48, v8, 0
    v_dot2_f32_bf16 v24, v49, v9, v24
    v_dot2_f32_bf16 v24, v50, v10, v24
    v_dot2_f32_bf16 v24, v51, v11, v24
    v_add_f32_dpp v38, v38, v38 row_ror:8 row_mask:0xf bank_mask:0x3
    s_nop 1
    v_add_f32_dpp v38, v39, v39 row_ror:8 row_mask:0xf bank_mask:0xc
    v_accvgpr_read_b32 v52, a4
    v_accvgpr_read_b32 v53, a5
    v_accvgpr_read_b32 v54, a6
    v_accvgpr_read_b32 v55, a7
    v_dot2_f32_bf16 v25, v52, v8, 0
    v_dot2_f32_bf16 v25, v53, v9, v25
    v_dot2_f32_bf16 v25, v54, v10, v25
    v_dot2_f32_bf16 v25, v55, v11, v25
    v_add_f32_dpp v36, v36, v36 row_shl:4 row_mask:0xf bank_mask:0x5
    s_nop 1
    v_add_f32_dpp v36, v38, v38 row_shr:4 row_mask:0xf bank_mask:0xa
    v_accvgpr_read_b32 v48, a8
    v_accvgpr_read_b32 v49, a9
    v_accvgpr_read_b32 v50, a10
    v_accvgpr_read_b32 v51, a11
    v_dot2_f32_bf16 v26, v48, v8, 0
    v_dot2_f32_bf16 v26, v49, v9, v26
    v_dot2_f32_bf16 v26, v50, v10, v26
    v_dot2_f32_bf16 v26, v51, v11, v26
    s_waitcnt vmcnt(5)
    v_xor_b32 v45, s80, v2
    buffer_load_dwordx4 a[172:175], v45, s[28:31], 0 offen nt
    s_add_u32 s100, s100, 1
    v_readlane_b32 s101, v61, s100
    s_mov_b32 s80, s101
    v_add_f32_dpp v24, v24, v24 row_ror:8 row_mask:0xf bank_mask:0x3
    s_nop 1
    v_add_f32_dpp v24, v25, v25 row_ror:8 row_mask:0xf bank_mask:0xc
    v_cndmask_b32 v42, v32, v36, s[10:11]
    v_cndmask_b32 v43, v36, v32, s[10:11]
    s_nop 1
    v_add_f32_dpp v41, v43, v42 quad_perm:[2,3,0,1] row_mask:0xf bank_mask:0xf
    v_accvgpr_read_b32 v52, a12
    v_accvgpr_read_b32 v53, a13
    v_accvgpr_read_b32 v54, a14
    v_accvgpr_read_b32 v55, a15
    v_dot2_f32_bf16 v27, v52, v8, 0
    v_dot2_f32_bf16 v27, v53, v9, v27
    v_dot2_f32_bf16 v27, v54, v10, v27
    v_dot2_f32_bf16 v27, v55, v11, v27
    v_cndmask_b32 v42, v40, v41, s[12:13]
    v_cndmask_b32 v43, v41, v40, s[12:13]
    s_nop 1
    v_add_f32_dpp v42, v43, v42 quad_perm:[1,0,3,2] row_mask:0xf bank_mask:0xf
    v_accvgpr_read_b32 v48, a16
    v_accvgpr_read_b32 v49, a17
    v_accvgpr_read_b32 v50, a18
    v_accvgpr_read_b32 v51, a19
    v_dot2_f32_bf16 v28, v48, v8, 0
    v_dot2_f32_bf16 v28, v49, v9, v28
    v_dot2_f32_bf16 v28, v50, v10, v28
    v_dot2_f32_bf16 v28, v51, v11, v28
    v_add_f32_dpp v26, v26, v26 row_ror:8 row_mask:0xf bank_mask:0x3
    s_nop 1
    v_add_f32_dpp v26, v27, v27 row_ror:8 row_mask:0xf bank_mask:0xc
    v_cvt_pk_bf16_f32 v43, v42, v42
    v_lshlrev_b32 v42, 16, v43
    v_mul_f32 v42, s16, v42
    v_cvt_pk_bf16_f32 v43, v42, v42
    v_lshlrev_b32 v42, 16, v43
    ds_write_b32 v44, v42
    v_add_u32 v44, 256, v44
    v_accvgpr_read_b32 v52, a20
    v_accvgpr_read_b32 v53, a21
    v_accvgpr_read_b32 v54, a22
    v_accvgpr_read_b32 v55, a23
    v_dot2_f32_bf16 v29, v52, v8, 0
    v_dot2_f32_bf16 v29, v53, v9, v29
    v_dot2_f32_bf16 v29, v54, v10, v29
    v_dot2_f32_bf16 v29, v55, v11, v29
    v_add_f32_dpp v24, v24, v24 row_shl:4 row_mask:0xf bank_mask:0x5
    s_nop 1
    v_add_f32_dpp v24, v26, v26 row_shr:4 row_mask:0xf bank_mask:0xa
    v_accvgpr_read_b32 v48, a24
    v_accvgpr_read_b32 v49, a25
    v_accvgpr_read_b32 v50, a26
    v_accvgpr_read_b32 v51, a27
    v_dot2_f32_bf16 v30, v48, v8, 0
    v_dot2_f32_bf16 v30, v49, v9, v30
    v_dot2_f32_bf16 v30, v50, v10, v30
    v_dot2_f32_bf16 v30, v51, v11, v30
    s_waitcnt vmcnt(5)
    v_xor_b32 v45, s80, v2
    buffer_load_dwordx4 a[176:179], v45, s[28:31], 0 offen nt
    s_xor_b32 s80, s101, 0x10100
    v_add_f32_dpp v28, v28, v28 row_ror:8 row_mask:0xf bank_mask:0x3
    s_nop 1
    v_add_f32_dpp v28, v29, v29 row_ror:8 row_mask:0xf bank_mask:0xc
    v_accvgpr_read_b32 v52, a28
    v_accvgpr_read_b32 v53, a29
    v_accvgpr_read_b32 v54, a30
    v_accvgpr_read_b32 v55, a31
    v_dot2_f32_bf16 v31, v52, v8, 0
    v_dot2_f32_bf16 v31, v53, v9, v31
    v_dot2_f32_bf16 v31, v54, v10, v31
    v_dot2_f32_bf16 v31, v55, v11, v31
    v_accvgpr_read_b32 v48, a32
    v_accvgpr_read_b32 v49, a33
    v_accvgpr_read_b32 v50, a34
    v_accvgpr_read_b32 v51, a35
    v_dot2_f32_bf16 v32, v48, v8, 0
    v_dot2_f32_bf16 v32, v49, v9, v32
    v_dot2_f32_bf16 v32, v50, v10, v32
    v_dot2_f32_bf16 v32, v51, v11, v32
    v_add_f32_dpp v30, v30, v30 row_ror:8 row_mask:0xf bank_mask:0x3
    s_nop 1
    v_add_f32_dpp v30, v31, v31 row_ror:8 row_mask:0xf bank_mask:0xc
    v_accvgpr_read_b32 v52, a36
    v_accvgpr_read_b32 v53, a37
    v_accvgpr_read_b32 v54, a38
    v_accvgpr_read_b32 v55, a39
    v_dot2_f32_bf16 v33, v52, v8, 0
    v_dot2_f32_bf16 v33, v53, v9, v33
    v_dot2_f32_bf16 v33, v54, v10, v33
    v_dot2_f32_bf16 v33, v55, v11, v33
    v_add_f32_dpp v28, v28, v28 row_shl:4 row_mask:0xf bank_mask:0x5
    s_nop 1
    v_add_f32_dpp v28, v30, v30 row_shr:4 row_mask:0xf bank_mask:0xa
    v_accvgpr_read_b32 v48, a40
    v_accvgpr_read_b32 v49, a41
    v_accvgpr_read_b32 v50, a42
    v_accvgpr_read_b32 v51, a43
    v_dot2_f32_bf16 v34, v48, v8, 0
    v_dot2_f32_bf16 v34, v49, v9, v34
    v_dot2_f32_bf16 v34, v50, v10, v34
    v_dot2_f32_bf16 v34, v51, v11, v34
    s_waitcnt vmcnt(5)
    v_xor_b32 v45, s80, v2
    buffer_load_dwordx4 a[180:183], v45, s[28:31], 0 offen nt
    s_xor_b32 s80, s101, 0x800
    v_add_f32_dpp v32, v32, v32 row_ror:8 row_mask:0xf bank_mask:0x3
    s_nop 1
    v_add_f32_dpp v32, v33, v33 row_ror:8 row_mask:0xf bank_mask:0xc
    v_cndmask_b32 v42, v24, v28, s[10:11]
    v_cndmask_b32 v43, v28, v24, s[10:11]
    s_nop 1
    v_add_f32_dpp v40, v43, v42 quad_perm:[2,3,0,1] row_mask:0xf bank_mask:0xf
    v_accvgpr_read_b32 v52, a44
    v_accvgpr_read_b32 v53, a45
    v_accvgpr_read_b32 v54, a46
    v_accvgpr_read_b32 v55, a47
    v_dot2_f32_bf16 v35, v52, v8, 0
    v_dot2_f32_bf16 v35, v53, v9, v35
    v_dot2_f32_bf16 v35, v54, v10, v35
    v_dot2_f32_bf16 v35, v55, v11, v35
    v_accvgpr_read_b32 v48, a48
    v_accvgpr_read_b32 v49, a49
    v_accvgpr_read_b32 v50, a50
    v_accvgpr_read_b32 v51, a51
    v_dot2_f32_bf16 v36, v48, v8, 0
    v_dot2_f32_bf16 v36, v49, v9, v36
    v_dot2_f32_bf16 v36, v50, v10, v36
    v_dot2_f32_bf16 v36, v51, v11, v36
    v_add_f32_dpp v34, v34, v34 row_ror:8 row_mask:0xf bank_mask:0x3
    s_nop 1
    v_add_f32_dpp v34, v35, v35 row_ror:8 row_mask:0xf bank_mask:0xc
    v_accvgpr_read_b32 v52, a52
    v_accvgpr_read_b32 v53, a53
    v_accvgpr_read_b32 v54, a54
    v_accvgpr_read_b32 v55, a55
    v_dot2_f32_bf16 v37, v52, v8, 0
    v_dot2_f32_bf16 v37, v53, v9, v37
    v_dot2_f32_bf16 v37, v54, v10, v37
    v_dot2_f32_bf16 v37, v55, v11, v37
    v_add_f32_dpp v32, v32, v32 row_shl:4 row_mask:0xf bank_mask:0x5
    s_nop 1
    v_add_f32_dpp v32, v34, v34 row_shr:4 row_mask:0xf bank_mask:0xa
    v_accvgpr_read_b32 v48, a56
    v_accvgpr_read_b32 v49, a57
    v_accvgpr_read_b32 v50, a58
    v_accvgpr_read_b32 v51, a59
    v_dot2_f32_bf16 v38, v48, v8, 0
    v_dot2_f32_bf16 v38, v49, v9, v38
    v_dot2_f32_bf16 v38, v50, v10, v38
    v_dot2_f32_bf16 v38, v51, v11, v38
    s_waitcnt vmcnt(5)
    v_xor_b32 v45, s80, v2
    buffer_load_dwordx4 a[184:187], v45, s[28:31], 0 offen nt
    s_xor_b32 s80, s101, 0x10900
    v_add_f32_dpp v36, v36, v36 row_ror:8 row_mask:0xf bank_mask:0x3
    s_nop 1
    v_add_f32_dpp v36, v37, v37 row_ror:8 row_mask:0xf bank_mask:0xc
    v_accvgpr_read_b32 v52, a60
    v_accvgpr_read_b32 v53, a61
    v_accvgpr_read_b32 v54, a62
    v_accvgpr_read_b32 v55, a63
    v_dot2_f32_bf16 v39, v52, v8, 0
    v_dot2_f32_bf16 v39, v53, v9, v39
    v_dot2_f32_bf16 v39, v54, v10, v39
    v_dot2_f32_bf16 v39, v55, v11, v39
    v_accvgpr_read_b32 v48, a64
    v_accvgpr_read_b32 v49, a65
    v_accvgpr_read_b32 v50, a66
    v_accvgpr_read_b32 v51, a67
    v_dot2_f32_bf16 v24, v48, v8, 0
    v_dot2_f32_bf16 v24, v49, v9, v24
    v_dot2_f32_bf16 v24, v50, v10, v24
    v_dot2_f32_bf16 v24, v51, v11, v24
    v_add_f32_dpp v38, v38, v38 row_ror:8 row_mask:0xf bank_mask:0x3
    s_nop 1
    v_add_f32_dpp v38, v39, v39 row_ror:8 row_mask:0xf bank_mask:0xc
    v_accvgpr_read_b32 v52, a68
    v_accvgpr_read_b32 v53, a69
    v_accvgpr_read_b32 v54, a70
    v_accvgpr_read_b32 v55, a71
    v_dot2_f32_bf16 v25, v52, v8, 0
    v_dot2_f32_bf16 v25, v53, v9, v25
    v_dot2_f32_bf16 v25, v54, v10, v25
    v_dot2_f32_bf16 v25, v55, v11, v25
    v_add_f32_dpp v36, v36, v36 row_shl:4 row_mask:0xf bank_mask:0x5
    s_nop 1
    v_add_f32_dpp v36, v38, v38 row_shr:4 row_mask:0xf bank_mask:0xa
    v_accvgpr_read_b32 v48, a72
    v_accvgpr_read_b32 v49, a73
    v_accvgpr_read_b32 v50, a74
    v_accvgpr_read_b32 v51, a75
    v_dot2_f32_bf16 v26, v48, v8, 0
    v_dot2_f32_bf16 v26, v49, v9, v26
    v_dot2_f32_bf16 v26, v50, v10, v26
    v_dot2_f32_bf16 v26, v51, v11, v26
    s_waitcnt vmcnt(5)
    v_xor_b32 v45, s80, v2
    buffer_load_dwordx4 a[188:191], v45, s[28:31], 0 offen nt
    s_add_u32 s100, s100, 1
    v_readlane_b32 s101, v61, s100
    s_mov_b32 s80, s101
    v_add_f32_dpp v24, v24, v24 row_ror:8 row_mask:0xf bank_mask:0x3
    s_nop 1
    v_add_f32_dpp v24, v25, v25 row_ror:8 row_mask:0xf bank_mask:0xc
    v_cndmask_b32 v42, v32, v36, s[10:11]
    v_cndmask_b32 v43, v36, v32, s[10:11]
    s_nop 1
    v_add_f32_dpp v41, v43, v42 quad_perm:[2,3,0,1] row_mask:0xf bank_mask:0xf
    v_accvgpr_read_b32 v52, a76
    v_accvgpr_read_b32 v53, a77
    v_accvgpr_read_b32 v54, a78
    v_accvgpr_read_b32 v55, a79
    v_dot2_f32_bf16 v27, v52, v8, 0
    v_dot2_f32_bf16 v27, v53, v9, v27
    v_dot2_f32_bf16 v27, v54, v10, v27
    v_dot2_f32_bf16 v27, v55, v11, v27
    v_cndmask_b32 v42, v40, v41, s[12:13]
    v_cndmask_b32 v43, v41, v40, s[12:13]
    s_nop 1
    v_add_f32_dpp v42, v43, v42 quad_perm:[1,0,3,2] row_mask:0xf bank_mask:0xf
    v_accvgpr_read_b32 v48, a80
    v_accvgpr_read_b32 v49, a81
    v_accvgpr_read_b32 v50, a82
    v_accvgpr_read_b32 v51, a83
    v_dot2_f32_bf16 v28, v48, v8, 0
    v_dot2_f32_bf16 v28, v49, v9, v28
    v_dot2_f32_bf16 v28, v50, v10, v28
    v_dot2_f32_bf16 v28, v51, v11, v28
    v_add_f32_dpp v26, v26, v26 row_ror:8 row_mask:0xf bank_mask:0x3
    s_nop 1
    v_add_f32_dpp v26, v27, v27 row_ror:8 row_mask:0xf bank_mask:0xc
    v_cvt_pk_bf16_f32 v43, v42, v42
    v_lshlrev_b32 v42, 16, v43
    v_mul_f32 v42, s16, v42
    v_cvt_pk_bf16_f32 v43, v42, v42
    v_lshlrev_b32 v42, 16, v43
    ds_write_b32 v44, v42
    v_add_u32 v44, 256, v44
    v_accvgpr_read_b32 v52, a84
    v_accvgpr_read_b32 v53, a85
    v_accvgpr_read_b32 v54, a86
    v_accvgpr_read_b32 v55, a87
    v_dot2_f32_bf16 v29, v52, v8, 0
    v_dot2_f32_bf16 v29, v53, v9, v29
    v_dot2_f32_bf16 v29, v54, v10, v29
    v_dot2_f32_bf16 v29, v55, v11, v29
    v_add_f32_dpp v24, v24, v24 row_shl:4 row_mask:0xf bank_mask:0x5
    s_nop 1
    v_add_f32_dpp v24, v26, v26 row_shr:4 row_mask:0xf bank_mask:0xa
    v_accvgpr_read_b32 v48, a88
    v_accvgpr_read_b32 v49, a89
    v_accvgpr_read_b32 v50, a90
    v_accvgpr_read_b32 v51, a91
    v_dot2_f32_bf16 v30, v48, v8, 0
    v_dot2_f32_bf16 v30, v49, v9, v30
    v_dot2_f32_bf16 v30, v50, v10, v30
    v_dot2_f32_bf16 v30, v51, v11, v30
    s_waitcnt vmcnt(5)
    v_xor_b32 v45, s80, v2
    buffer_load_dwordx4 v[64:67], v45, s[28:31], 0 offen nt
    s_xor_b32 s80, s101, 0x10100
    v_add_f32_dpp v28, v28, v28 row_ror:8 row_mask:0xf bank_mask:0x3
    s_nop 1
    v_add_f32_dpp v28, v29, v29 row_ror:8 row_mask:0xf bank_mask:0xc
    v_accvgpr_read_b32 v52, a92
    v_accvgpr_read_b32 v53, a93
    v_accvgpr_read_b32 v54, a94
    v_accvgpr_read_b32 v55, a95
    v_dot2_f32_bf16 v31, v52, v8, 0
    v_dot2_f32_bf16 v31, v53, v9, v31
    v_dot2_f32_bf16 v31, v54, v10, v31
    v_dot2_f32_bf16 v31, v55, v11, v31
    v_accvgpr_read_b32 v48, a96
    v_accvgpr_read_b32 v49, a97
    v_accvgpr_read_b32 v50, a98
    v_accvgpr_read_b32 v51, a99
    v_dot2_f32_bf16 v32, v48, v8, 0
    v_dot2_f32_bf16 v32, v49, v9, v32
    v_dot2_f32_bf16 v32, v50, v10, v32
    v_dot2_f32_bf16 v32, v51, v11, v32
    v_add_f32_dpp v30, v30, v30 row_ror:8 row_mask:0xf bank_mask:0x3
    s_nop 1
    v_add_f32_dpp v30, v31, v31 row_ror:8 row_mask:0xf bank_mask:0xc
    v_accvgpr_read_b32 v52, a100
    v_accvgpr_read_b32 v53, a101
    v_accvgpr_read_b32 v54, a102
    v_accvgpr_read_b32 v55, a103
    v_dot2_f32_bf16 v33, v52, v8, 0
    v_dot2_f32_bf16 v33, v53, v9, v33
    v_dot2_f32_bf16 v33, v54, v10, v33
    v_dot2_f32_bf16 v33, v55, v11, v33
    v_add_f32_dpp v28, v28, v28 row_shl:4 row_mask:0xf bank_mask:0x5
    s_nop 1
    v_add_f32_dpp v28, v30, v30 row_shr:4 row_mask:0xf bank_mask:0xa
    v_accvgpr_read_b32 v48, a104
    v_accvgpr_read_b32 v49, a105
    v_accvgpr_read_b32 v50, a106
    v_accvgpr_read_b32 v51, a107
    v_dot2_f32_bf16 v34, v48, v8, 0
    v_dot2_f32_bf16 v34, v49, v9, v34
    v_dot2_f32_bf16 v34, v50, v10, v34
    v_dot2_f32_bf16 v34, v51, v11, v34
    v_add_f32_dpp v32, v32, v32 row_ror:8 row_mask:0xf bank_mask:0x3
    s_nop 1
    v_add_f32_dpp v32, v33, v33 row_ror:8 row_mask:0xf bank_mask:0xc
    v_cndmask_b32 v42, v24, v28, s[10:11]
    v_cndmask_b32 v43, v28, v24, s[10:11]
    s_nop 1
    v_add_f32_dpp v40, v43, v42 quad_perm:[2,3,0,1] row_mask:0xf bank_mask:0xf
    v_accvgpr_read_b32 v52, a108
    v_accvgpr_read_b32 v53, a109
    v_accvgpr_read_b32 v54, a110
    v_accvgpr_read_b32 v55, a111
    v_dot2_f32_bf16 v35, v52, v8, 0
    v_dot2_f32_bf16 v35, v53, v9, v35
    v_dot2_f32_bf16 v35, v54, v10, v35
    v_dot2_f32_bf16 v35, v55, v11, v35
    s_waitcnt vmcnt(5)
    v_xor_b32 v45, s80, v2
    buffer_load_dwordx4 v[68:71], v45, s[28:31], 0 offen nt
    s_xor_b32 s80, s101, 0x800
    v_accvgpr_read_b32 v48, a112
    v_accvgpr_read_b32 v49, a113
    v_accvgpr_read_b32 v50, a114
    v_accvgpr_read_b32 v51, a115
    v_dot2_f32_bf16 v36, v48, v8, 0
    v_dot2_f32_bf16 v36, v49, v9, v36
    v_dot2_f32_bf16 v36, v50, v10, v36
    v_dot2_f32_bf16 v36, v51, v11, v36
    v_add_f32_dpp v34, v34, v34 row_ror:8 row_mask:0xf bank_mask:0x3
    s_nop 1
    v_add_f32_dpp v34, v35, v35 row_ror:8 row_mask:0xf bank_mask:0xc
    v_accvgpr_read_b32 v52, a116
    v_accvgpr_read_b32 v53, a117
    v_accvgpr_read_b32 v54, a118
    v_accvgpr_read_b32 v55, a119
    v_dot2_f32_bf16 v37, v52, v8, 0
    v_dot2_f32_bf16 v37, v53, v9, v37
    v_dot2_f32_bf16 v37, v54, v10, v37
    v_dot2_f32_bf16 v37, v55, v11, v37
    v_add_f32_dpp v32, v32, v32 row_shl:4 row_mask:0xf bank_mask:0x5
    s_nop 1
    v_add_f32_dpp v32, v34, v34 row_shr:4 row_mask:0xf bank_mask:0xa
    v_accvgpr_read_b32 v48, a120
    v_accvgpr_read_b32 v49, a121
    v_accvgpr_read_b32 v50, a122
    v_accvgpr_read_b32 v51, a123
    v_dot2_f32_bf16 v38, v48, v8, 0
    v_dot2_f32_bf16 v38, v49, v9, v38
    v_dot2_f32_bf16 v38, v50, v10, v38
    v_dot2_f32_bf16 v38, v51, v11, v38
    v_add_f32_dpp v36, v36, v36 row_ror:8 row_mask:0xf bank_mask:0x3
    s_nop 1
    v_add_f32_dpp v36, v37, v37 row_ror:8 row_mask:0xf bank_mask:0xc
    v_accvgpr_read_b32 v52, a124
    v_accvgpr_read_b32 v53, a125
    v_accvgpr_read_b32 v54, a126
    v_accvgpr_read_b32 v55, a127
    v_dot2_f32_bf16 v39, v52, v8, 0
    v_dot2_f32_bf16 v39, v53, v9, v39
    v_dot2_f32_bf16 v39, v54, v10, v39
    v_dot2_f32_bf16 v39, v55, v11, v39
    s_waitcnt vmcnt(5)
    v_xor_b32 v45, s80, v2
    buffer_load_dwordx4 v[72:75], v45, s[28:31], 0 offen nt
    s_xor_b32 s80, s101, 0x10900
    v_accvgpr_read_b32 v48, a128
    v_accvgpr_read_b32 v49, a129
    v_accvgpr_read_b32 v50, a130
    v_accvgpr_read_b32 v51, a131
    v_dot2_f32_bf16 v24, v48, v8, 0
    v_dot2_f32_bf16 v24, v49, v9, v24
    v_dot2_f32_bf16 v24, v50, v10, v24
    v_dot2_f32_bf16 v24, v51, v11, v24
    v_add_f32_dpp v38, v38, v38 row_ror:8 row_mask:0xf bank_mask:0x3
    s_nop 1
    v_add_f32_dpp v38, v39, v39 row_ror:8 row_mask:0xf bank_mask:0xc
    v_accvgpr_read_b32 v52, a132
    v_accvgpr_read_b32 v53, a133
    v_accvgpr_read_b32 v54, a134
    v_accvgpr_read_b32 v55, a135
    v_dot2_f32_bf16 v25, v52, v8, 0
    v_dot2_f32_bf16 v25, v53, v9, v25
    v_dot2_f32_bf16 v25, v54, v10, v25
    v_dot2_f32_bf16 v25, v55, v11, v25
    v_add_f32_dpp v36, v36, v36 row_shl:4 row_mask:0xf bank_mask:0x5
    s_nop 1
    v_add_f32_dpp v36, v38, v38 row_shr:4 row_mask:0xf bank_mask:0xa
    v_accvgpr_read_b32 v48, a136
    v_accvgpr_read_b32 v49, a137
    v_accvgpr_read_b32 v50, a138
    v_accvgpr_read_b32 v51, a139
    v_dot2_f32_bf16 v26, v48, v8, 0
    v_dot2_f32_bf16 v26, v49, v9, v26
    v_dot2_f32_bf16 v26, v50, v10, v26
    v_dot2_f32_bf16 v26, v51, v11, v26
    v_add_f32_dpp v24, v24, v24 row_ror:8 row_mask:0xf bank_mask:0x3
    s_nop 1
    v_add_f32_dpp v24, v25, v25 row_ror:8 row_mask:0xf bank_mask:0xc
    v_cndmask_b32 v42, v32, v36, s[10:11]
    v_cndmask_b32 v43, v36, v32, s[10:11]
    s_nop 1
    v_add_f32_dpp v41, v43, v42 quad_perm:[2,3,0,1] row_mask:0xf bank_mask:0xf
    v_accvgpr_read_b32 v52, a140
    v_accvgpr_read_b32 v53, a141
    v_accvgpr_read_b32 v54, a142
    v_accvgpr_read_b32 v55, a143
    v_dot2_f32_bf16 v27, v52, v8, 0
    v_dot2_f32_bf16 v27, v53, v9, v27
    v_dot2_f32_bf16 v27, v54, v10, v27
    v_dot2_f32_bf16 v27, v55, v11, v27
    s_waitcnt vmcnt(5)
    v_xor_b32 v45, s80, v2
    buffer_load_dwordx4 v[76:79], v45, s[28:31], 0 offen nt
    s_add_u32 s100, s100, 1
    v_readlane_b32 s101, v61, s100
    s_mov_b32 s80, s101
    v_cndmask_b32 v42, v40, v41, s[12:13]
    v_cndmask_b32 v43, v41, v40, s[12:13]
    s_nop 1
    v_add_f32_dpp v42, v43, v42 quad_perm:[1,0,3,2] row_mask:0xf bank_mask:0xf
    v_accvgpr_read_b32 v48, a144
    v_accvgpr_read_b32 v49, a145
    v_accvgpr_read_b32 v50, a146
    v_accvgpr_read_b32 v51, a147
    v_dot2_f32_bf16 v28, v48, v8, 0
    v_dot2_f32_bf16 v28, v49, v9, v28
    v_dot2_f32_bf16 v28, v50, v10, v28
    v_dot2_f32_bf16 v28, v51, v11, v28
    v_add_f32_dpp v26, v26, v26 row_ror:8 row_mask:0xf bank_mask:0x3
    s_nop 1
    v_add_f32_dpp v26, v27, v27 row_ror:8 row_mask:0xf bank_mask:0xc
    v_cvt_pk_bf16_f32 v43, v42, v42
    v_lshlrev_b32 v42, 16, v43
    v_mul_f32 v42, s16, v42
    v_cvt_pk_bf16_f32 v43, v42, v42
    v_lshlrev_b32 v42, 16, v43
    ds_write_b32 v44, v42
    v_add_u32 v44, 256, v44
    v_accvgpr_read_b32 v52, a148
    v_accvgpr_read_b32 v53, a149
    v_accvgpr_read_b32 v54, a150
    v_accvgpr_read_b32 v55, a151
    v_dot2_f32_bf16 v29, v52, v8, 0
    v_dot2_f32_bf16 v29, v53, v9, v29
    v_dot2_f32_bf16 v29, v54, v10, v29
    v_dot2_f32_bf16 v29, v55, v11, v29
    v_add_f32_dpp v24, v24, v24 row_shl:4 row_mask:0xf bank_mask:0x5
    s_nop 1
    v_add_f32_dpp v24, v26, v26 row_shr:4 row_mask:0xf bank_mask:0xa
    v_accvgpr_read_b32 v48, a152
    v_accvgpr_read_b32 v49, a153
    v_accvgpr_read_b32 v50, a154
    v_accvgpr_read_b32 v51, a155
    v_dot2_f32_bf16 v30, v48, v8, 0
    v_dot2_f32_bf16 v30, v49, v9, v30
    v_dot2_f32_bf16 v30, v50, v10, v30
    v_dot2_f32_bf16 v30, v51, v11, v30
    v_add_f32_dpp v28, v28, v28 row_ror:8 row_mask:0xf bank_mask:0x3
    s_nop 1
    v_add_f32_dpp v28, v29, v29 row_ror:8 row_mask:0xf bank_mask:0xc
    v_accvgpr_read_b32 v52, a156
    v_accvgpr_read_b32 v53, a157
    v_accvgpr_read_b32 v54, a158
    v_accvgpr_read_b32 v55, a159
    v_dot2_f32_bf16 v31, v52, v8, 0
    v_dot2_f32_bf16 v31, v53, v9, v31
    v_dot2_f32_bf16 v31, v54, v10, v31
    v_dot2_f32_bf16 v31, v55, v11, v31
    s_waitcnt vmcnt(5)
    v_xor_b32 v45, s80, v2
    buffer_load_dwordx4 v[80:83], v45, s[28:31], 0 offen nt
    s_xor_b32 s80, s101, 0x10100
    v_accvgpr_read_b32 v48, a160
    v_accvgpr_read_b32 v49, a161
    v_accvgpr_read_b32 v50, a162
    v_accvgpr_read_b32 v51, a163
    v_dot2_f32_bf16 v32, v48, v8, 0
    v_dot2_f32_bf16 v32, v49, v9, v32
    v_dot2_f32_bf16 v32, v50, v10, v32
    v_dot2_f32_bf16 v32, v51, v11, v32
    v_add_f32_dpp v30, v30, v30 row_ror:8 row_mask:0xf bank_mask:0x3
    s_nop 1
    v_add_f32_dpp v30, v31, v31 row_ror:8 row_mask:0xf bank_mask:0xc
    v_accvgpr_read_b32 v52, a164
    v_accvgpr_read_b32 v53, a165
    v_accvgpr_read_b32 v54, a166
    v_accvgpr_read_b32 v55, a167
    v_dot2_f32_bf16 v33, v52, v8, 0
    v_dot2_f32_bf16 v33, v53, v9, v33
    v_dot2_f32_bf16 v33, v54, v10, v33
    v_dot2_f32_bf16 v33, v55, v11, v33
    v_add_f32_dpp v28, v28, v28 row_shl:4 row_mask:0xf bank_mask:0x5
    s_nop 1
    v_add_f32_dpp v28, v30, v30 row_shr:4 row_mask:0xf bank_mask:0xa
    v_accvgpr_read_b32 v48, a168
    v_accvgpr_read_b32 v49, a169
    v_accvgpr_read_b32 v50, a170
    v_accvgpr_read_b32 v51, a171
    v_dot2_f32_bf16 v34, v48, v8, 0
    v_dot2_f32_bf16 v34, v49, v9, v34
    v_dot2_f32_bf16 v34, v50, v10, v34
    v_dot2_f32_bf16 v34, v51, v11, v34
    v_add_f32_dpp v32, v32, v32 row_ror:8 row_mask:0xf bank_mask:0x3
    s_nop 1
    v_add_f32_dpp v32, v33, v33 row_ror:8 row_mask:0xf bank_mask:0xc
    v_cndmask_b32 v42, v24, v28, s[10:11]
    v_cndmask_b32 v43, v28, v24, s[10:11]
    s_nop 1
    v_add_f32_dpp v40, v43, v42 quad_perm:[2,3,0,1] row_mask:0xf bank_mask:0xf
    v_accvgpr_read_b32 v52, a172
    v_accvgpr_read_b32 v53, a173
    v_accvgpr_read_b32 v54, a174
    v_accvgpr_read_b32 v55, a175
    v_dot2_f32_bf16 v35, v52, v8, 0
    v_dot2_f32_bf16 v35, v53, v9, v35
    v_dot2_f32_bf16 v35, v54, v10, v35
    v_dot2_f32_bf16 v35, v55, v11, v35
    s_waitcnt vmcnt(5)
    v_xor_b32 v45, s80, v2
    buffer_load_dwordx4 v[84:87], v45, s[28:31], 0 offen nt
    s_xor_b32 s80, s101, 0x800
    v_accvgpr_read_b32 v48, a176
    v_accvgpr_read_b32 v49, a177
    v_accvgpr_read_b32 v50, a178
    v_accvgpr_read_b32 v51, a179
    v_dot2_f32_bf16 v36, v48, v8, 0
    v_dot2_f32_bf16 v36, v49, v9, v36
    v_dot2_f32_bf16 v36, v50, v10, v36
    v_dot2_f32_bf16 v36, v51, v11, v36
    v_add_f32_dpp v34, v34, v34 row_ror:8 row_mask:0xf bank_mask:0x3
    s_nop 1
    v_add_f32_dpp v34, v35, v35 row_ror:8 row_mask:0xf bank_mask:0xc
    v_accvgpr_read_b32 v52, a180
    v_accvgpr_read_b32 v53, a181
    v_accvgpr_read_b32 v54, a182
    v_accvgpr_read_b32 v55, a183
    v_dot2_f32_bf16 v37, v52, v8, 0
    v_dot2_f32_bf16 v37, v53, v9, v37
    v_dot2_f32_bf16 v37, v54, v10, v37
    v_dot2_f32_bf16 v37, v55, v11, v37
    v_add_f32_dpp v32, v32, v32 row_shl:4 row_mask:0xf bank_mask:0x5
    s_nop 1
    v_add_f32_dpp v32, v34, v34 row_shr:4 row_mask:0xf bank_mask:0xa
    v_accvgpr_read_b32 v48, a184
    v_accvgpr_read_b32 v49, a185
    v_accvgpr_read_b32 v50, a186
    v_accvgpr_read_b32 v51, a187
    v_dot2_f32_bf16 v38, v48, v8, 0
    v_dot2_f32_bf16 v38, v49, v9, v38
    v_dot2_f32_bf16 v38, v50, v10, v38
    v_dot2_f32_bf16 v38, v51, v11, v38
    v_add_f32_dpp v36, v36, v36 row_ror:8 row_mask:0xf bank_mask:0x3
    s_nop 1
    v_add_f32_dpp v36, v37, v37 row_ror:8 row_mask:0xf bank_mask:0xc
    v_accvgpr_read_b32 v52, a188
    v_accvgpr_read_b32 v53, a189
    v_accvgpr_read_b32 v54, a190
    v_accvgpr_read_b32 v55, a191
    v_dot2_f32_bf16 v39, v52, v8, 0
    v_dot2_f32_bf16 v39, v53, v9, v39
    v_dot2_f32_bf16 v39, v54, v10, v39
    v_dot2_f32_bf16 v39, v55, v11, v39
    s_waitcnt vmcnt(5)
    v_xor_b32 v45, s80, v2
    buffer_load_dwordx4 v[88:91], v45, s[28:31], 0 offen nt
    s_xor_b32 s80, s101, 0x10900
    s_mov_b32 s81, 6
    s_mov_b32 s14, 0
    s_mov_b32 s15, 0
    s_mov_b32 s17, 0
    s_mul_i32 s14, s75, 5120
    s_mul_i32 s17, s75, 20
    s_mov_b32 s82, 0
    s_mov_b32 s83, 0
    s_mul_i32 s14, s75, 5
    s_lshl_b32 s15, s3, 3
    s_lshl_b32 s21, s3, 8
    s_sub_u32 s21, 1024, s21
    s_cmp_lg_u32 s3, 0
    s_cbranch_scc1 L_k0
    s_cmp_lg_u32 s73, 14
    s_cbranch_scc1 L_k1
L_k2:
L_lpk2:
    s_waitcnt vmcnt(6)
    v_dot2_f32_bf16 v24, v64, v8, 0
    v_dot2_f32_bf16 v24, v65, v9, v24
    v_dot2_f32_bf16 v24, v66, v10, v24
    v_dot2_f32_bf16 v24, v67, v11, v24
    buffer_store_dword v162, v151, s[44:47], s27 offen sc1
    buffer_store_dword v158, v151, s[44:47], s6 offen
    s_mul_i32 s99, s77, 215
    s_memrealtime s[94:95]
    s_add_u32 s23, s14, s15
    s_and_b32 s23, s23, 31
    s_mul_i32 s23, s23, 5120
    s_cmp_lt_u32 s14, 32
    s_cselect_b32 s7, 0, s21
    s_add_u32 s23, s23, s7
    s_cmp_lt_u32 s82, 40
    s_cselect_b32 s23, s23, 2130706432
    s_add_u32 s82, s82, 1
    buffer_load_dwordx4 v[128:131], v60, s[40:43], s23 offen
    s_add_u32 s14, s14, 1
    s_cmp_eq_u32 s14, 40
    s_cselect_b32 s14, 0, s14
    s_cmp_gt_u32 s4, 16
    s_cbranch_scc1 L_sk1
    s_cmp_gt_u32 s4, 0
    s_cbranch_scc1 L_sk1m
    s_waitcnt vmcnt(6)
L_sk1m:
    s_waitcnt vmcnt(7)
L_sk1:
    v_xor_b32 v45, s80, v2
    buffer_load_dwordx4 v[92:95], v45, s[28:31], 0 offen nt
    s_add_u32 s100, s100, 1
    v_readlane_b32 s101, v61, s100
    s_mov_b32 s80, s101
    v_add_u32 v159, 1, v159
    ds_write_b32 v160, v159 offset:21252
    v_add_f32_dpp v38, v38, v38 row_ror:8 row_mask:0xf bank_mask:0x3
    s_nop 1
    v_add_f32_dpp v38, v39, v39 row_ror:8 row_mask:0xf bank_mask:0xc
    s_waitcnt vmcnt(9)
    v_dot2_f32_bf16 v25, v68, v8, 0
    v_dot2_f32_bf16 v25, v69, v9, v25
    v_dot2_f32_bf16 v25, v70, v10, v25
    v_dot2_f32_bf16 v25, v71, v11, v25
    s_waitcnt lgkmcnt(0)
    s_sub_u32 s79, s94, s99
    s_mov_b32 s96, s79
    v_mov_b32 v153, s79
    buffer_store_dword v153, v151, s[44:47], s25 offen
    s_sub_u32 s79, s79, s98
    s_add_u32 s79, s79, s38
    s_and_b32 s79, s79, s97
    s_mul_i32 s79, s79, 3
    s_ashr_i32 s79, s79, 3
    s_add_u32 s79, s79, 46
    s_max_i32 s79, s79, 0
    s_min_i32 s79, s79, 64
    v_mov_b32 v157, s79
    ds_write_b32 v160, v157 offset:21248
    s_lshr_b32 s4, s79, 1
    s_cmp_gt_u32 s4, 24
    s_cbranch_scc1 L_sk2
    s_cmp_gt_u32 s4, 8
    s_cbranch_scc1 L_sk2m
    s_waitcnt vmcnt(7)
L_sk2m:
    s_waitcnt vmcnt(8)
L_sk2:
    v_xor_b32 v45, s80, v2
    buffer_load_dwordx4 v[96:99], v45, s[28:31], 0 offen nt
    s_xor_b32 s80, s101, 0x10100
    v_add_u32 v159, 1, v159
    ds_write_b32 v160, v159 offset:21252
    v_add_f32_dpp v36, v36, v36 row_shl:4 row_mask:0xf bank_mask:0x5
    s_nop 1
    v_add_f32_dpp v36, v38, v38 row_shr:4 row_mask:0xf bank_mask:0xa
    s_waitcnt vmcnt(10)
    v_dot2_f32_bf16 v26, v72, v8, 0
    v_dot2_f32_bf16 v26, v73, v9, v26
    v_dot2_f32_bf16 v26, v74, v10, v26
    v_dot2_f32_bf16 v26, v75, v11, v26
    s_memrealtime s[94:95]
    s_add_u32 s23, s14, s15
    s_and_b32 s23, s23, 31
    s_mul_i32 s23, s23, 5120
    s_cmp_lt_u32 s14, 32
    s_cselect_b32 s7, 0, s21
    s_add_u32 s23, s23, s7
    s_cmp_lt_u32 s82, 40
    s_cselect_b32 s23, s23, 2130706432
    s_add_u32 s82, s82, 1
    buffer_load_dwordx4 v[132:135], v60, s[40:43], s23 offen
    s_add_u32 s14, s14, 1
    s_cmp_eq_u32 s14, 40
    s_cselect_b32 s14, 0, s14
    s_cmp_gt_u32 s4, 20
    s_cbranch_scc1 L_sk3
    s_cmp_gt_u32 s4, 4
    s_cbranch_scc1 L_sk3m
    s_waitcnt vmcnt(8)
L_sk3m:
    s_waitcnt vmcnt(9)
L_sk3:
    v_xor_b32 v45, s80, v2
    buffer_load_dwordx4 v[100:103], v45, s[28:31], 0 offen nt
    s_xor_b32 s80, s101, 0x800
    v_add_u32 v159, 1, v159
    ds_write_b32 v160, v159 offset:21252
    v_add_f32_dpp v24, v24, v24 row_ror:8 row_mask:0xf bank_mask:0x3
    s_nop 1
    v_add_f32_dpp v24, v25, v25 row_ror:8 row_mask:0xf bank_mask:0xc
    v_cndmask_b32 v42, v32, v36, s[10:11]
    v_cndmask_b32 v43, v36, v32, s[10:11]
    s_nop 1
    v_add_f32_dpp v41, v43, v42 quad_perm:[2,3,0,1] row_mask:0xf bank_mask:0xf
    s_waitcnt vmcnt(11)
    v_dot2_f32_bf16 v27, v76, v8, 0
    v_dot2_f32_bf16 v27, v77, v9, v27
    v_dot2_f32_bf16 v27, v78, v10, v27
    v_dot2_f32_bf16 v27, v79, v11, v27
    s_waitcnt lgkmcnt(0)
    s_sub_u32 s79, s94, s99
    s_sub_u32 s79, s79, s98
    s_add_u32 s79, s79, s38
    s_sub_u32 s79, s79, 26
    s_and_b32 s79, s79, s97
    s_mul_i32 s79, s79, 3
    s_ashr_i32 s79, s79, 3
    s_add_u32 s79, s79, 46
    s_max_i32 s79, s79, 0
    s_min_i32 s79, s79, 64
    v_mov_b32 v157, s79
    ds_write_b32 v160, v157 offset:21248
    s_add_u32 s79, s79, 1
    s_lshr_b32 s4, s79, 1
    s_cmp_gt_u32 s4, 28
    s_cbranch_scc1 L_sk4
    s_cmp_gt_u32 s4, 12
    s_cbranch_scc1 L_sk4m
    s_waitcnt vmcnt(8)
L_sk4m:
    s_waitcnt vmcnt(9)
L_sk4:
    v_xor_b32 v45, s80, v2
    buffer_load_dwordx4 v[104:107], v45, s[28:31], 0 offen nt
    s_xor_b32 s80, s101, 0x10900
    v_add_u32 v159, 1, v159
    ds_write_b32 v160, v159 offset:21252
    v_cndmask_b32 v42, v40, v41, s[12:13]
    v_cndmask_b32 v43, v41, v40, s[12:13]
    s_nop 1
    v_add_f32_dpp v42, v43, v42 quad_perm:[1,0,3,2] row_mask:0xf bank_mask:0xf
    s_waitcnt vmcnt(11)
    v_dot2_f32_bf16 v28, v80, v8, 0
    v_dot2_f32_bf16 v28, v81, v9, v28
    v_dot2_f32_bf16 v28, v82, v10, v28
    v_dot2_f32_bf16 v28, v83, v11, v28
    buffer_load_dword v154, v150, s[44:47], s24 offen sc1
    s_memrealtime s[94:95]
    s_add_u32 s23, s14, s15
    s_and_b32 s23, s23, 31
    s_mul_i32 s23, s23, 5120
    s_cmp_lt_u32 s14, 32
    s_cselect_b32 s7, 0, s21
    s_add_u32 s23, s23, s7
    s_cmp_lt_u32 s82, 40
    s_cselect_b32 s23, s23, 2130706432
    s_add_u32 s82, s82, 1
    buffer_load_dwordx4 v[136:139], v60, s[40:43], s23 offen
    s_add_u32 s14, s14, 1
    s_cmp_eq_u32 s14, 40
    s_cselect_b32 s14, 0, s14
    s_cmp_gt_u32 s4, 18
    s_cbranch_scc1 L_sk5
    s_cmp_gt_u32 s4, 2
    s_cbranch_scc1 L_sk5m
    s_waitcnt vmcnt(7)
L_sk5m:
    s_waitcnt vmcnt(11)
L_sk5:
    v_xor_b32 v45, s80, v2
    buffer_load_dwordx4 v[108:111], v45, s[28:31], 0 offen nt
    s_add_u32 s100, s100, 1
    v_readlane_b32 s101, v61, s100
    s_mov_b32 s80, s101
    v_add_u32 v159, 1, v159
    ds_write_b32 v160, v159 offset:21252
    v_add_f32_dpp v26, v26, v26 row_ror:8 row_mask:0xf bank_mask:0x3
    s_nop 1
    v_add_f32_dpp v26, v27, v27 row_ror:8 row_mask:0xf bank_mask:0xc
    v_cvt_pk_bf16_f32 v43, v42, v42
    v_lshlrev_b32 v42, 16, v43
    v_mul_f32 v42, s16, v42
    v_cvt_pk_bf16_f32 v43, v42, v42
    v_lshlrev_b32 v42, 16, v43
    ds_write_b32 v44, v42
    v_add_u32 v44, 256, v44
    s_waitcnt vmcnt(13)
    v_dot2_f32_bf16 v29, v84, v8, 0
    v_dot2_f32_bf16 v29, v85, v9, v29
    v_dot2_f32_bf16 v29, v86, v10, v29
    v_dot2_f32_bf16 v29, v87, v11, v29
    s_waitcnt lgkmcnt(0)
    s_sub_u32 s79, s94, s99
    s_sub_u32 s79, s79, s98
    s_add_u32 s79, s79, s38
    s_sub_u32 s79, s79, 53
    s_and_b32 s79, s79, s97
    s_mul_i32 s79, s79, 3
    s_ashr_i32 s79, s79, 3
    s_add_u32 s79, s79, 46
    s_max_i32 s79, s79, 0
    s_min_i32 s79, s79, 64
    v_mov_b32 v157, s79
    ds_write_b32 v160, v157 offset:21248
    s_lshr_b32 s4, s79, 1
    s_cmp_gt_u32 s4, 26
    s_cbranch_scc1 L_sk6
    s_cmp_gt_u32 s4, 10
    s_cbranch_scc1 L_sk6m
    s_waitcnt vmcnt(6)
L_sk6m:
    s_waitcnt vmcnt(8)
L_sk6:
    v_xor_b32 v45, s80, v2
    buffer_load_dwordx4 v[112:115], v45, s[28:31], 0 offen nt
    s_xor_b32 s80, s101, 0x10100
    v_add_u32 v159, 1, v159
    ds_write_b32 v160, v159 offset:21252
    v_add_f32_dpp v24, v24, v24 row_shl:4 row_mask:0xf bank_mask:0x5
    s_nop 1
    v_add_f32_dpp v24, v26, v26 row_shr:4 row_mask:0xf bank_mask:0xa
    s_waitcnt vmcnt(13)
    v_dot2_f32_bf16 v30, v88, v8, 0
    v_dot2_f32_bf16 v30, v89, v9, v30
    v_dot2_f32_bf16 v30, v90, v10, v30
    v_dot2_f32_bf16 v30, v91, v11, v30
    buffer_load_dword v155, v152, s[44:47], 0 offen sc1
    s_memrealtime s[94:95]
    s_add_u32 s23, s14, s15
    s_and_b32 s23, s23, 31
    s_mul_i32 s23, s23, 5120
    s_cmp_lt_u32 s14, 32
    s_cselect_b32 s7, 0, s21
    s_add_u32 s23, s23, s7
    s_cmp_lt_u32 s82, 40
    s_cselect_b32 s23, s23, 2130706432
    s_add_u32 s82, s82, 1
    buffer_load_dwordx4 v[140:143], v60, s[40:43], s23 offen
    s_add_u32 s14, s14, 1
    s_cmp_eq_u32 s14, 40
    s_cselect_b32 s14, 0, s14
    s_cmp_gt_u32 s4, 22
    s_cbranch_scc1 L_sk7
    s_cmp_gt_u32 s4, 6
    s_cbranch_scc1 L_sk7m
    s_waitcnt vmcnt(7)
L_sk7m:
    s_waitcnt vmcnt(9)
L_sk7:
    v_xor_b32 v45, s80, v2
    buffer_load_dwordx4 v[116:119], v45, s[28:31], 0 offen nt
    s_xor_b32 s80, s101, 0x800
    v_add_u32 v159, 1, v159
    ds_write_b32 v160, v159 offset:21252
    v_add_f32_dpp v28, v28, v28 row_ror:8 row_mask:0xf bank_mask:0x3
    s_nop 1
    v_add_f32_dpp v28, v29, v29 row_ror:8 row_mask:0xf bank_mask:0xc
    s_waitcnt vmcnt(12)
    v_dot2_f32_bf16 v31, v92, v8, 0
    v_dot2_f32_bf16 v31, v93, v9, v31
    v_dot2_f32_bf16 v31, v94, v10, v31
    v_dot2_f32_bf16 v31, v95, v11, v31
    s_cmp_lt_u32 s83, 40
    s_cselect_b32 s23, s17, 160
    s_add_u32 s83, s83, 1
    s_set_gpr_idx_on s23, gpr_idx(DST)
    v_accvgpr_write_b32 a0, v128
    v_accvgpr_write_b32 a1, v129
    v_accvgpr_write_b32 a2, v130
    v_accvgpr_write_b32 a3, v131
    s_set_gpr_idx_off
    s_add_u32 s17, s17, 4
    s_cmp_eq_u32 s17, 160
    s_cselect_b32 s17, 0, s17
    s_waitcnt lgkmcnt(0)
    s_sub_u32 s79, s94, s99
    s_sub_u32 s79, s79, s98
    s_add_u32 s79, s79, s38
    s_sub_u32 s79, s79, 80
    s_and_b32 s79, s79, s97
    s_mul_i32 s79, s79, 3
    s_ashr_i32 s79, s79, 3
    s_add_u32 s79, s79, 46
    s_max_i32 s79, s79, 0
    s_min_i32 s79, s79, 64
    v_mov_b32 v157, s79
    ds_write_b32 v160, v157 offset:21248
    s_add_u32 s79, s79, 1
    s_lshr_b32 s4, s79, 1
    s_cmp_gt_u32 s4, 30
    s_cbranch_scc1 L_sk8
    s_cmp_gt_u32 s4, 14
    s_cbranch_scc1 L_sk8m
    s_waitcnt vmcnt(7)
L_sk8m:
    s_waitcnt vmcnt(8)
L_sk8:
    v_xor_b32 v45, s80, v2
    buffer_load_dwordx4 v[120:123], v45, s[28:31], 0 offen nt
    s_xor_b32 s80, s101, 0x10900
    v_add_u32 v159, 1, v159
    ds_write_b32 v160, v159 offset:21252
    s_waitcnt vmcnt(11)
    v_dot2_f32_bf16 v32, v96, v8, 0
    v_dot2_f32_bf16 v32, v97, v9, v32
    v_dot2_f32_bf16 v32, v98, v10, v32
    v_dot2_f32_bf16 v32, v99, v11, v32
    s_memrealtime s[94:95]
    s_cmp_gt_u32 s4, 17
    s_cbranch_scc1 L_sk9
    s_cmp_gt_u32 s4, 1
    s_cbranch_scc1 L_sk9m
    s_waitcnt vmcnt(5)
L_sk9m:
    s_waitcnt vmcnt(8)
L_sk9:
    v_xor_b32 v45, s80, v2
    buffer_load_dwordx4 v[124:127], v45, s[28:31], 0 offen nt
    s_add_u32 s100, s100, 1
    v_readlane_b32 s101, v61, s100
    s_mov_b32 s80, s101
    v_add_u32 v159, 1, v159
    ds_write_b32 v160, v159 offset:21252
    v_add_f32_dpp v30, v30, v30 row_ror:8 row_mask:0xf bank_mask:0x3
    s_nop 1
    v_add_f32_dpp v30, v31, v31 row_ror:8 row_mask:0xf bank_mask:0xc
    s_waitcnt vmcnt(10)
    v_dot2_f32_bf16 v33, v100, v8, 0
    v_dot2_f32_bf16 v33, v101, v9, v33
    v_dot2_f32_bf16 v33, v102, v10, v33
    v_dot2_f32_bf16 v33, v103, v11, v33
    s_cmp_lt_u32 s83, 40
    s_cselect_b32 s23, s17, 160
    s_add_u32 s83, s83, 1
    s_set_gpr_idx_on s23, gpr_idx(DST)
    v_accvgpr_write_b32 a0, v132
    v_accvgpr_write_b32 a1, v133
    v_accvgpr_write_b32 a2, v134
    v_accvgpr_write_b32 a3, v135
    s_set_gpr_idx_off
    s_add_u32 s17, s17, 4
    s_cmp_eq_u32 s17, 160
    s_cselect_b32 s17, 0, s17
    s_waitcnt lgkmcnt(0)
    s_sub_u32 s79, s94, s99
    s_sub_u32 s79, s79, s98
    s_add_u32 s79, s79, s38
    s_sub_u32 s79, s79, 107
    s_and_b32 s79, s79, s97
    s_mul_i32 s79, s79, 3
    s_ashr_i32 s79, s79, 3
    s_add_u32 s79, s79, 46
    s_max_i32 s79, s79, 0
    s_min_i32 s79, s79, 64
    v_mov_b32 v157, s79
    ds_write_b32 v160, v157 offset:21248
    s_lshr_b32 s4, s79, 1
    s_cmp_lg_u32 s81, 15
    s_cbranch_scc1 L_noswk2
    s_mov_b32 s28, s8
    s_mov_b32 s29, s9
    s_mov_b32 s100, 0
    v_readlane_b32 s101, v61, 0
    s_mov_b32 s80, s101
L_noswk2:
    s_cmp_gt_u32 s4, 25
    s_cbranch_scc1 L_sk10
    s_cmp_gt_u32 s4, 9
    s_cbranch_scc1 L_sk10m
    s_waitcnt vmcnt(5)
L_sk10m:
    s_waitcnt vmcnt(6)
L_sk10:
    v_xor_b32 v45, s80, v2
    buffer_load_dwordx4 v[64:67], v45, s[28:31], 0 offen nt
    s_xor_b32 s80, s101, 0x10100
    v_add_u32 v159, 1, v159
    ds_write_b32 v160, v159 offset:21252
    v_add_f32_dpp v28, v28, v28 row_shl:4 row_mask:0xf bank_mask:0x5
    s_nop 1
    v_add_f32_dpp v28, v30, v30 row_shr:4 row_mask:0xf bank_mask:0xa
    s_waitcnt vmcnt(10)
    v_dot2_f32_bf16 v34, v104, v8, 0
    v_dot2_f32_bf16 v34, v105, v9, v34
    v_dot2_f32_bf16 v34, v106, v10, v34
    v_dot2_f32_bf16 v34, v107, v11, v34
    s_memrealtime s[94:95]
    s_cmp_gt_u32 s4, 21
    s_cbranch_scc1 L_sk11
    s_cmp_gt_u32 s4, 5
    s_cbranch_scc1 L_sk11m
    s_waitcnt vmcnt(3)
L_sk11m:
    s_waitcnt vmcnt(6)
L_sk11:
    v_xor_b32 v45, s80, v2
    buffer_load_dwordx4 v[68:71], v45, s[28:31], 0 offen nt
    s_xor_b32 s80, s101, 0x800
    v_add_u32 v159, 1, v159
    ds_write_b32 v160, v159 offset:21252
    v_add_f32_dpp v32, v32, v32 row_ror:8 row_mask:0xf bank_mask:0x3
    s_nop 1
    v_add_f32_dpp v32, v33, v33 row_ror:8 row_mask:0xf bank_mask:0xc
    v_cndmask_b32 v42, v24, v28, s[10:11]
    v_cndmask_b32 v43, v28, v24, s[10:11]
    s_nop 1
    v_add_f32_dpp v40, v43, v42 quad_perm:[2,3,0,1] row_mask:0xf bank_mask:0xf
    s_waitcnt vmcnt(8)
    v_dot2_f32_bf16 v35, v108, v8, 0
    v_dot2_f32_bf16 v35, v109, v9, v35
    v_dot2_f32_bf16 v35, v110, v10, v35
    v_dot2_f32_bf16 v35, v111, v11, v35
    s_cmp_lt_u32 s83, 40
    s_cselect_b32 s23, s17, 160
    s_add_u32 s83, s83, 1
    s_set_gpr_idx_on s23, gpr_idx(DST)
    v_accvgpr_write_b32 a0, v136
    v_accvgpr_write_b32 a1, v137
    v_accvgpr_write_b32 a2, v138
    v_accvgpr_write_b32 a3, v139
    s_set_gpr_idx_off
    s_add_u32 s17, s17, 4
    s_cmp_eq_u32 s17, 160
    s_cselect_b32 s17, 0, s17
    s_waitcnt lgkmcnt(0)
    s_sub_u32 s79, s94, s99
    s_sub_u32 s79, s79, s98
    s_add_u32 s79, s79, s38
    s_sub_u32 s79, s79, 134
    s_and_b32 s79, s79, s97
    s_mul_i32 s79, s79, 3
    s_ashr_i32 s79, s79, 3
    s_add_u32 s79, s79, 46
    s_max_i32 s79, s79, 0
    s_min_i32 s79, s79, 64
    v_mov_b32 v157, s79
    ds_write_b32 v160, v157 offset:21248
    s_add_u32 s79, s79, 1
    s_lshr_b32 s4, s79, 1
    s_cmp_gt_u32 s4, 29
    s_cbranch_scc1 L_sk12
    s_cmp_gt_u32 s4, 13
    s_cbranch_scc1 L_sk12m
    s_waitcnt vmcnt(3)
L_sk12m:
    s_waitcnt vmcnt(4)
L_sk12:
    v_xor_b32 v45, s80, v2
    buffer_load_dwordx4 v[72:75], v45, s[28:31], 0 offen nt
    s_xor_b32 s80, s101, 0x10900
    v_add_u32 v159, 1, v159
    ds_write_b32 v160, v159 offset:21252
    s_waitcnt vmcnt(8)
    v_dot2_f32_bf16 v36, v112, v8, 0
    v_dot2_f32_bf16 v36, v113, v9, v36
    v_dot2_f32_bf16 v36, v114, v10, v36
    v_dot2_f32_bf16 v36, v115, v11, v36
    v_readlane_b32 s7, v154, 32
    v_sub_u32 v157, s96, v154
    v_cmp_eq_u32 vcc, -1, v154
    v_max_i32 v157, -200, v157
    v_min_i32 v157, 200, v157
    v_cndmask_b32 v157, v157, v160, vcc
    s_nop 1
    v_add_u32_dpp v157, v157, v157 quad_perm:[1,0,3,2] row_mask:0xf bank_mask:0xf
    s_nop 1
    v_add_u32_dpp v157, v157, v157 quad_perm:[2,3,0,1] row_mask:0xf bank_mask:0xf
    s_nop 1
    v_add_u32_dpp v157, v157, v157 row_half_mirror row_mask:0xf bank_mask:0xf
    s_nop 1
    v_add_u32_dpp v157, v157, v157 row_mirror row_mask:0xf bank_mask:0xf
    s_nop 0
    v_readlane_b32 s79, v157, 0
    v_readlane_b32 s98, v157, 16
    s_add_u32 s79, s79, s98
    s_ashr_i32 s79, s79, 5
    s_sub_u32 s98, s96, s79
    v_mov_b32 v162, s98
    s_mov_b32 s97, -1
    s_cmp_eq_u32 s7, -1
    s_cselect_b32 s98, s98, s7
    s_memrealtime s[94:95]
    s_and_b32 s7, s73, 7
    s_add_u32 s7, s7, 6
    s_cmp_lg_u32 s7, s81
    s_cbranch_scc1 L_nfk2
    s_mov_b32 s79, 0x8000
L_fchkk2:
    s_load_dword s7, s[68:69], 0 glc
    s_waitcnt lgkmcnt(0)
    s_cmp_lg_u32 s7, 0
    s_cbranch_scc1 L_fokk2
    s_sleep 8
    s_sub_u32 s79, s79, 1
    s_cmp_lg_u32 s79, 0
    s_cbranch_scc1 L_fchkk2
L_fokk2:
    v_mov_b32 v149, 1
    buffer_store_dword v149, v151, s[44:47], s22 offen sc1
L_nfk2:
    s_cmp_gt_u32 s4, 19
    s_cbranch_scc1 L_sk13
    s_cmp_gt_u32 s4, 3
    s_cbranch_scc1 L_sk13m
    s_waitcnt vmcnt(3)
L_sk13m:
    s_waitcnt vmcnt(4)
L_sk13:
    v_xor_b32 v45, s80, v2
    buffer_load_dwordx4 v[76:79], v45, s[28:31], 0 offen nt
    s_add_u32 s100, s100, 1
    v_readlane_b32 s101, v61, s100
    s_mov_b32 s80, s101
    v_add_u32 v159, 1, v159
    ds_write_b32 v160, v159 offset:21252
    v_add_f32_dpp v34, v34, v34 row_ror:8 row_mask:0xf bank_mask:0x3
    s_nop 1
    v_add_f32_dpp v34, v35, v35 row_ror:8 row_mask:0xf bank_mask:0xc
    s_waitcnt vmcnt(6)
    v_dot2_f32_bf16 v37, v116, v8, 0
    v_dot2_f32_bf16 v37, v117, v9, v37
    v_dot2_f32_bf16 v37, v118, v10, v37
    v_dot2_f32_bf16 v37, v119, v11, v37
    s_cmp_lt_u32 s83, 40
    s_cselect_b32 s23, s17, 160
    s_add_u32 s83, s83, 1
    s_set_gpr_idx_on s23, gpr_idx(DST)
    v_accvgpr_write_b32 a0, v140
    v_accvgpr_write_b32 a1, v141
    v_accvgpr_write_b32 a2, v142
    v_accvgpr_write_b32 a3, v143
    s_set_gpr_idx_off
    s_add_u32 s17, s17, 4
    s_cmp_eq_u32 s17, 160
    s_cselect_b32 s17, 0, s17
    s_waitcnt lgkmcnt(0)
    s_sub_u32 s79, s94, s99
    s_sub_u32 s79, s79, s98
    s_add_u32 s79, s79, s38
    s_sub_u32 s79, s79, 161
    s_and_b32 s79, s79, s97
    s_mul_i32 s79, s79, 3
    s_ashr_i32 s79, s79, 3
    s_add_u32 s79, s79, 46
    s_max_i32 s79, s79, 0
    s_min_i32 s79, s79, 64
    v_mov_b32 v157, s79
    ds_write_b32 v160, v157 offset:21248
    s_lshr_b32 s4, s79, 1
    s_cmp_gt_u32 s4, 27
    s_cbranch_scc1 L_sk14
    s_cmp_gt_u32 s4, 11
    s_cbranch_scc1 L_sk14m
    s_waitcnt vmcnt(3)
L_sk14m:
    s_waitcnt vmcnt(4)
L_sk14:
    v_xor_b32 v45, s80, v2
    buffer_load_dwordx4 v[80:83], v45, s[28:31], 0 offen nt
    s_xor_b32 s80, s101, 0x10100
    v_add_u32 v159, 1, v159
    ds_write_b32 v160, v159 offset:21252
    v_add_f32_dpp v32, v32, v32 row_shl:4 row_mask:0xf bank_mask:0x5
    s_nop 1
    v_add_f32_dpp v32, v34, v34 row_shr:4 row_mask:0xf bank_mask:0xa
    s_waitcnt vmcnt(6)
    v_dot2_f32_bf16 v38, v120, v8, 0
    v_dot2_f32_bf16 v38, v121, v9, v38
    v_dot2_f32_bf16 v38, v122, v10, v38
    v_dot2_f32_bf16 v38, v123, v11, v38
    s_mov_b32 m0, s72
    s_nop 0
    v_readlane_b32 s7, v155, m0
    s_nop 1
    v_sub_u32 v157, s7, v155
    v_cmp_eq_u32 vcc, -1, v155
    v_max_i32 v157, -200, v157
    v_min_i32 v157, 200, v157
    v_cndmask_b32 v157, v157, v160, vcc
    s_nop 1
    v_add_u32_dpp v157, v157, v157 quad_perm:[1,0,3,2] row_mask:0xf bank_mask:0xf
    s_nop 1
    v_add_u32_dpp v157, v157, v157 quad_perm:[2,3,0,1] row_mask:0xf bank_mask:0xf
    s_nop 1
    v_add_u32_dpp v157, v157, v157 row_half_mirror row_mask:0xf bank_mask:0xf
    s_nop 0
    v_readfirstlane_b32 s79, v157
    s_cmp_eq_u32 s7, -1
    s_nop 2
    s_cbranch_scc1 L_nog15
    s_ashr_i32 s79, s79, 3
    s_sub_u32 s7, s7, s79
    s_sub_u32 s79, s7, s36
    s_ashr_i32 s23, s39, 2
    s_sub_u32 s79, s79, s23
    s_max_i32 s79, s79, -6
    s_min_i32 s79, s79, 6
    s_cmp_eq_u32 s36, -1
    s_cselect_b32 s79, 0, s79
    s_mov_b32 s36, s7
    s_add_u32 s39, s39, s79
    s_max_i32 s39, s39, -64
    s_min_i32 s39, s39, 64
    s_mul_i32 s79, s39, 3
    s_ashr_i32 s79, s79, 2
    s_add_u32 s7, s7, s79
    v_mov_b32 v158, s7
L_nog15:
    s_memrealtime s[94:95]
    s_cmp_gt_u32 s4, 23
    s_cbranch_scc1 L_sk16
    s_cmp_gt_u32 s4, 7
    s_cbranch_scc1 L_sk16m
    s_waitcnt vmcnt(3)
L_sk16m:
    s_waitcnt vmcnt(4)
L_sk16:
    v_xor_b32 v45, s80, v2
    buffer_load_dwordx4 v[84:87], v45, s[28:31], 0 offen nt
    s_xor_b32 s80, s101, 0x800
    v_add_u32 v159, 1, v159
    ds_write_b32 v160, v159 offset:21252
    v_add_f32_dpp v36, v36, v36 row_ror:8 row_mask:0xf bank_mask:0x3
    s_nop 1
    v_add_f32_dpp v36, v37, v37 row_ror:8 row_mask:0xf bank_mask:0xc
    s_waitcnt vmcnt(6)
    v_dot2_f32_bf16 v39, v124, v8, 0
    v_dot2_f32_bf16 v39, v125, v9, v39
    v_dot2_f32_bf16 v39, v126, v10, v39
    v_dot2_f32_bf16 v39, v127, v11, v39
    s_waitcnt lgkmcnt(0)
    s_sub_u32 s79, s94, s99
    s_sub_u32 s79, s79, s98
    s_add_u32 s79, s79, s38
    s_sub_u32 s79, s79, 188
    s_and_b32 s79, s79, s97
    s_mul_i32 s79, s79, 3
    s_ashr_i32 s79, s79, 3
    s_add_u32 s79, s79, 46
    s_max_i32 s79, s79, 0
    s_min_i32 s79, s79, 64
    v_mov_b32 v157, s79
    ds_write_b32 v160, v157 offset:21248
    s_add_u32 s79, s79, 1
    s_lshr_b32 s4, s79, 1
    s_cmp_gt_u32 s4, 31
    s_cbranch_scc1 L_sk17
    s_cmp_gt_u32 s4, 15
    s_cbranch_scc1 L_sk17m
    s_waitcnt vmcnt(3)
L_sk17m:
    s_waitcnt vmcnt(4)
L_sk17:
    v_xor_b32 v45, s80, v2
    buffer_load_dwordx4 v[88:91], v45, s[28:31], 0 offen nt
    s_xor_b32 s80, s101, 0x10900
    v_add_u32 v159, 1, v159
    ds_write_b32 v160, v159 offset:21252
    s_add_u32 s77, s77, 1
    s_add_u32 s81, s81, 1
    s_cmp_lt_u32 s81, 16
    s_cbranch_scc1 L_lpk2
    s_branch L_kend
L_k1:
L_lpk1:
    s_waitcnt vmcnt(6)
    v_dot2_f32_bf16 v24, v64, v8, 0
    v_dot2_f32_bf16 v24, v65, v9, v24
    v_dot2_f32_bf16 v24, v66, v10, v24
    v_dot2_f32_bf16 v24, v67, v11, v24
    s_mul_i32 s99, s77, 215
    s_memrealtime s[94:95]
    s_add_u32 s23, s14, s15
    s_and_b32 s23, s23, 31
    s_mul_i32 s23, s23, 5120
    s_cmp_lt_u32 s14, 32
    s_cselect_b32 s7, 0, s21
    s_add_u32 s23, s23, s7
    s_cmp_lt_u32 s82, 40
    s_cselect_b32 s23, s23, 2130706432
    s_add_u32 s82, s82, 1
    buffer_load_dwordx4 v[128:131], v60, s[40:43], s23 offen
    s_add_u32 s14, s14, 1
    s_cmp_eq_u32 s14, 40
    s_cselect_b32 s14, 0, s14
    s_cmp_gt_u32 s4, 16
    s_cbranch_scc1 L_sk18
    s_cmp_gt_u32 s4, 0
    s_cbranch_scc1 L_sk18m
    s_waitcnt vmcnt(4)
L_sk18m:
    s_waitcnt vmcnt(5)
L_sk18:
    v_xor_b32 v45, s80, v2
    buffer_load_dwordx4 v[92:95], v45, s[28:31], 0 offen nt
    s_add_u32 s100, s100, 1
    v_readlane_b32 s101, v61, s100
    s_mov_b32 s80, s101
    v_add_u32 v159, 1, v159
    ds_write_b32 v160, v159 offset:21252
    v_add_f32_dpp v38, v38, v38 row_ror:8 row_mask:0xf bank_mask:0x3
    s_nop 1
    v_add_f32_dpp v38, v39, v39 row_ror:8 row_mask:0xf bank_mask:0xc
    s_waitcnt vmcnt(7)
    v_dot2_f32_bf16 v25, v68, v8, 0
    v_dot2_f32_bf16 v25, v69, v9, v25
    v_dot2_f32_bf16 v25, v70, v10, v25
    v_dot2_f32_bf16 v25, v71, v11, v25
    s_waitcnt lgkmcnt(0)
    s_sub_u32 s79, s94, s99
    s_mov_b32 s96, s79
    v_mov_b32 v153, s79
    buffer_store_dword v153, v151, s[44:47], s25 offen
    s_sub_u32 s79, s79, s98
    s_add_u32 s79, s79, s38
    s_and_b32 s79, s79, s97
    s_mul_i32 s79, s79, 3
    s_ashr_i32 s79, s79, 3
    s_add_u32 s79, s79, 46
    s_max_i32 s79, s79, 0
    s_min_i32 s79, s79, 64
    v_mov_b32 v157, s79
    ds_write_b32 v160, v157 offset:21248
    s_lshr_b32 s4, s79, 1
    s_cmp_gt_u32 s4, 24
    s_cbranch_scc1 L_sk19
    s_cmp_gt_u32 s4, 8
    s_cbranch_scc1 L_sk19m
    s_waitcnt vmcnt(5)
L_sk19m:
    s_waitcnt vmcnt(6)
L_sk19:
    v_xor_b32 v45, s80, v2
    buffer_load_dwordx4 v[96:99], v45, s[28:31], 0 offen nt
    s_xor_b32 s80, s101, 0x10100
    v_add_u32 v159, 1, v159
    ds_write_b32 v160, v159 offset:21252
    v_add_f32_dpp v36, v36, v36 row_shl:4 row_mask:0xf bank_mask:0x5
    s_nop 1
    v_add_f32_dpp v36, v38, v38 row_shr:4 row_mask:0xf bank_mask:0xa
    s_waitcnt vmcnt(8)
    v_dot2_f32_bf16 v26, v72, v8, 0
    v_dot2_f32_bf16 v26, v73, v9, v26
    v_dot2_f32_bf16 v26, v74, v10, v26
    v_dot2_f32_bf16 v26, v75, v11, v26
    s_memrealtime s[94:95]
    s_add_u32 s23, s14, s15
    s_and_b32 s23, s23, 31
    s_mul_i32 s23, s23, 5120
    s_cmp_lt_u32 s14, 32
    s_cselect_b32 s7, 0, s21
    s_add_u32 s23, s23, s7
    s_cmp_lt_u32 s82, 40
    s_cselect_b32 s23, s23, 2130706432
    s_add_u32 s82, s82, 1
    buffer_load_dwordx4 v[132:135], v60, s[40:43], s23 offen
    s_add_u32 s14, s14, 1
    s_cmp_eq_u32 s14, 40
    s_cselect_b32 s14, 0, s14
    s_cmp_gt_u32 s4, 20
    s_cbranch_scc1 L_sk20
    s_cmp_gt_u32 s4, 4
    s_cbranch_scc1 L_sk20m
    s_waitcnt vmcnt(6)
L_sk20m:
    s_waitcnt vmcnt(7)
L_sk20:
    v_xor_b32 v45, s80, v2
    buffer_load_dwordx4 v[100:103], v45, s[28:31], 0 offen nt
    s_xor_b32 s80, s101, 0x800
    v_add_u32 v159, 1, v159
    ds_write_b32 v160, v159 offset:21252
    v_add_f32_dpp v24, v24, v24 row_ror:8 row_mask:0xf bank_mask:0x3
    s_nop 1
    v_add_f32_dpp v24, v25, v25 row_ror:8 row_mask:0xf bank_mask:0xc
    v_cndmask_b32 v42, v32, v36, s[10:11]
    v_cndmask_b32 v43, v36, v32, s[10:11]
    s_nop 1
    v_add_f32_dpp v41, v43, v42 quad_perm:[2,3,0,1] row_mask:0xf bank_mask:0xf
    s_waitcnt vmcnt(9)
    v_dot2_f32_bf16 v27, v76, v8, 0
    v_dot2_f32_bf16 v27, v77, v9, v27
    v_dot2_f32_bf16 v27, v78, v10, v27
    v_dot2_f32_bf16 v27, v79, v11, v27
    s_waitcnt lgkmcnt(0)
    s_sub_u32 s79, s94, s99
    s_sub_u32 s79, s79, s98
    s_add_u32 s79, s79, s38
    s_sub_u32 s79, s79, 26
    s_and_b32 s79, s79, s97
    s_mul_i32 s79, s79, 3
    s_ashr_i32 s79, s79, 3
    s_add_u32 s79, s79, 46
    s_max_i32 s79, s79, 0
    s_min_i32 s79, s79, 64
    v_mov_b32 v157, s79
    ds_write_b32 v160, v157 offset:21248
    s_add_u32 s79, s79, 1
    s_lshr_b32 s4, s79, 1
    s_cmp_gt_u32 s4, 28
    s_cbranch_scc1 L_sk21
    s_cmp_gt_u32 s4, 12
    s_cbranch_scc1 L_sk21m
    s_waitcnt vmcnt(6)
L_sk21m:
    s_waitcnt vmcnt(7)
L_sk21:
    v_xor_b32 v45, s80, v2
    buffer_load_dwordx4 v[104:107], v45, s[28:31], 0 offen nt
    s_xor_b32 s80, s101, 0x10900
    v_add_u32 v159, 1, v159
    ds_write_b32 v160, v159 offset:21252
    v_cndmask_b32 v42, v40, v41, s[12:13]
    v_cndmask_b32 v43, v41, v40, s[12:13]
    s_nop 1
    v_add_f32_dpp v42, v43, v42 quad_perm:[1,0,3,2] row_mask:0xf bank_mask:0xf
    s_waitcnt vmcnt(9)
    v_dot2_f32_bf16 v28, v80, v8, 0
    v_dot2_f32_bf16 v28, v81, v9, v28
    v_dot2_f32_bf16 v28, v82, v10, v28
    v_dot2_f32_bf16 v28, v83, v11, v28
    buffer_load_dword v154, v150, s[44:47], s24 offen sc1
    s_memrealtime s[94:95]
    s_add_u32 s23, s14, s15
    s_and_b32 s23, s23, 31
    s_mul_i32 s23, s23, 5120
    s_cmp_lt_u32 s14, 32
    s_cselect_b32 s7, 0, s21
    s_add_u32 s23, s23, s7
    s_cmp_lt_u32 s82, 40
    s_cselect_b32 s23, s23, 2130706432
    s_add_u32 s82, s82, 1
    buffer_load_dwordx4 v[136:139], v60, s[40:43], s23 offen
    s_add_u32 s14, s14, 1
    s_cmp_eq_u32 s14, 40
    s_cselect_b32 s14, 0, s14
    s_cmp_gt_u32 s4, 18
    s_cbranch_scc1 L_sk22
    s_cmp_gt_u32 s4, 2
    s_cbranch_scc1 L_sk22m
    s_waitcnt vmcnt(7)
L_sk22m:
    s_waitcnt vmcnt(9)
L_sk22:
    v_xor_b32 v45, s80, v2
    buffer_load_dwordx4 v[108:111], v45, s[28:31], 0 offen nt
    s_add_u32 s100, s100, 1
    v_readlane_b32 s101, v61, s100
    s_mov_b32 s80, s101
    v_add_u32 v159, 1, v159
    ds_write_b32 v160, v159 offset:21252
    v_add_f32_dpp v26, v26, v26 row_ror:8 row_mask:0xf bank_mask:0x3
    s_nop 1
    v_add_f32_dpp v26, v27, v27 row_ror:8 row_mask:0xf bank_mask:0xc
    v_cvt_pk_bf16_f32 v43, v42, v42
    v_lshlrev_b32 v42, 16, v43
    v_mul_f32 v42, s16, v42
    v_cvt_pk_bf16_f32 v43, v42, v42
    v_lshlrev_b32 v42, 16, v43
    ds_write_b32 v44, v42
    v_add_u32 v44, 256, v44
    s_waitcnt vmcnt(11)
    v_dot2_f32_bf16 v29, v84, v8, 0
    v_dot2_f32_bf16 v29, v85, v9, v29
    v_dot2_f32_bf16 v29, v86, v10, v29
    v_dot2_f32_bf16 v29, v87, v11, v29
    s_waitcnt lgkmcnt(0)
    s_sub_u32 s79, s94, s99
    s_sub_u32 s79, s79, s98
    s_add_u32 s79, s79, s38
    s_sub_u32 s79, s79, 53
    s_and_b32 s79, s79, s97
    s_mul_i32 s79, s79, 3
    s_ashr_i32 s79, s79, 3
    s_add_u32 s79, s79, 46
    s_max_i32 s79, s79, 0
    s_min_i32 s79, s79, 64
    v_mov_b32 v157, s79
    ds_write_b32 v160, v157 offset:21248
    s_lshr_b32 s4, s79, 1
    s_cmp_gt_u32 s4, 26
    s_cbranch_scc1 L_sk23
    s_cmp_gt_u32 s4, 10
    s_cbranch_scc1 L_sk23m
    s_waitcnt vmcnt(6)
L_sk23m:
    s_waitcnt vmcnt(8)
L_sk23:
    v_xor_b32 v45, s80, v2
    buffer_load_dwordx4 v[112:115], v45, s[28:31], 0 offen nt
    s_xor_b32 s80, s101, 0x10100
    v_add_u32 v159, 1, v159
    ds_write_b32 v160, v159 offset:21252
    v_add_f32_dpp v24, v24, v24 row_shl:4 row_mask:0xf bank_mask:0x5
    s_nop 1
    v_add_f32_dpp v24, v26, v26 row_shr:4 row_mask:0xf bank_mask:0xa
    s_waitcnt vmcnt(11)
    v_dot2_f32_bf16 v30, v88, v8, 0
    v_dot2_f32_bf16 v30, v89, v9, v30
    v_dot2_f32_bf16 v30, v90, v10, v30
    v_dot2_f32_bf16 v30, v91, v11, v30
    s_memrealtime s[94:95]
    s_add_u32 s23, s14, s15
    s_and_b32 s23, s23, 31
    s_mul_i32 s23, s23, 5120
    s_cmp_lt_u32 s14, 32
    s_cselect_b32 s7, 0, s21
    s_add_u32 s23, s23, s7
    s_cmp_lt_u32 s82, 40
    s_cselect_b32 s23, s23, 2130706432
    s_add_u32 s82, s82, 1
    buffer_load_dwordx4 v[140:143], v60, s[40:43], s23 offen
    s_add_u32 s14, s14, 1
    s_cmp_eq_u32 s14, 40
    s_cselect_b32 s14, 0, s14
    s_cmp_gt_u32 s4, 22
    s_cbranch_scc1 L_sk24
    s_cmp_gt_u32 s4, 6
    s_cbranch_scc1 L_sk24m
    s_waitcnt vmcnt(6)
L_sk24m:
    s_waitcnt vmcnt(8)
L_sk24:
    v_xor_b32 v45, s80, v2
    buffer_load_dwordx4 v[116:119], v45, s[28:31], 0 offen nt
    s_xor_b32 s80, s101, 0x800
    v_add_u32 v159, 1, v159
    ds_write_b32 v160, v159 offset:21252
    v_add_f32_dpp v28, v28, v28 row_ror:8 row_mask:0xf bank_mask:0x3
    s_nop 1
    v_add_f32_dpp v28, v29, v29 row_ror:8 row_mask:0xf bank_mask:0xc
    s_waitcnt vmcnt(11)
    v_dot2_f32_bf16 v31, v92, v8, 0
    v_dot2_f32_bf16 v31, v93, v9, v31
    v_dot2_f32_bf16 v31, v94, v10, v31
    v_dot2_f32_bf16 v31, v95, v11, v31
    s_cmp_lt_u32 s83, 40
    s_cselect_b32 s23, s17, 160
    s_add_u32 s83, s83, 1
    s_set_gpr_idx_on s23, gpr_idx(DST)
    v_accvgpr_write_b32 a0, v128
    v_accvgpr_write_b32 a1, v129
    v_accvgpr_write_b32 a2, v130
    v_accvgpr_write_b32 a3, v131
    s_set_gpr_idx_off
    s_add_u32 s17, s17, 4
    s_cmp_eq_u32 s17, 160
    s_cselect_b32 s17, 0, s17
    s_waitcnt lgkmcnt(0)
    s_sub_u32 s79, s94, s99
    s_sub_u32 s79, s79, s98
    s_add_u32 s79, s79, s38
    s_sub_u32 s79, s79, 80
    s_and_b32 s79, s79, s97
    s_mul_i32 s79, s79, 3
    s_ashr_i32 s79, s79, 3
    s_add_u32 s79, s79, 46
    s_max_i32 s79, s79, 0
    s_min_i32 s79, s79, 64
    v_mov_b32 v157, s79
    ds_write_b32 v160, v157 offset:21248
    s_add_u32 s79, s79, 1
    s_lshr_b32 s4, s79, 1
    s_cmp_gt_u32 s4, 30
    s_cbranch_scc1 L_sk25
    s_cmp_gt_u32 s4, 14
    s_cbranch_scc1 L_sk25m
    s_waitcnt vmcnt(6)
L_sk25m:
    s_waitcnt vmcnt(7)
L_sk25:
    v_xor_b32 v45, s80, v2
    buffer_load_dwordx4 v[120:123], v45, s[28:31], 0 offen nt
    s_xor_b32 s80, s101, 0x10900
    v_add_u32 v159, 1, v159
    ds_write_b32 v160, v159 offset:21252
    s_waitcnt vmcnt(10)
    v_dot2_f32_bf16 v32, v96, v8, 0
    v_dot2_f32_bf16 v32, v97, v9, v32
    v_dot2_f32_bf16 v32, v98, v10, v32
    v_dot2_f32_bf16 v32, v99, v11, v32
    s_memrealtime s[94:95]
    s_cmp_gt_u32 s4, 17
    s_cbranch_scc1 L_sk26
    s_cmp_gt_u32 s4, 1
    s_cbranch_scc1 L_sk26m
    s_waitcnt vmcnt(4)
L_sk26m:
    s_waitcnt vmcnt(7)
L_sk26:
    v_xor_b32 v45, s80, v2
    buffer_load_dwordx4 v[124:127], v45, s[28:31], 0 offen nt
    s_add_u32 s100, s100, 1
    v_readlane_b32 s101, v61, s100
    s_mov_b32 s80, s101
    v_add_u32 v159, 1, v159
    ds_write_b32 v160, v159 offset:21252
    v_add_f32_dpp v30, v30, v30 row_ror:8 row_mask:0xf bank_mask:0x3
    s_nop 1
    v_add_f32_dpp v30, v31, v31 row_ror:8 row_mask:0xf bank_mask:0xc
    s_waitcnt vmcnt(9)
    v_dot2_f32_bf16 v33, v100, v8, 0
    v_dot2_f32_bf16 v33, v101, v9, v33
    v_dot2_f32_bf16 v33, v102, v10, v33
    v_dot2_f32_bf16 v33, v103, v11, v33
    s_cmp_lt_u32 s83, 40
    s_cselect_b32 s23, s17, 160
    s_add_u32 s83, s83, 1
    s_set_gpr_idx_on s23, gpr_idx(DST)
    v_accvgpr_write_b32 a0, v132
    v_accvgpr_write_b32 a1, v133
    v_accvgpr_write_b32 a2, v134
    v_accvgpr_write_b32 a3, v135
    s_set_gpr_idx_off
    s_add_u32 s17, s17, 4
    s_cmp_eq_u32 s17, 160
    s_cselect_b32 s17, 0, s17
    s_waitcnt lgkmcnt(0)
    s_sub_u32 s79, s94, s99
    s_sub_u32 s79, s79, s98
    s_add_u32 s79, s79, s38
    s_sub_u32 s79, s79, 107
    s_and_b32 s79, s79, s97
    s_mul_i32 s79, s79, 3
    s_ashr_i32 s79, s79, 3
    s_add_u32 s79, s79, 46
    s_max_i32 s79, s79, 0
    s_min_i32 s79, s79, 64
    v_mov_b32 v157, s79
    ds_write_b32 v160, v157 offset:21248
    s_lshr_b32 s4, s79, 1
    s_cmp_lg_u32 s81, 15
    s_cbranch_scc1 L_noswk1
    s_mov_b32 s28, s8
    s_mov_b32 s29, s9
    s_mov_b32 s100, 0
    v_readlane_b32 s101, v61, 0
    s_mov_b32 s80, s101
L_noswk1:
    s_cmp_gt_u32 s4, 25
    s_cbranch_scc1 L_sk27
    s_cmp_gt_u32 s4, 9
    s_cbranch_scc1 L_sk27m
    s_waitcnt vmcnt(4)
L_sk27m:
    s_waitcnt vmcnt(5)
L_sk27:
    v_xor_b32 v45, s80, v2
    buffer_load_dwordx4 v[64:67], v45, s[28:31], 0 offen nt
    s_xor_b32 s80, s101, 0x10100
    v_add_u32 v159, 1, v159
    ds_write_b32 v160, v159 offset:21252
    v_add_f32_dpp v28, v28, v28 row_shl:4 row_mask:0xf bank_mask:0x5
    s_nop 1
    v_add_f32_dpp v28, v30, v30 row_shr:4 row_mask:0xf bank_mask:0xa
    s_waitcnt vmcnt(9)
    v_dot2_f32_bf16 v34, v104, v8, 0
    v_dot2_f32_bf16 v34, v105, v9, v34
    v_dot2_f32_bf16 v34, v106, v10, v34
    v_dot2_f32_bf16 v34, v107, v11, v34
    s_memrealtime s[94:95]
    s_cmp_gt_u32 s4, 21
    s_cbranch_scc1 L_sk28
    s_cmp_gt_u32 s4, 5
    s_cbranch_scc1 L_sk28m
    s_waitcnt vmcnt(3)
L_sk28m:
    s_waitcnt vmcnt(5)
L_sk28:
    v_xor_b32 v45, s80, v2
    buffer_load_dwordx4 v[68:71], v45, s[28:31], 0 offen nt
    s_xor_b32 s80, s101, 0x800
    v_add_u32 v159, 1, v159
    ds_write_b32 v160, v159 offset:21252
    v_add_f32_dpp v32, v32, v32 row_ror:8 row_mask:0xf bank_mask:0x3
    s_nop 1
    v_add_f32_dpp v32, v33, v33 row_ror:8 row_mask:0xf bank_mask:0xc
    v_cndmask_b32 v42, v24, v28, s[10:11]
    v_cndmask_b32 v43, v28, v24, s[10:11]
    s_nop 1
    v_add_f32_dpp v40, v43, v42 quad_perm:[2,3,0,1] row_mask:0xf bank_mask:0xf
    s_waitcnt vmcnt(7)
    v_dot2_f32_bf16 v35, v108, v8, 0
    v_dot2_f32_bf16 v35, v109, v9, v35
    v_dot2_f32_bf16 v35, v110, v10, v35
    v_dot2_f32_bf16 v35, v111, v11, v35
    s_cmp_lt_u32 s83, 40
    s_cselect_b32 s23, s17, 160
    s_add_u32 s83, s83, 1
    s_set_gpr_idx_on s23, gpr_idx(DST)
    v_accvgpr_write_b32 a0, v136
    v_accvgpr_write_b32 a1, v137
    v_accvgpr_write_b32 a2, v138
    v_accvgpr_write_b32 a3, v139
    s_set_gpr_idx_off
    s_add_u32 s17, s17, 4
    s_cmp_eq_u32 s17, 160
    s_cselect_b32 s17, 0, s17
    s_waitcnt lgkmcnt(0)
    s_sub_u32 s79, s94, s99
    s_sub_u32 s79, s79, s98
    s_add_u32 s79, s79, s38
    s_sub_u32 s79, s79, 134
    s_and_b32 s79, s79, s97
    s_mul_i32 s79, s79, 3
    s_ashr_i32 s79, s79, 3
    s_add_u32 s79, s79, 46
    s_max_i32 s79, s79, 0
    s_min_i32 s79, s79, 64
    v_mov_b32 v157, s79
    ds_write_b32 v160, v157 offset:21248
    s_add_u32 s79, s79, 1
    s_lshr_b32 s4, s79, 1
    s_cmp_gt_u32 s4, 29
    s_cbranch_scc1 L_sk29
    s_cmp_gt_u32 s4, 13
    s_cbranch_scc1 L_sk29m
    s_waitcnt vmcnt(3)
L_sk29m:
    s_waitcnt vmcnt(4)
L_sk29:
    v_xor_b32 v45, s80, v2
    buffer_load_dwordx4 v[72:75], v45, s[28:31], 0 offen nt
    s_xor_b32 s80, s101, 0x10900
    v_add_u32 v159, 1, v159
    ds_write_b32 v160, v159 offset:21252
    s_waitcnt vmcnt(7)
    v_dot2_f32_bf16 v36, v112, v8, 0
    v_dot2_f32_bf16 v36, v113, v9, v36
    v_dot2_f32_bf16 v36, v114, v10, v36
    v_dot2_f32_bf16 v36, v115, v11, v36
    v_readlane_b32 s7, v154, 32
    v_sub_u32 v157, s96, v154
    v_cmp_eq_u32 vcc, -1, v154
    v_max_i32 v157, -200, v157
    v_min_i32 v157, 200, v157
    v_cndmask_b32 v157, v157, v160, vcc
    s_nop 1
    v_add_u32_dpp v157, v157, v157 quad_perm:[1,0,3,2] row_mask:0xf bank_mask:0xf
    s_nop 1
    v_add_u32_dpp v157, v157, v157 quad_perm:[2,3,0,1] row_mask:0xf bank_mask:0xf
    s_nop 1
    v_add_u32_dpp v157, v157, v157 row_half_mirror row_mask:0xf bank_mask:0xf
    s_nop 1
    v_add_u32_dpp v157, v157, v157 row_mirror row_mask:0xf bank_mask:0xf
    s_nop 0
    v_readlane_b32 s79, v157, 0
    v_readlane_b32 s98, v157, 16
    s_add_u32 s79, s79, s98
    s_ashr_i32 s79, s79, 5
    s_sub_u32 s98, s96, s79
    s_mov_b32 s97, -1
    s_cmp_eq_u32 s7, -1
    s_cselect_b32 s98, s98, s7
    s_memrealtime s[94:95]
    s_and_b32 s7, s73, 7
    s_add_u32 s7, s7, 6
    s_cmp_lg_u32 s7, s81
    s_cbranch_scc1 L_nfk1
    s_mov_b32 s79, 0x8000
L_fchkk1:
    s_load_dword s7, s[68:69], 0 glc
    s_waitcnt lgkmcnt(0)
    s_cmp_lg_u32 s7, 0
    s_cbranch_scc1 L_fokk1
    s_sleep 8
    s_sub_u32 s79, s79, 1
    s_cmp_lg_u32 s79, 0
    s_cbranch_scc1 L_fchkk1
L_fokk1:
    v_mov_b32 v149, 1
    buffer_store_dword v149, v151, s[44:47], s22 offen sc1
L_nfk1:
    s_cmp_gt_u32 s4, 19
    s_cbranch_scc1 L_sk30
    s_cmp_gt_u32 s4, 3
    s_cbranch_scc1 L_sk30m
    s_waitcnt vmcnt(3)
L_sk30m:
    s_waitcnt vmcnt(4)
L_sk30:
    v_xor_b32 v45, s80, v2
    buffer_load_dwordx4 v[76:79], v45, s[28:31], 0 offen nt
    s_add_u32 s100, s100, 1
    v_readlane_b32 s101, v61, s100
    s_mov_b32 s80, s101
    v_add_u32 v159, 1, v159
    ds_write_b32 v160, v159 offset:21252
    v_add_f32_dpp v34, v34, v34 row_ror:8 row_mask:0xf bank_mask:0x3
    s_nop 1
    v_add_f32_dpp v34, v35, v35 row_ror:8 row_mask:0xf bank_mask:0xc
    s_waitcnt vmcnt(6)
    v_dot2_f32_bf16 v37, v116, v8, 0
    v_dot2_f32_bf16 v37, v117, v9, v37
    v_dot2_f32_bf16 v37, v118, v10, v37
    v_dot2_f32_bf16 v37, v119, v11, v37
    s_cmp_lt_u32 s83, 40
    s_cselect_b32 s23, s17, 160
    s_add_u32 s83, s83, 1
    s_set_gpr_idx_on s23, gpr_idx(DST)
    v_accvgpr_write_b32 a0, v140
    v_accvgpr_write_b32 a1, v141
    v_accvgpr_write_b32 a2, v142
    v_accvgpr_write_b32 a3, v143
    s_set_gpr_idx_off
    s_add_u32 s17, s17, 4
    s_cmp_eq_u32 s17, 160
    s_cselect_b32 s17, 0, s17
    s_waitcnt lgkmcnt(0)
    s_sub_u32 s79, s94, s99
    s_sub_u32 s79, s79, s98
    s_add_u32 s79, s79, s38
    s_sub_u32 s79, s79, 161
    s_and_b32 s79, s79, s97
    s_mul_i32 s79, s79, 3
    s_ashr_i32 s79, s79, 3
    s_add_u32 s79, s79, 46
    s_max_i32 s79, s79, 0
    s_min_i32 s79, s79, 64
    v_mov_b32 v157, s79
    ds_write_b32 v160, v157 offset:21248
    s_lshr_b32 s4, s79, 1
    s_cmp_gt_u32 s4, 27
    s_cbranch_scc1 L_sk31
    s_cmp_gt_u32 s4, 11
    s_cbranch_scc1 L_sk31m
    s_waitcnt vmcnt(3)
L_sk31m:
    s_waitcnt vmcnt(4)
L_sk31:
    v_xor_b32 v45, s80, v2
    buffer_load_dwordx4 v[80:83], v45, s[28:31], 0 offen nt
    s_xor_b32 s80, s101, 0x10100
    v_add_u32 v159, 1, v159
    ds_write_b32 v160, v159 offset:21252
    v_add_f32_dpp v32, v32, v32 row_shl:4 row_mask:0xf bank_mask:0x5
    s_nop 1
    v_add_f32_dpp v32, v34, v34 row_shr:4 row_mask:0xf bank_mask:0xa
    s_waitcnt vmcnt(6)
    v_dot2_f32_bf16 v38, v120, v8, 0
    v_dot2_f32_bf16 v38, v121, v9, v38
    v_dot2_f32_bf16 v38, v122, v10, v38
    v_dot2_f32_bf16 v38, v123, v11, v38
    s_memrealtime s[94:95]
    s_cmp_gt_u32 s4, 23
    s_cbranch_scc1 L_sk32
    s_cmp_gt_u32 s4, 7
    s_cbranch_scc1 L_sk32m
    s_waitcnt vmcnt(3)
L_sk32m:
    s_waitcnt vmcnt(4)
L_sk32:
    v_xor_b32 v45, s80, v2
    buffer_load_dwordx4 v[84:87], v45, s[28:31], 0 offen nt
    s_xor_b32 s80, s101, 0x800
    v_add_u32 v159, 1, v159
    ds_write_b32 v160, v159 offset:21252
    v_add_f32_dpp v36, v36, v36 row_ror:8 row_mask:0xf bank_mask:0x3
    s_nop 1
    v_add_f32_dpp v36, v37, v37 row_ror:8 row_mask:0xf bank_mask:0xc
    s_waitcnt vmcnt(6)
    v_dot2_f32_bf16 v39, v124, v8, 0
    v_dot2_f32_bf16 v39, v125, v9, v39
    v_dot2_f32_bf16 v39, v126, v10, v39
    v_dot2_f32_bf16 v39, v127, v11, v39
    s_waitcnt lgkmcnt(0)
    s_sub_u32 s79, s94, s99
    s_sub_u32 s79, s79, s98
    s_add_u32 s79, s79, s38
    s_sub_u32 s79, s79, 188
    s_and_b32 s79, s79, s97
    s_mul_i32 s79, s79, 3
    s_ashr_i32 s79, s79, 3
    s_add_u32 s79, s79, 46
    s_max_i32 s79, s79, 0
    s_min_i32 s79, s79, 64
    v_mov_b32 v157, s79
    ds_write_b32 v160, v157 offset:21248
    s_add_u32 s79, s79, 1
    s_lshr_b32 s4, s79, 1
    s_cmp_gt_u32 s4, 31
    s_cbranch_scc1 L_sk33
    s_cmp_gt_u32 s4, 15
    s_cbranch_scc1 L_sk33m
    s_waitcnt vmcnt(3)
L_sk33m:
    s_waitcnt vmcnt(4)
L_sk33:
    v_xor_b32 v45, s80, v2
    buffer_load_dwordx4 v[88:91], v45, s[28:31], 0 offen nt
    s_xor_b32 s80, s101, 0x10900
    v_add_u32 v159, 1, v159
    ds_write_b32 v160, v159 offset:21252
    s_add_u32 s77, s77, 1
    s_add_u32 s81, s81, 1
    s_cmp_lt_u32 s81, 16
    s_cbranch_scc1 L_lpk1
    s_branch L_kend
L_k0:
L_lpk0:
    s_waitcnt vmcnt(6)
    v_dot2_f32_bf16 v24, v64, v8, 0
    v_dot2_f32_bf16 v24, v65, v9, v24
    v_dot2_f32_bf16 v24, v66, v10, v24
    v_dot2_f32_bf16 v24, v67, v11, v24
    ds_read_b64 v[162:163], v160 offset:21248
    s_add_u32 s23, s14, s15
    s_and_b32 s23, s23, 31
    s_mul_i32 s23, s23, 5120
    s_cmp_lt_u32 s14, 32
    s_cselect_b32 s7, 0, s21
    s_add_u32 s23, s23, s7
    s_cmp_lt_u32 s82, 40
    s_cselect_b32 s23, s23, 2130706432
    s_add_u32 s82, s82, 1
    buffer_load_dwordx4 v[128:131], v60, s[40:43], s23 offen
    s_add_u32 s14, s14, 1
    s_cmp_eq_u32 s14, 40
    s_cselect_b32 s14, 0, s14
    s_cmp_gt_u32 s4, 16
    s_cbranch_scc1 L_sk34
    s_cmp_gt_u32 s4, 0
    s_cbranch_scc1 L_sk34m
    s_waitcnt vmcnt(4)
L_sk34m:
    s_waitcnt vmcnt(5)
L_sk34:
    v_xor_b32 v45, s80, v2
    buffer_load_dwordx4 v[92:95], v45, s[28:31], 0 offen nt
    s_add_u32 s100, s100, 1
    v_readlane_b32 s101, v61, s100
    s_mov_b32 s80, s101
    v_add_f32_dpp v38, v38, v38 row_ror:8 row_mask:0xf bank_mask:0x3
    s_nop 1
    v_add_f32_dpp v38, v39, v39 row_ror:8 row_mask:0xf bank_mask:0xc
    s_waitcnt vmcnt(7)
    v_dot2_f32_bf16 v25, v68, v8, 0
    v_dot2_f32_bf16 v25, v69, v9, v25
    v_dot2_f32_bf16 v25, v70, v10, v25
    v_dot2_f32_bf16 v25, v71, v11, v25
    s_waitcnt lgkmcnt(0)
    v_readfirstlane_b32 s4, v162
    v_readfirstlane_b32 s79, v163
    s_lshl_b32 s7, s77, 4
    s_sub_u32 s79, s79, s7
    s_mul_i32 s79, s79, 4
    s_add_u32 s4, s4, s79
    s_max_i32 s4, s4, 0
    s_min_i32 s4, s4, 64
    s_lshr_b32 s4, s4, 1
    s_cmp_gt_u32 s4, 24
    s_cbranch_scc1 L_sk35
    s_cmp_gt_u32 s4, 8
    s_cbranch_scc1 L_sk35m
    s_waitcnt vmcnt(4)
L_sk35m:
    s_waitcnt vmcnt(5)
L_sk35:
    v_xor_b32 v45, s80, v2
    buffer_load_dwordx4 v[96:99], v45, s[28:31], 0 offen nt
    s_xor_b32 s80, s101, 0x10100
    v_add_f32_dpp v36, v36, v36 row_shl:4 row_mask:0xf bank_mask:0x5
    s_nop 1
    v_add_f32_dpp v36, v38, v38 row_shr:4 row_mask:0xf bank_mask:0xa
    s_waitcnt vmcnt(7)
    v_dot2_f32_bf16 v26, v72, v8, 0
    v_dot2_f32_bf16 v26, v73, v9, v26
    v_dot2_f32_bf16 v26, v74, v10, v26
    v_dot2_f32_bf16 v26, v75, v11, v26
    ds_read_b64 v[162:163], v160 offset:21248
    s_add_u32 s23, s14, s15
    s_and_b32 s23, s23, 31
    s_mul_i32 s23, s23, 5120
    s_cmp_lt_u32 s14, 32
    s_cselect_b32 s7, 0, s21
    s_add_u32 s23, s23, s7
    s_cmp_lt_u32 s82, 40
    s_cselect_b32 s23, s23, 2130706432
    s_add_u32 s82, s82, 1
    buffer_load_dwordx4 v[132:135], v60, s[40:43], s23 offen
    s_add_u32 s14, s14, 1
    s_cmp_eq_u32 s14, 40
    s_cselect_b32 s14, 0, s14
    s_cmp_gt_u32 s4, 20
    s_cbranch_scc1 L_sk36
    s_cmp_gt_u32 s4, 4
    s_cbranch_scc1 L_sk36m
    s_waitcnt vmcnt(5)
L_sk36m:
    s_waitcnt vmcnt(6)
L_sk36:
    v_xor_b32 v45, s80, v2
    buffer_load_dwordx4 v[100:103], v45, s[28:31], 0 offen nt
    s_xor_b32 s80, s101, 0x800
    v_add_f32_dpp v24, v24, v24 row_ror:8 row_mask:0xf bank_mask:0x3
    s_nop 1
    v_add_f32_dpp v24, v25, v25 row_ror:8 row_mask:0xf bank_mask:0xc
    v_cndmask_b32 v42, v32, v36, s[10:11]
    v_cndmask_b32 v43, v36, v32, s[10:11]
    s_nop 1
    v_add_f32_dpp v41, v43, v42 quad_perm:[2,3,0,1] row_mask:0xf bank_mask:0xf
    s_waitcnt vmcnt(8)
    v_dot2_f32_bf16 v27, v76, v8, 0
    v_dot2_f32_bf16 v27, v77, v9, v27
    v_dot2_f32_bf16 v27, v78, v10, v27
    v_dot2_f32_bf16 v27, v79, v11, v27
    s_waitcnt lgkmcnt(0)
    v_readfirstlane_b32 s4, v162
    v_readfirstlane_b32 s79, v163
    s_lshl_b32 s7, s77, 4
    s_sub_u32 s79, s79, s7
    s_sub_u32 s79, s79, 2
    s_mul_i32 s79, s79, 4
    s_add_u32 s4, s4, s79
    s_max_i32 s4, s4, 0
    s_min_i32 s4, s4, 64
    s_add_u32 s4, s4, 1
    s_lshr_b32 s4, s4, 1
    s_cmp_gt_u32 s4, 28
    s_cbranch_scc1 L_sk37
    s_cmp_gt_u32 s4, 12
    s_cbranch_scc1 L_sk37m
    s_waitcnt vmcnt(5)
L_sk37m:
    s_waitcnt vmcnt(6)
L_sk37:
    v_xor_b32 v45, s80, v2
    buffer_load_dwordx4 v[104:107], v45, s[28:31], 0 offen nt
    s_xor_b32 s80, s101, 0x10900
    v_cndmask_b32 v42, v40, v41, s[12:13]
    v_cndmask_b32 v43, v41, v40, s[12:13]
    s_nop 1
    v_add_f32_dpp v42, v43, v42 quad_perm:[1,0,3,2] row_mask:0xf bank_mask:0xf
    s_waitcnt vmcnt(8)
    v_dot2_f32_bf16 v28, v80, v8, 0
    v_dot2_f32_bf16 v28, v81, v9, v28
    v_dot2_f32_bf16 v28, v82, v10, v28
    v_dot2_f32_bf16 v28, v83, v11, v28
    ds_read_b64 v[162:163], v160 offset:21248
    s_add_u32 s23, s14, s15
    s_and_b32 s23, s23, 31
    s_mul_i32 s23, s23, 5120
    s_cmp_lt_u32 s14, 32
    s_cselect_b32 s7, 0, s21
    s_add_u32 s23, s23, s7
    s_cmp_lt_u32 s82, 40
    s_cselect_b32 s23, s23, 2130706432
    s_add_u32 s82, s82, 1
    buffer_load_dwordx4 v[136:139], v60, s[40:43], s23 offen
    s_add_u32 s14, s14, 1
    s_cmp_eq_u32 s14, 40
    s_cselect_b32 s14, 0, s14
    s_cmp_gt_u32 s4, 18
    s_cbranch_scc1 L_sk38
    s_cmp_gt_u32 s4, 2
    s_cbranch_scc1 L_sk38m
    s_waitcnt vmcnt(5)
L_sk38m:
    s_waitcnt vmcnt(7)
L_sk38:
    v_xor_b32 v45, s80, v2
    buffer_load_dwordx4 v[108:111], v45, s[28:31], 0 offen nt
    s_add_u32 s100, s100, 1
    v_readlane_b32 s101, v61, s100
    s_mov_b32 s80, s101
    v_add_f32_dpp v26, v26, v26 row_ror:8 row_mask:0xf bank_mask:0x3
    s_nop 1
    v_add_f32_dpp v26, v27, v27 row_ror:8 row_mask:0xf bank_mask:0xc
    v_cvt_pk_bf16_f32 v43, v42, v42
    v_lshlrev_b32 v42, 16, v43
    v_mul_f32 v42, s16, v42
    v_cvt_pk_bf16_f32 v43, v42, v42
    v_lshlrev_b32 v42, 16, v43
    ds_write_b32 v44, v42
    v_add_u32 v44, 256, v44
    s_waitcnt vmcnt(9)
    v_dot2_f32_bf16 v29, v84, v8, 0
    v_dot2_f32_bf16 v29, v85, v9, v29
    v_dot2_f32_bf16 v29, v86, v10, v29
    v_dot2_f32_bf16 v29, v87, v11, v29
    s_waitcnt lgkmcnt(0)
    v_readfirstlane_b32 s4, v162
    v_readfirstlane_b32 s79, v163
    s_lshl_b32 s7, s77, 4
    s_sub_u32 s79, s79, s7
    s_sub_u32 s79, s79, 4
    s_mul_i32 s79, s79, 4
    s_add_u32 s4, s4, s79
    s_max_i32 s4, s4, 0
    s_min_i32 s4, s4, 64
    s_lshr_b32 s4, s4, 1
    s_cmp_gt_u32 s4, 26
    s_cbranch_scc1 L_sk39
    s_cmp_gt_u32 s4, 10
    s_cbranch_scc1 L_sk39m
    s_waitcnt vmcnt(5)
L_sk39m:
    s_waitcnt vmcnt(6)
L_sk39:
    v_xor_b32 v45, s80, v2
    buffer_load_dwordx4 v[112:115], v45, s[28:31], 0 offen nt
    s_xor_b32 s80, s101, 0x10100
    v_add_f32_dpp v24, v24, v24 row_shl:4 row_mask:0xf bank_mask:0x5
    s_nop 1
    v_add_f32_dpp v24, v26, v26 row_shr:4 row_mask:0xf bank_mask:0xa
    s_waitcnt vmcnt(9)
    v_dot2_f32_bf16 v30, v88, v8, 0
    v_dot2_f32_bf16 v30, v89, v9, v30
    v_dot2_f32_bf16 v30, v90, v10, v30
    v_dot2_f32_bf16 v30, v91, v11, v30
    ds_read_b64 v[162:163], v160 offset:21248
    s_add_u32 s23, s14, s15
    s_and_b32 s23, s23, 31
    s_mul_i32 s23, s23, 5120
    s_cmp_lt_u32 s14, 32
    s_cselect_b32 s7, 0, s21
    s_add_u32 s23, s23, s7
    s_cmp_lt_u32 s82, 40
    s_cselect_b32 s23, s23, 2130706432
    s_add_u32 s82, s82, 1
    buffer_load_dwordx4 v[140:143], v60, s[40:43], s23 offen
    s_add_u32 s14, s14, 1
    s_cmp_eq_u32 s14, 40
    s_cselect_b32 s14, 0, s14
    s_cmp_gt_u32 s4, 22
    s_cbranch_scc1 L_sk40
    s_cmp_gt_u32 s4, 6
    s_cbranch_scc1 L_sk40m
    s_waitcnt vmcnt(5)
L_sk40m:
    s_waitcnt vmcnt(7)
L_sk40:
    v_xor_b32 v45, s80, v2
    buffer_load_dwordx4 v[116:119], v45, s[28:31], 0 offen nt
    s_xor_b32 s80, s101, 0x800
    v_add_f32_dpp v28, v28, v28 row_ror:8 row_mask:0xf bank_mask:0x3
    s_nop 1
    v_add_f32_dpp v28, v29, v29 row_ror:8 row_mask:0xf bank_mask:0xc
    s_waitcnt vmcnt(9)
    v_dot2_f32_bf16 v31, v92, v8, 0
    v_dot2_f32_bf16 v31, v93, v9, v31
    v_dot2_f32_bf16 v31, v94, v10, v31
    v_dot2_f32_bf16 v31, v95, v11, v31
    s_cmp_lt_u32 s83, 40
    s_cselect_b32 s23, s17, 160
    s_add_u32 s83, s83, 1
    s_set_gpr_idx_on s23, gpr_idx(DST)
    v_accvgpr_write_b32 a0, v128
    v_accvgpr_write_b32 a1, v129
    v_accvgpr_write_b32 a2, v130
    v_accvgpr_write_b32 a3, v131
    s_set_gpr_idx_off
    s_add_u32 s17, s17, 4
    s_cmp_eq_u32 s17, 160
    s_cselect_b32 s17, 0, s17
    s_waitcnt lgkmcnt(0)
    v_readfirstlane_b32 s4, v162
    v_readfirstlane_b32 s79, v163
    s_lshl_b32 s7, s77, 4
    s_sub_u32 s79, s79, s7
    s_sub_u32 s79, s79, 6
    s_mul_i32 s79, s79, 4
    s_add_u32 s4, s4, s79
    s_max_i32 s4, s4, 0
    s_min_i32 s4, s4, 64
    s_add_u32 s4, s4, 1
    s_lshr_b32 s4, s4, 1
    s_cmp_gt_u32 s4, 30
    s_cbranch_scc1 L_sk41
    s_cmp_gt_u32 s4, 14
    s_cbranch_scc1 L_sk41m
    s_waitcnt vmcnt(5)
L_sk41m:
    s_waitcnt vmcnt(6)
L_sk41:
    v_xor_b32 v45, s80, v2
    buffer_load_dwordx4 v[120:123], v45, s[28:31], 0 offen nt
    s_xor_b32 s80, s101, 0x10900
    s_waitcnt vmcnt(9)
    v_dot2_f32_bf16 v32, v96, v8, 0
    v_dot2_f32_bf16 v32, v97, v9, v32
    v_dot2_f32_bf16 v32, v98, v10, v32
    v_dot2_f32_bf16 v32, v99, v11, v32
    ds_read_b64 v[162:163], v160 offset:21248
    s_cmp_gt_u32 s4, 17
    s_cbranch_scc1 L_sk42
    s_cmp_gt_u32 s4, 1
    s_cbranch_scc1 L_sk42m
    s_waitcnt vmcnt(4)
L_sk42m:
    s_waitcnt vmcnt(6)
L_sk42:
    v_xor_b32 v45, s80, v2
    buffer_load_dwordx4 v[124:127], v45, s[28:31], 0 offen nt
    s_add_u32 s100, s100, 1
    v_readlane_b32 s101, v61, s100
    s_mov_b32 s80, s101
    v_add_f32_dpp v30, v30, v30 row_ror:8 row_mask:0xf bank_mask:0x3
    s_nop 1
    v_add_f32_dpp v30, v31, v31 row_ror:8 row_mask:0xf bank_mask:0xc
    s_waitcnt vmcnt(8)
    v_dot2_f32_bf16 v33, v100, v8, 0
    v_dot2_f32_bf16 v33, v101, v9, v33
    v_dot2_f32_bf16 v33, v102, v10, v33
    v_dot2_f32_bf16 v33, v103, v11, v33
    s_cmp_lt_u32 s83, 40
    s_cselect_b32 s23, s17, 160
    s_add_u32 s83, s83, 1
    s_set_gpr_idx_on s23, gpr_idx(DST)
    v_accvgpr_write_b32 a0, v132
    v_accvgpr_write_b32 a1, v133
    v_accvgpr_write_b32 a2, v134
    v_accvgpr_write_b32 a3, v135
    s_set_gpr_idx_off
    s_add_u32 s17, s17, 4
    s_cmp_eq_u32 s17, 160
    s_cselect_b32 s17, 0, s17
    s_waitcnt lgkmcnt(0)
    v_readfirstlane_b32 s4, v162
    v_readfirstlane_b32 s79, v163
    s_lshl_b32 s7, s77, 4
    s_sub_u32 s79, s79, s7
    s_sub_u32 s79, s79, 8
    s_mul_i32 s79, s79, 4
    s_add_u32 s4, s4, s79
    s_max_i32 s4, s4, 0
    s_min_i32 s4, s4, 64
    s_lshr_b32 s4, s4, 1
    s_cmp_lg_u32 s81, 15
    s_cbranch_scc1 L_noswk0
    s_mov_b32 s28, s8
    s_mov_b32 s29, s9
    s_mov_b32 s100, 0
    v_readlane_b32 s101, v61, 0
    s_mov_b32 s80, s101
L_noswk0:
    s_cmp_gt_u32 s4, 25
    s_cbranch_scc1 L_sk43
    s_cmp_gt_u32 s4, 9
    s_cbranch_scc1 L_sk43m
    s_waitcnt vmcnt(4)
L_sk43m:
    s_waitcnt vmcnt(5)
L_sk43:
    v_xor_b32 v45, s80, v2
    buffer_load_dwordx4 v[64:67], v45, s[28:31], 0 offen nt
    s_xor_b32 s80, s101, 0x10100
    v_add_f32_dpp v28, v28, v28 row_shl:4 row_mask:0xf bank_mask:0x5
    s_nop 1
    v_add_f32_dpp v28, v30, v30 row_shr:4 row_mask:0xf bank_mask:0xa
    s_waitcnt vmcnt(8)
    v_dot2_f32_bf16 v34, v104, v8, 0
    v_dot2_f32_bf16 v34, v105, v9, v34
    v_dot2_f32_bf16 v34, v106, v10, v34
    v_dot2_f32_bf16 v34, v107, v11, v34
    ds_read_b64 v[162:163], v160 offset:21248
    s_cmp_gt_u32 s4, 21
    s_cbranch_scc1 L_sk44
    s_cmp_gt_u32 s4, 5
    s_cbranch_scc1 L_sk44m
    s_waitcnt vmcnt(3)
L_sk44m:
    s_waitcnt vmcnt(5)
L_sk44:
    v_xor_b32 v45, s80, v2
    buffer_load_dwordx4 v[68:71], v45, s[28:31], 0 offen nt
    s_xor_b32 s80, s101, 0x800
    v_add_f32_dpp v32, v32, v32 row_ror:8 row_mask:0xf bank_mask:0x3
    s_nop 1
    v_add_f32_dpp v32, v33, v33 row_ror:8 row_mask:0xf bank_mask:0xc
    v_cndmask_b32 v42, v24, v28, s[10:11]
    v_cndmask_b32 v43, v28, v24, s[10:11]
    s_nop 1
    v_add_f32_dpp v40, v43, v42 quad_perm:[2,3,0,1] row_mask:0xf bank_mask:0xf
    s_waitcnt vmcnt(7)
    v_dot2_f32_bf16 v35, v108, v8, 0
    v_dot2_f32_bf16 v35, v109, v9, v35
    v_dot2_f32_bf16 v35, v110, v10, v35
    v_dot2_f32_bf16 v35, v111, v11, v35
    s_cmp_lt_u32 s83, 40
    s_cselect_b32 s23, s17, 160
    s_add_u32 s83, s83, 1
    s_set_gpr_idx_on s23, gpr_idx(DST)
    v_accvgpr_write_b32 a0, v136
    v_accvgpr_write_b32 a1, v137
    v_accvgpr_write_b32 a2, v138
    v_accvgpr_write_b32 a3, v139
    s_set_gpr_idx_off
    s_add_u32 s17, s17, 4
    s_cmp_eq_u32 s17, 160
    s_cselect_b32 s17, 0, s17
    s_waitcnt lgkmcnt(0)
    v_readfirstlane_b32 s4, v162
    v_readfirstlane_b32 s79, v163
    s_lshl_b32 s7, s77, 4
    s_sub_u32 s79, s79, s7
    s_sub_u32 s79, s79, 10
    s_mul_i32 s79, s79, 4
    s_add_u32 s4, s4, s79
    s_max_i32 s4, s4, 0
    s_min_i32 s4, s4, 64
    s_add_u32 s4, s4, 1
    s_lshr_b32 s4, s4, 1
    s_cmp_gt_u32 s4, 29
    s_cbranch_scc1 L_sk45
    s_cmp_gt_u32 s4, 13
    s_cbranch_scc1 L_sk45m
    s_waitcnt vmcnt(3)
L_sk45m:
    s_waitcnt vmcnt(4)
L_sk45:
    v_xor_b32 v45, s80, v2
    buffer_load_dwordx4 v[72:75], v45, s[28:31], 0 offen nt
    s_xor_b32 s80, s101, 0x10900
    s_waitcnt vmcnt(7)
    v_dot2_f32_bf16 v36, v112, v8, 0
    v_dot2_f32_bf16 v36, v113, v9, v36
    v_dot2_f32_bf16 v36, v114, v10, v36
    v_dot2_f32_bf16 v36, v115, v11, v36
    ds_read_b64 v[162:163], v160 offset:21248
    s_cmp_gt_u32 s4, 19
    s_cbranch_scc1 L_sk46
    s_cmp_gt_u32 s4, 3
    s_cbranch_scc1 L_sk46m
    s_waitcnt vmcnt(3)
L_sk46m:
    s_waitcnt vmcnt(4)
L_sk46:
    v_xor_b32 v45, s80, v2
    buffer_load_dwordx4 v[76:79], v45, s[28:31], 0 offen nt
    s_add_u32 s100, s100, 1
    v_readlane_b32 s101, v61, s100
    s_mov_b32 s80, s101
    v_add_f32_dpp v34, v34, v34 row_ror:8 row_mask:0xf bank_mask:0x3
    s_nop 1
    v_add_f32_dpp v34, v35, v35 row_ror:8 row_mask:0xf bank_mask:0xc
    s_waitcnt vmcnt(6)
    v_dot2_f32_bf16 v37, v116, v8, 0
    v_dot2_f32_bf16 v37, v117, v9, v37
    v_dot2_f32_bf16 v37, v118, v10, v37
    v_dot2_f32_bf16 v37, v119, v11, v37
    s_cmp_lt_u32 s83, 40
    s_cselect_b32 s23, s17, 160
    s_add_u32 s83, s83, 1
    s_set_gpr_idx_on s23, gpr_idx(DST)
    v_accvgpr_write_b32 a0, v140
    v_accvgpr_write_b32 a1, v141
    v_accvgpr_write_b32 a2, v142
    v_accvgpr_write_b32 a3, v143
    s_set_gpr_idx_off
    s_add_u32 s17, s17, 4
    s_cmp_eq_u32 s17, 160
    s_cselect_b32 s17, 0, s17
    s_waitcnt lgkmcnt(0)
    v_readfirstlane_b32 s4, v162
    v_readfirstlane_b32 s79, v163
    s_lshl_b32 s7, s77, 4
    s_sub_u32 s79, s79, s7
    s_sub_u32 s79, s79, 12
    s_mul_i32 s79, s79, 4
    s_add_u32 s4, s4, s79
    s_max_i32 s4, s4, 0
    s_min_i32 s4, s4, 64
    s_lshr_b32 s4, s4, 1
    s_cmp_gt_u32 s4, 27
    s_cbranch_scc1 L_sk47
    s_cmp_gt_u32 s4, 11
    s_cbranch_scc1 L_sk47m
    s_waitcnt vmcnt(3)
L_sk47m:
    s_waitcnt vmcnt(4)
L_sk47:
    v_xor_b32 v45, s80, v2
    buffer_load_dwordx4 v[80:83], v45, s[28:31], 0 offen nt
    s_xor_b32 s80, s101, 0x10100
    v_add_f32_dpp v32, v32, v32 row_shl:4 row_mask:0xf bank_mask:0x5
    s_nop 1
    v_add_f32_dpp v32, v34, v34 row_shr:4 row_mask:0xf bank_mask:0xa
    s_waitcnt vmcnt(6)
    v_dot2_f32_bf16 v38, v120, v8, 0
    v_dot2_f32_bf16 v38, v121, v9, v38
    v_dot2_f32_bf16 v38, v122, v10, v38
    v_dot2_f32_bf16 v38, v123, v11, v38
    ds_read_b64 v[162:163], v160 offset:21248
    s_cmp_gt_u32 s4, 23
    s_cbranch_scc1 L_sk48
    s_cmp_gt_u32 s4, 7
    s_cbranch_scc1 L_sk48m
    s_waitcnt vmcnt(3)
L_sk48m:
    s_waitcnt vmcnt(4)
L_sk48:
    v_xor_b32 v45, s80, v2
    buffer_load_dwordx4 v[84:87], v45, s[28:31], 0 offen nt
    s_xor_b32 s80, s101, 0x800
    v_add_f32_dpp v36, v36, v36 row_ror:8 row_mask:0xf bank_mask:0x3
    s_nop 1
    v_add_f32_dpp v36, v37, v37 row_ror:8 row_mask:0xf bank_mask:0xc
    s_waitcnt vmcnt(6)
    v_dot2_f32_bf16 v39, v124, v8, 0
    v_dot2_f32_bf16 v39, v125, v9, v39
    v_dot2_f32_bf16 v39, v126, v10, v39
    v_dot2_f32_bf16 v39, v127, v11, v39
    s_waitcnt lgkmcnt(0)
    v_readfirstlane_b32 s4, v162
    v_readfirstlane_b32 s79, v163
    s_lshl_b32 s7, s77, 4
    s_sub_u32 s79, s79, s7
    s_sub_u32 s79, s79, 14
    s_mul_i32 s79, s79, 4
    s_add_u32 s4, s4, s79
    s_max_i32 s4, s4, 0
    s_min_i32 s4, s4, 64
    s_add_u32 s4, s4, 1
    s_lshr_b32 s4, s4, 1
    s_cmp_gt_u32 s4, 31
    s_cbranch_scc1 L_sk49
    s_cmp_gt_u32 s4, 15
    s_cbranch_scc1 L_sk49m
    s_waitcnt vmcnt(3)
L_sk49m:
    s_waitcnt vmcnt(4)
L_sk49:
    v_xor_b32 v45, s80, v2
    buffer_load_dwordx4 v[88:91], v45, s[28:31], 0 offen nt
    s_xor_b32 s80, s101, 0x10900
    s_add_u32 s77, s77, 1
    s_add_u32 s81, s81, 1
    s_cmp_lt_u32 s81, 16
    s_cbranch_scc1 L_lpk0
L_kend:
    v_add_f32_dpp v38, v38, v38 row_ror:8 row_mask:0xf bank_mask:0x3
    s_nop 1
    v_add_f32_dpp v38, v39, v39 row_ror:8 row_mask:0xf bank_mask:0xc
    v_add_f32_dpp v36, v36, v36 row_shl:4 row_mask:0xf bank_mask:0x5
    s_nop 1
    v_add_f32_dpp v36, v38, v38 row_shr:4 row_mask:0xf bank_mask:0xa
    v_cndmask_b32 v42, v32, v36, s[10:11]
    v_cndmask_b32 v43, v36, v32, s[10:11]
    s_nop 1
    v_add_f32_dpp v41, v43, v42 quad_perm:[2,3,0,1] row_mask:0xf bank_mask:0xf
    v_cndmask_b32 v42, v40, v41, s[12:13]
    v_cndmask_b32 v43, v41, v40, s[12:13]
    s_nop 1
    v_add_f32_dpp v42, v43, v42 quad_perm:[1,0,3,2] row_mask:0xf bank_mask:0xf
    v_cvt_pk_bf16_f32 v43, v42, v42
    v_lshlrev_b32 v42, 16, v43
    v_mul_f32 v42, s16, v42
    v_cvt_pk_bf16_f32 v43, v42, v42
    v_lshlrev_b32 v42, 16, v43
    ds_write_b32 v44, v42
    v_add_u32 v44, 256, v44
    v_and_b32 v56, 7, v1
    v_lshlrev_b32 v56, 3, v56
    buffer_load_dwordx2 v[62:63], v56, s[48:51], s20 offen
    v_subrev_u32 v44, 4096, v44
    s_waitcnt lgkmcnt(0)
    ds_read_b32 v24, v44 offset:0
    ds_read_b32 v25, v44 offset:256
    ds_read_b32 v26, v44 offset:512
    ds_read_b32 v27, v44 offset:768
    ds_read_b32 v28, v44 offset:1024
    ds_read_b32 v29, v44 offset:1280
    ds_read_b32 v30, v44 offset:1536
    ds_read_b32 v31, v44 offset:1792
    ds_read_b32 v32, v44 offset:2048
    ds_read_b32 v33, v44 offset:2304
    ds_read_b32 v34, v44 offset:2560
    ds_read_b32 v35, v44 offset:2816
    ds_read_b32 v36, v44 offset:3072
    ds_read_b32 v37, v44 offset:3328
    ds_read_b32 v38, v44 offset:3584
    ds_read_b32 v39, v44 offset:3840
    s_mov_b32 s17, 0x3fb8aa3b
    s_cmp_eq_u32 s19, 3
    s_cbranch_scc1 L_pdown
    v_lshrrev_b32 v56, 5, v1
    s_lshl_b32 s14, s3, 1
    v_add_u32 v56, s14, v56
    v_xor_b32 v56, v56, v1
    v_and_b32 v56, 3, v56
    v_lshrrev_b32 v57, 2, v1
    v_mul_u32_u24 v60, 3456, v57
    v_lshl_add_u32 v60, v56, 4, v60
    s_lshl_b32 s14, s18, 6
    v_add_u32 v60, s14, v60
    s_mul_i32 s60, s3, 55296
    s_mov_b32 s62, 221184
    s_lshl_b32 s63, s3, 10
    s_add_u32 s63, s63, 32768
    s_cmp_eq_u32 s19, 1
    s_cselect_b32 s78, 0, 0
    s_mov_b32 s37, s78
    s_mov_b32 s61, 4096
    s_branch L_pdone
L_pdown:
    v_lshrrev_b32 v60, 1, v1
    v_mul_u32_u24 v60, 1280, v60
    v_and_b32 v56, 1, v1
    v_lshl_add_u32 v60, v56, 4, v60
    s_lshl_b32 s14, s18, 5
    v_add_u32 v60, s14, v60
    s_mul_i32 s60, s3, 40960
    s_mov_b32 s62, 163840
    s_mul_i32 s63, s3, 14336
    s_add_u32 s63, s63, 32768
    s_mov_b32 s78, 0
    s_mov_b32 s37, 0
    s_mov_b32 s61, 1024
L_pdone:
    s_waitcnt lgkmcnt(0)
    v_max3_f32 v40, v24, v25, v26
    v_max3_f32 v40, v40, v27, v28
    v_max3_f32 v40, v40, v29, v30
    v_max3_f32 v40, v40, v31, v32
    v_max3_f32 v40, v40, v33, v34
    v_max3_f32 v40, v40, v35, v36
    v_max3_f32 v40, v40, v37, v38
    v_max_f32 v40, v40, v39
    s_nop 1
    v_max_f32_dpp v40, v40, v40 quad_perm:[1,0,3,2] row_mask:0xf bank_mask:0xf
    s_nop 1
    v_max_f32_dpp v40, v40, v40 quad_perm:[2,3,0,1] row_mask:0xf bank_mask:0xf
    s_nop 1
    v_max_f32_dpp v40, v40, v40 row_half_mirror row_mask:0xf bank_mask:0xf
    s_nop 1
    v_max_f32_dpp v40, v40, v40 row_ror:8 row_mask:0xf bank_mask:0xf
    v_mov_b32 v41, v40
    s_nop 1
    v_permlane16_swap_b32 v40, v41
    v_max_f32 v40, v40, v41
    v_mov_b32 v41, v40
    s_nop 1
    v_permlane32_swap_b32 v40, v41
    v_max_f32 v40, v40, v41
    v_sub_f32 v24, v24, v40
    v_xor_b32 v45, s80, v2
    buffer_load_dwordx4 v[92:95], v45, s[28:31], 0 offen nt
    s_add_u32 s100, s100, 1
    v_readlane_b32 s101, v61, s100
    s_mov_b32 s80, s101
    v_sub_f32 v25, v25, v40
    v_sub_f32 v26, v26, v40
    v_sub_f32 v27, v27, v40
    v_sub_f32 v28, v28, v40
    v_sub_f32 v29, v29, v40
    v_sub_f32 v30, v30, v40
    v_sub_f32 v31, v31, v40
    v_sub_f32 v32, v32, v40
    v_sub_f32 v33, v33, v40
    v_sub_f32 v34, v34, v40
    v_sub_f32 v35, v35, v40
    v_sub_f32 v36, v36, v40
    v_sub_f32 v37, v37, v40
    v_sub_f32 v38, v38, v40
    v_sub_f32 v39, v39, v40
    v_mul_f32 v24, s17, v24
    v_mul_f32 v25, s17, v25
    v_mul_f32 v26, s17, v26
    v_mul_f32 v27, s17, v27
    v_xor_b32 v45, s80, v2
    buffer_load_dwordx4 v[96:99], v45, s[28:31], 0 offen nt
    s_xor_b32 s80, s101, 0x10100
    v_mul_f32 v28, s17, v28
    v_mul_f32 v29, s17, v29
    v_mul_f32 v30, s17, v30
    v_mul_f32 v31, s17, v31
    v_mul_f32 v32, s17, v32
    v_mul_f32 v33, s17, v33
    v_mul_f32 v34, s17, v34
    v_mul_f32 v35, s17, v35
    v_mul_f32 v36, s17, v36
    v_mul_f32 v37, s17, v37
    v_mul_f32 v38, s17, v38
    v_mul_f32 v39, s17, v39
    v_exp_f32 v24, v24
    v_exp_f32 v25, v25
    v_exp_f32 v26, v26
    v_exp_f32 v27, v27
    v_exp_f32 v28, v28
    v_exp_f32 v29, v29
    v_exp_f32 v30, v30
    v_xor_b32 v45, s80, v2
    buffer_load_dwordx4 v[100:103], v45, s[28:31], 0 offen nt
    s_xor_b32 s80, s101, 0x800
    v_exp_f32 v31, v31
    v_exp_f32 v32, v32
    v_exp_f32 v33, v33
    v_exp_f32 v34, v34
    v_exp_f32 v35, v35
    v_exp_f32 v36, v36
    v_exp_f32 v37, v37
    v_exp_f32 v38, v38
    v_exp_f32 v39, v39
    v_add_f32 v41, v24, v25
    v_add_f32 v42, v26, v27
    v_add_f32 v41, v41, v28
    v_add_f32 v42, v42, v29
    v_add_f32 v41, v41, v30
    v_add_f32 v42, v42, v31
    v_add_f32 v41, v41, v32
    v_add_f32 v42, v42, v33
    v_add_f32 v41, v41, v34
    v_add_f32 v42, v42, v35
    v_xor_b32 v45, s80, v2
    buffer_load_dwordx4 v[104:107], v45, s[28:31], 0 offen nt
    s_xor_b32 s80, s101, 0x10900
    v_add_f32 v41, v41, v36
    v_add_f32 v42, v42, v37
    v_add_f32 v41, v41, v38
    v_add_f32 v42, v42, v39
    v_add_f32 v41, v41, v42
    s_nop 1
    v_add_f32_dpp v41, v41, v41 quad_perm:[1,0,3,2] row_mask:0xf bank_mask:0xf
    s_nop 1
    v_add_f32_dpp v41, v41, v41 quad_perm:[2,3,0,1] row_mask:0xf bank_mask:0xf
    s_nop 1
    v_add_f32_dpp v41, v41, v41 row_half_mirror row_mask:0xf bank_mask:0xf
    s_nop 1
    v_add_f32_dpp v41, v41, v41 row_ror:8 row_mask:0xf bank_mask:0xf
    v_mov_b32 v42, v41
    s_nop 1
    v_permlane16_swap_b32 v41, v42
    v_add_f32 v41, v41, v42
    v_mov_b32 v42, v41
    s_nop 1
    v_permlane32_swap_b32 v41, v42
    v_add_f32 v41, v41, v42
    s_lshl_b32 s14, s3, 3
    v_mov_b32 v56, s14
    ds_write_b64 v56, v[40:41] offset:20480
    s_waitcnt lgkmcnt(0)
    s_barrier
    v_mov_b32 v56, 0
    ds_read_b128 v[48:51], v56 offset:20480
    ds_read_b128 v[52:55], v56 offset:20496
    v_xor_b32 v45, s80, v2
    buffer_load_dwordx4 v[108:111], v45, s[28:31], 0 offen nt
    s_add_u32 s100, s100, 1
    v_readlane_b32 s101, v61, s100
    s_mov_b32 s80, s101
    s_waitcnt lgkmcnt(0)
    v_max3_f32 v42, v48, v50, v52
    v_max_f32 v42, v42, v54
    v_sub_f32 v48, v48, v42
    v_sub_f32 v50, v50, v42
    v_sub_f32 v52, v52, v42
    v_sub_f32 v54, v54, v42
    v_sub_f32 v40, v40, v42
    v_mul_f32 v48, s17, v48
    v_mul_f32 v50, s17, v50
    v_mul_f32 v52, s17, v52
    v_mul_f32 v54, s17, v54
    v_mul_f32 v40, s17, v40
    v_exp_f32 v48, v48
    v_exp_f32 v50, v50
    v_exp_f32 v52, v52
    v_exp_f32 v54, v54
    v_exp_f32 v40, v40
    v_mul_f32 v43, v48, v49
    v_fmac_f32 v43, v50, v51
    v_fmac_f32 v43, v52, v53
    v_fmac_f32 v43, v54, v55
    v_rcp_f32 v41, v43
    s_nop 0
    v_fma_f32 v42, -v43, v41, 1.0
    v_fma_f32 v41, v42, v41, v41
    v_mul_f32 v40, v40, v41
    v_xor_b32 v45, s80, v2
    buffer_load_dwordx4 v[112:115], v45, s[28:31], 0 offen nt
    s_xor_b32 s80, s101, 0x10100
    v_mul_f32 v24, v24, v40
    v_mul_f32 v25, v25, v40
    v_mul_f32 v26, v26, v40
    v_mul_f32 v27, v27, v40
    v_mul_f32 v28, v28, v40
    v_mul_f32 v29, v29, v40
    v_mul_f32 v30, v30, v40
    v_mul_f32 v31, v31, v40
    v_mul_f32 v32, v32, v40
    v_mul_f32 v33, v33, v40
    v_mul_f32 v34, v34, v40
    v_mul_f32 v35, v35, v40
    v_mul_f32 v36, v36, v40
    v_mul_f32 v37, v37, v40
    v_mul_f32 v38, v38, v40
    v_mul_f32 v39, v39, v40
    v_cvt_pk_bf16_f32 v24, v24, v24
    v_cvt_pk_bf16_f32 v25, v25, v25
    v_cvt_pk_bf16_f32 v26, v26, v26
    v_cvt_pk_bf16_f32 v27, v27, v27
    v_cvt_pk_bf16_f32 v28, v28, v28
    v_cvt_pk_bf16_f32 v29, v29, v29
    v_cvt_pk_bf16_f32 v30, v30, v30
    v_cvt_pk_bf16_f32 v31, v31, v31
    v_xor_b32 v45, s80, v2
    buffer_load_dwordx4 v[116:119], v45, s[28:31], 0 offen nt
    s_xor_b32 s80, s101, 0x800
    v_cvt_pk_bf16_f32 v32, v32, v32
    v_cvt_pk_bf16_f32 v33, v33, v33
    v_cvt_pk_bf16_f32 v34, v34, v34
    v_cvt_pk_bf16_f32 v35, v35, v35
    v_cvt_pk_bf16_f32 v36, v36, v36
    v_cvt_pk_bf16_f32 v37, v37, v37
    v_cvt_pk_bf16_f32 v38, v38, v38
    v_cvt_pk_bf16_f32 v39, v39, v39
    ds_write_b32 v44, v26 offset:512
    ds_write_b32 v44, v27 offset:768
    ds_write_b32 v44, v28 offset:1024
    ds_write_b32 v44, v29 offset:1280
    ds_write_b32 v44, v30 offset:1536
    ds_write_b32 v44, v31 offset:1792
    ds_write_b32 v44, v32 offset:2048
    ds_write_b32 v44, v33 offset:2304
    ds_write_b32 v44, v34 offset:2560
    ds_write_b32 v44, v35 offset:2816
    ds_write_b32 v44, v36 offset:3072
    ds_write_b32 v44, v37 offset:3328
    ds_write_b32 v44, v38 offset:3584
    ds_write_b32 v44, v39 offset:3840
    v_add_u32 v44, 512, v44
    v_mov_b32 v42, v25
    s_cmp_lg_u32 s3, 0
    s_cbranch_scc1 L_v0
    s_cmp_lg_u32 s73, 14
    s_cbranch_scc1 L_v1
L_v2:
    v_and_b32_dpp v16, v24, v4 row_newbcast:0 row_mask:0xf bank_mask:0xf
    v_and_b32_dpp v17, v24, v5 row_newbcast:0 row_mask:0xf bank_mask:0xf
    v_and_b32_dpp v18, v24, v6 row_newbcast:0 row_mask:0xf bank_mask:0xf
    v_and_b32_dpp v19, v24, v7 row_newbcast:0 row_mask:0xf bank_mask:0xf
    s_waitcnt vmcnt(14)
    s_nop 0
    v_mfma_f32_16x16x32_bf16 v[12:15], v[16:19], v[64:67], 0
    buffer_store_dword v162, v151, s[44:47], s27 offen sc1
    buffer_store_dword v158, v151, s[44:47], s6 offen
    s_mul_i32 s99, s77, 215
    v_add_u32 v159, 1, v159
    ds_write_b32 v160, v159 offset:21252
    v_and_b32_dpp v20, v24, v4 row_newbcast:8 row_mask:0xf bank_mask:0xf
    v_and_b32_dpp v21, v24, v5 row_newbcast:8 row_mask:0xf bank_mask:0xf
    v_and_b32_dpp v22, v24, v6 row_newbcast:8 row_mask:0xf bank_mask:0xf
    v_and_b32_dpp v23, v24, v7 row_newbcast:8 row_mask:0xf bank_mask:0xf
    s_waitcnt vmcnt(15)
    s_nop 0
    v_mfma_f32_16x16x32_bf16 v[12:15], v[20:23], v[68:71], v[12:15]
    v_add_u32 v159, 1, v159
    ds_write_b32 v160, v159 offset:21252
    v_and_b32_dpp v16, v24, v4 row_newbcast:4 row_mask:0xf bank_mask:0xf
    v_and_b32_dpp v17, v24, v5 row_newbcast:4 row_mask:0xf bank_mask:0xf
    v_and_b32_dpp v18, v24, v6 row_newbcast:4 row_mask:0xf bank_mask:0xf
    v_and_b32_dpp v19, v24, v7 row_newbcast:4 row_mask:0xf bank_mask:0xf
    s_waitcnt vmcnt(14)
    s_nop 0
    v_mfma_f32_16x16x32_bf16 v[12:15], v[16:19], v[72:75], v[12:15]
    v_add_u32 v159, 1, v159
    ds_write_b32 v160, v159 offset:21252
    v_and_b32_dpp v20, v24, v4 row_newbcast:12 row_mask:0xf bank_mask:0xf
    v_and_b32_dpp v21, v24, v5 row_newbcast:12 row_mask:0xf bank_mask:0xf
    v_and_b32_dpp v22, v24, v6 row_newbcast:12 row_mask:0xf bank_mask:0xf
    v_and_b32_dpp v23, v24, v7 row_newbcast:12 row_mask:0xf bank_mask:0xf
    s_waitcnt vmcnt(13)
    s_nop 0
    v_mfma_f32_16x16x32_bf16 v[12:15], v[20:23], v[76:79], v[12:15]
    v_add_u32 v159, 1, v159
    ds_write_b32 v160, v159 offset:21252
    v_and_b32_dpp v16, v24, v4 row_newbcast:2 row_mask:0xf bank_mask:0xf
    v_and_b32_dpp v17, v24, v5 row_newbcast:2 row_mask:0xf bank_mask:0xf
    v_and_b32_dpp v18, v24, v6 row_newbcast:2 row_mask:0xf bank_mask:0xf
    v_and_b32_dpp v19, v24, v7 row_newbcast:2 row_mask:0xf bank_mask:0xf
    s_waitcnt vmcnt(12)
    s_nop 0
    v_mfma_f32_16x16x32_bf16 v[12:15], v[16:19], v[80:83], v[12:15]
    v_add_u32 v159, 1, v159
    ds_write_b32 v160, v159 offset:21252
    v_and_b32_dpp v20, v24, v4 row_newbcast:10 row_mask:0xf bank_mask:0xf
    v_and_b32_dpp v21, v24, v5 row_newbcast:10 row_mask:0xf bank_mask:0xf
    v_and_b32_dpp v22, v24, v6 row_newbcast:10 row_mask:0xf bank_mask:0xf
    v_and_b32_dpp v23, v24, v7 row_newbcast:10 row_mask:0xf bank_mask:0xf
    s_waitcnt vmcnt(11)
    s_nop 0
    v_mfma_f32_16x16x32_bf16 v[12:15], v[20:23], v[84:87], v[12:15]
    v_add_u32 v159, 1, v159
    ds_write_b32 v160, v159 offset:21252
    v_and_b32_dpp v16, v24, v4 row_newbcast:6 row_mask:0xf bank_mask:0xf
    v_and_b32_dpp v17, v24, v5 row_newbcast:6 row_mask:0xf bank_mask:0xf
    v_and_b32_dpp v18, v24, v6 row_newbcast:6 row_mask:0xf bank_mask:0xf
    v_and_b32_dpp v19, v24, v7 row_newbcast:6 row_mask:0xf bank_mask:0xf
    s_waitcnt vmcnt(10)
    s_nop 0
    v_mfma_f32_16x16x32_bf16 v[12:15], v[16:19], v[88:91], v[12:15]
    v_add_u32 v159, 1, v159
    ds_write_b32 v160, v159 offset:21252
    v_and_b32_dpp v20, v24, v4 row_newbcast:14 row_mask:0xf bank_mask:0xf
    v_and_b32_dpp v21, v24, v5 row_newbcast:14 row_mask:0xf bank_mask:0xf
    v_and_b32_dpp v22, v24, v6 row_newbcast:14 row_mask:0xf bank_mask:0xf
    v_and_b32_dpp v23, v24, v7 row_newbcast:14 row_mask:0xf bank_mask:0xf
    s_waitcnt vmcnt(8)
    s_nop 0
    v_mfma_f32_16x16x32_bf16 v[12:15], v[20:23], v[92:95], v[12:15]
    s_cmp_gt_u32 s4, 30
    s_cbranch_scc1 L_sk50
    s_cmp_gt_u32 s4, 14
    s_cbranch_scc1 L_sk50m
    s_waitcnt vmcnt(5)
L_sk50m:
    s_waitcnt vmcnt(6)
L_sk50:
    v_xor_b32 v45, s80, v2
    buffer_load_dwordx4 v[120:123], v45, s[28:31], 0 offen nt
    s_xor_b32 s80, s101, 0x10900
    v_add_u32 v159, 1, v159
    ds_write_b32 v160, v159 offset:21252
    v_and_b32_dpp v16, v24, v4 row_newbcast:1 row_mask:0xf bank_mask:0xf
    v_and_b32_dpp v17, v24, v5 row_newbcast:1 row_mask:0xf bank_mask:0xf
    v_and_b32_dpp v18, v24, v6 row_newbcast:1 row_mask:0xf bank_mask:0xf
    v_and_b32_dpp v19, v24, v7 row_newbcast:1 row_mask:0xf bank_mask:0xf
    s_waitcnt vmcnt(8)
    s_nop 0
    v_mfma_f32_16x16x32_bf16 v[12:15], v[16:19], v[96:99], v[12:15]
    s_cmp_gt_u32 s4, 17
    s_cbranch_scc1 L_sk51
    s_cmp_gt_u32 s4, 1
    s_cbranch_scc1 L_sk51m
    s_waitcnt vmcnt(5)
L_sk51m:
    s_waitcnt vmcnt(6)
L_sk51:
    v_xor_b32 v45, s80, v2
    buffer_load_dwordx4 v[124:127], v45, s[28:31], 0 offen nt
    s_add_u32 s100, s100, 1
    v_readlane_b32 s101, v61, s100
    s_mov_b32 s80, s101
    v_add_u32 v159, 1, v159
    ds_write_b32 v160, v159 offset:21252
    v_and_b32_dpp v20, v24, v4 row_newbcast:9 row_mask:0xf bank_mask:0xf
    v_and_b32_dpp v21, v24, v5 row_newbcast:9 row_mask:0xf bank_mask:0xf
    v_and_b32_dpp v22, v24, v6 row_newbcast:9 row_mask:0xf bank_mask:0xf
    v_and_b32_dpp v23, v24, v7 row_newbcast:9 row_mask:0xf bank_mask:0xf
    s_waitcnt vmcnt(8)
    s_nop 0
    v_mfma_f32_16x16x32_bf16 v[12:15], v[20:23], v[100:103], v[12:15]
    s_cmp_gt_u32 s4, 25
    s_cbranch_scc1 L_sk52
    s_cmp_gt_u32 s4, 9
    s_cbranch_scc1 L_sk52m
    s_waitcnt vmcnt(5)
L_sk52m:
    s_waitcnt vmcnt(6)
L_sk52:
    v_xor_b32 v45, s80, v2
    buffer_load_dwordx4 v[64:67], v45, s[28:31], 0 offen nt
    s_xor_b32 s80, s101, 0x10100
    v_add_u32 v159, 1, v159
    ds_write_b32 v160, v159 offset:21252
    v_and_b32_dpp v16, v24, v4 row_newbcast:5 row_mask:0xf bank_mask:0xf
    v_and_b32_dpp v17, v24, v5 row_newbcast:5 row_mask:0xf bank_mask:0xf
    v_and_b32_dpp v18, v24, v6 row_newbcast:5 row_mask:0xf bank_mask:0xf
    v_and_b32_dpp v19, v24, v7 row_newbcast:5 row_mask:0xf bank_mask:0xf
    s_waitcnt vmcnt(8)
    s_nop 0
    v_mfma_f32_16x16x32_bf16 v[12:15], v[16:19], v[104:107], v[12:15]
    s_memrealtime s[94:95]
    s_cmp_gt_u32 s4, 21
    s_cbranch_scc1 L_sk53
    s_cmp_gt_u32 s4, 5
    s_cbranch_scc1 L_sk53m
    s_waitcnt vmcnt(5)
L_sk53m:
    s_waitcnt vmcnt(6)
L_sk53:
    v_xor_b32 v45, s80, v2
    buffer_load_dwordx4 v[68:71], v45, s[28:31], 0 offen nt
    s_xor_b32 s80, s101, 0x800
    v_add_u32 v159, 1, v159
    ds_write_b32 v160, v159 offset:21252
    v_and_b32_dpp v20, v24, v4 row_newbcast:13 row_mask:0xf bank_mask:0xf
    v_and_b32_dpp v21, v24, v5 row_newbcast:13 row_mask:0xf bank_mask:0xf
    v_and_b32_dpp v22, v24, v6 row_newbcast:13 row_mask:0xf bank_mask:0xf
    v_and_b32_dpp v23, v24, v7 row_newbcast:13 row_mask:0xf bank_mask:0xf
    s_waitcnt vmcnt(8)
    s_nop 0
    v_mfma_f32_16x16x32_bf16 v[12:15], v[20:23], v[108:111], v[12:15]
    s_waitcnt lgkmcnt(0)
    s_sub_u32 s79, s94, s99
    s_sub_u32 s79, s79, s98
    s_add_u32 s79, s79, s38
    s_sub_u32 s79, s79, 134
    s_and_b32 s79, s79, s97
    s_mul_i32 s79, s79, 3
    s_ashr_i32 s79, s79, 3
    s_ashr_i32 s7, s5, 5
    s_add_u32 s79, s79, s7
    s_add_u32 s79, s79, 43
    s_max_i32 s79, s79, 0
    s_min_i32 s79, s79, 64
    v_mov_b32 v157, s79
    ds_write_b32 v160, v157 offset:21248
    s_add_u32 s79, s79, 1
    s_lshr_b32 s4, s79, 1
    s_cmp_gt_u32 s4, 29
    s_cbranch_scc1 L_sk54
    s_cmp_gt_u32 s4, 13
    s_cbranch_scc1 L_sk54m
    s_waitcnt vmcnt(3)
L_sk54m:
    s_waitcnt vmcnt(6)
L_sk54:
    v_xor_b32 v45, s80, v2
    buffer_load_dwordx4 v[72:75], v45, s[28:31], 0 offen nt
    s_xor_b32 s80, s101, 0x10900
    v_add_u32 v159, 1, v159
    ds_write_b32 v160, v159 offset:21252
    v_and_b32_dpp v16, v24, v4 row_newbcast:3 row_mask:0xf bank_mask:0xf
    v_and_b32_dpp v17, v24, v5 row_newbcast:3 row_mask:0xf bank_mask:0xf
    v_and_b32_dpp v18, v24, v6 row_newbcast:3 row_mask:0xf bank_mask:0xf
    v_and_b32_dpp v19, v24, v7 row_newbcast:3 row_mask:0xf bank_mask:0xf
    s_waitcnt vmcnt(8)
    s_nop 0
    v_mfma_f32_16x16x32_bf16 v[12:15], v[16:19], v[112:115], v[12:15]
    s_memrealtime s[94:95]
    s_cmp_gt_u32 s4, 19
    s_cbranch_scc1 L_sk55
    s_cmp_gt_u32 s4, 3
    s_cbranch_scc1 L_sk55m
    s_waitcnt vmcnt(3)
L_sk55m:
    s_waitcnt vmcnt(4)
L_sk55:
    v_xor_b32 v45, s80, v2
    buffer_load_dwordx4 v[76:79], v45, s[28:31], 0 offen nt
    s_add_u32 s100, s100, 1
    v_readlane_b32 s101, v61, s100
    s_mov_b32 s80, s101
    v_add_u32 v159, 1, v159
    ds_write_b32 v160, v159 offset:21252
    v_and_b32_dpp v20, v24, v4 row_newbcast:11 row_mask:0xf bank_mask:0xf
    v_and_b32_dpp v21, v24, v5 row_newbcast:11 row_mask:0xf bank_mask:0xf
    v_and_b32_dpp v22, v24, v6 row_newbcast:11 row_mask:0xf bank_mask:0xf
    v_and_b32_dpp v23, v24, v7 row_newbcast:11 row_mask:0xf bank_mask:0xf
    s_waitcnt vmcnt(8)
    s_nop 0
    v_mfma_f32_16x16x32_bf16 v[12:15], v[20:23], v[116:119], v[12:15]
    s_waitcnt lgkmcnt(0)
    s_sub_u32 s79, s94, s99
    s_sub_u32 s79, s79, s98
    s_add_u32 s79, s79, s38
    s_sub_u32 s79, s79, 161
    s_and_b32 s79, s79, s97
    s_mul_i32 s79, s79, 3
    s_ashr_i32 s79, s79, 3
    s_ashr_i32 s7, s5, 5
    s_add_u32 s79, s79, s7
    s_add_u32 s79, s79, 43
    s_max_i32 s79, s79, 0
    s_min_i32 s79, s79, 64
    v_mov_b32 v157, s79
    ds_write_b32 v160, v157 offset:21248
    s_lshr_b32 s4, s79, 1
    s_cmp_gt_u32 s4, 27
    s_cbranch_scc1 L_sk56
    s_cmp_gt_u32 s4, 11
    s_cbranch_scc1 L_sk56m
    s_waitcnt vmcnt(3)
L_sk56m:
    s_waitcnt vmcnt(4)
L_sk56:
    v_xor_b32 v45, s80, v2
    buffer_load_dwordx4 v[80:83], v45, s[28:31], 0 offen nt
    s_xor_b32 s80, s101, 0x10100
    v_add_u32 v159, 1, v159
    ds_write_b32 v160, v159 offset:21252
    v_and_b32_dpp v16, v24, v4 row_newbcast:7 row_mask:0xf bank_mask:0xf
    v_and_b32_dpp v17, v24, v5 row_newbcast:7 row_mask:0xf bank_mask:0xf
    v_and_b32_dpp v18, v24, v6 row_newbcast:7 row_mask:0xf bank_mask:0xf
    v_and_b32_dpp v19, v24, v7 row_newbcast:7 row_mask:0xf bank_mask:0xf
    s_waitcnt vmcnt(6)
    s_nop 0
    v_mfma_f32_16x16x32_bf16 v[12:15], v[16:19], v[120:123], v[12:15]
    s_memrealtime s[94:95]
    s_cmp_gt_u32 s4, 23
    s_cbranch_scc1 L_sk57
    s_cmp_gt_u32 s4, 7
    s_cbranch_scc1 L_sk57m
    s_waitcnt vmcnt(3)
L_sk57m:
    s_waitcnt vmcnt(4)
L_sk57:
    v_xor_b32 v45, s80, v2
    buffer_load_dwordx4 v[84:87], v45, s[28:31], 0 offen nt
    s_xor_b32 s80, s101, 0x800
    v_add_u32 v159, 1, v159
    ds_write_b32 v160, v159 offset:21252
    v_and_b32_dpp v20, v24, v4 row_newbcast:15 row_mask:0xf bank_mask:0xf
    v_and_b32_dpp v21, v24, v5 row_newbcast:15 row_mask:0xf bank_mask:0xf
    v_and_b32_dpp v22, v24, v6 row_newbcast:15 row_mask:0xf bank_mask:0xf
    v_and_b32_dpp v23, v24, v7 row_newbcast:15 row_mask:0xf bank_mask:0xf
    s_waitcnt vmcnt(6)
    s_nop 0
    v_mfma_f32_16x16x32_bf16 v[12:15], v[20:23], v[124:127], v[12:15]
    s_waitcnt lgkmcnt(0)
    s_sub_u32 s79, s94, s99
    s_sub_u32 s79, s79, s98
    s_add_u32 s79, s79, s38
    s_sub_u32 s79, s79, 188
    s_and_b32 s79, s79, s97
    s_mul_i32 s79, s79, 3
    s_ashr_i32 s79, s79, 3
    s_ashr_i32 s7, s5, 5
    s_add_u32 s79, s79, s7
    s_add_u32 s79, s79, 43
    s_max_i32 s79, s79, 0
    s_min_i32 s79, s79, 64
    v_mov_b32 v157, s79
    ds_write_b32 v160, v157 offset:21248
    s_add_u32 s79, s79, 1
    s_lshr_b32 s4, s79, 1
    s_cmp_gt_u32 s4, 31
    s_cbranch_scc1 L_sk58
    s_cmp_gt_u32 s4, 15
    s_cbranch_scc1 L_sk58m
    s_waitcnt vmcnt(3)
L_sk58m:
    s_waitcnt vmcnt(4)
L_sk58:
    v_xor_b32 v45, s80, v2
    buffer_load_dwordx4 v[88:91], v45, s[28:31], 0 offen nt
    s_xor_b32 s80, s101, 0x10900
    v_add_u32 v159, 1, v159
    ds_write_b32 v160, v159 offset:21252
    s_add_u32 s77, s77, 1
    s_mov_b32 s81, 1
L_lpv2:
    s_waitcnt lgkmcnt(0)
    v_mov_b32 v40, v42
    ds_read_b32 v42, v44
    v_add_u32 v44, 256, v44
    v_and_b32_dpp v16, v40, v4 row_newbcast:0 row_mask:0xf bank_mask:0xf
    v_and_b32_dpp v17, v40, v5 row_newbcast:0 row_mask:0xf bank_mask:0xf
    v_and_b32_dpp v18, v40, v6 row_newbcast:0 row_mask:0xf bank_mask:0xf
    v_and_b32_dpp v19, v40, v7 row_newbcast:0 row_mask:0xf bank_mask:0xf
    s_waitcnt vmcnt(6)
    s_nop 0
    v_mfma_f32_16x16x32_bf16 v[12:15], v[16:19], v[64:67], v[12:15]
    buffer_store_dword v162, v151, s[44:47], s27 offen sc1
    buffer_store_dword v158, v151, s[44:47], s6 offen
    s_mul_i32 s99, s77, 215
    s_memrealtime s[94:95]
    s_cmp_gt_u32 s4, 16
    s_cbranch_scc1 L_sk59
    s_cmp_gt_u32 s4, 0
    s_cbranch_scc1 L_sk59m
    s_waitcnt vmcnt(5)
L_sk59m:
    s_waitcnt vmcnt(6)
L_sk59:
    v_xor_b32 v45, s80, v2
    buffer_load_dwordx4 v[92:95], v45, s[28:31], 0 offen nt
    s_add_u32 s100, s100, 1
    v_readlane_b32 s101, v61, s100
    s_mov_b32 s80, s101
    v_add_u32 v159, 1, v159
    ds_write_b32 v160, v159 offset:21252
    v_and_b32_dpp v20, v40, v4 row_newbcast:8 row_mask:0xf bank_mask:0xf
    v_and_b32_dpp v21, v40, v5 row_newbcast:8 row_mask:0xf bank_mask:0xf
    v_and_b32_dpp v22, v40, v6 row_newbcast:8 row_mask:0xf bank_mask:0xf
    v_and_b32_dpp v23, v40, v7 row_newbcast:8 row_mask:0xf bank_mask:0xf
    s_waitcnt vmcnt(8)
    s_nop 0
    v_mfma_f32_16x16x32_bf16 v[12:15], v[20:23], v[68:71], v[12:15]
    s_waitcnt lgkmcnt(0)
    s_sub_u32 s79, s94, s99
    s_mov_b32 s96, s79
    v_mov_b32 v153, s79
    buffer_store_dword v153, v151, s[44:47], s25 offen
    s_sub_u32 s79, s79, s98
    s_add_u32 s79, s79, s38
    s_and_b32 s79, s79, s97
    s_max_i32 s7, s79, -40
    s_min_i32 s7, s7, 40
    s_add_u32 s5, s5, s7
    s_max_i32 s5, s5, -512
    s_min_i32 s5, s5, 512
    s_mul_i32 s79, s79, 3
    s_ashr_i32 s79, s79, 3
    s_ashr_i32 s7, s5, 5
    s_add_u32 s79, s79, s7
    s_add_u32 s79, s79, 43
    s_max_i32 s79, s79, 0
    s_min_i32 s79, s79, 64
    v_mov_b32 v157, s79
    ds_write_b32 v160, v157 offset:21248
    s_lshr_b32 s4, s79, 1
    s_cmp_gt_u32 s4, 24
    s_cbranch_scc1 L_sk60
    s_cmp_gt_u32 s4, 8
    s_cbranch_scc1 L_sk60m
    s_waitcnt vmcnt(6)
L_sk60m:
    s_waitcnt vmcnt(7)
L_sk60:
    v_xor_b32 v45, s80, v2
    buffer_load_dwordx4 v[96:99], v45, s[28:31], 0 offen nt
    s_xor_b32 s80, s101, 0x10100
    v_add_u32 v159, 1, v159
    ds_write_b32 v160, v159 offset:21252
    v_and_b32_dpp v16, v40, v4 row_newbcast:4 row_mask:0xf bank_mask:0xf
    v_and_b32_dpp v17, v40, v5 row_newbcast:4 row_mask:0xf bank_mask:0xf
    v_and_b32_dpp v18, v40, v6 row_newbcast:4 row_mask:0xf bank_mask:0xf
    v_and_b32_dpp v19, v40, v7 row_newbcast:4 row_mask:0xf bank_mask:0xf
    s_waitcnt vmcnt(9)
    s_nop 0
    v_mfma_f32_16x16x32_bf16 v[12:15], v[16:19], v[72:75], v[12:15]
    s_memrealtime s[94:95]
    s_and_b32 s7, s73, 7
    s_add_u32 s7, s7, 2
    s_cmp_lg_u32 s7, s81
    s_nop 2
    s_cbranch_scc1 L_nav22
    v_lshrrev_b32 v148, 1, v1
    v_mul_u32_u24 v148, 4224, v148
    v_and_b32 v149, 1, v1
    v_lshl_add_u32 v148, v149, 4, v148
    s_mov_b32 s7, 1388544
    buffer_load_dwordx4 v[144:147], v148, s[44:47], s7 offen sc1
L_nav22:
    s_cmp_gt_u32 s4, 20
    s_cbranch_scc1 L_sk61
    s_cmp_gt_u32 s4, 4
    s_cbranch_scc1 L_sk61m
    s_waitcnt vmcnt(6)
L_sk61m:
    s_waitcnt vmcnt(7)
L_sk61:
    v_xor_b32 v45, s80, v2
    buffer_load_dwordx4 v[100:103], v45, s[28:31], 0 offen nt
    s_xor_b32 s80, s101, 0x800
    v_add_u32 v159, 1, v159
    ds_write_b32 v160, v159 offset:21252
    v_and_b32_dpp v20, v40, v4 row_newbcast:12 row_mask:0xf bank_mask:0xf
    v_and_b32_dpp v21, v40, v5 row_newbcast:12 row_mask:0xf bank_mask:0xf
    v_and_b32_dpp v22, v40, v6 row_newbcast:12 row_mask:0xf bank_mask:0xf
    v_and_b32_dpp v23, v40, v7 row_newbcast:12 row_mask:0xf bank_mask:0xf
    s_waitcnt vmcnt(9)
    s_nop 0
    v_mfma_f32_16x16x32_bf16 v[12:15], v[20:23], v[76:79], v[12:15]
    s_waitcnt lgkmcnt(0)
    s_sub_u32 s79, s94, s99
    s_sub_u32 s79, s79, s98
    s_add_u32 s79, s79, s38
    s_sub_u32 s79, s79, 26
    s_and_b32 s79, s79, s97
    s_mul_i32 s79, s79, 3
    s_ashr_i32 s79, s79, 3
    s_ashr_i32 s7, s5, 5
    s_add_u32 s79, s79, s7
    s_add_u32 s79, s79, 43
    s_max_i32 s79, s79, 0
    s_min_i32 s79, s79, 64
    v_mov_b32 v157, s79
    ds_write_b32 v160, v157 offset:21248
    s_add_u32 s79, s79, 1
    s_lshr_b32 s4, s79, 1
    s_cmp_gt_u32 s4, 28
    s_cbranch_scc1 L_sk62
    s_cmp_gt_u32 s4, 12
    s_cbranch_scc1 L_sk62m
    s_waitcnt vmcnt(6)
L_sk62m:
    s_waitcnt vmcnt(7)
L_sk62:
    v_xor_b32 v45, s80, v2
    buffer_load_dwordx4 v[104:107], v45, s[28:31], 0 offen nt
    s_xor_b32 s80, s101, 0x10900
    v_add_u32 v159, 1, v159
    ds_write_b32 v160, v159 offset:21252
    v_and_b32_dpp v16, v40, v4 row_newbcast:2 row_mask:0xf bank_mask:0xf
    v_and_b32_dpp v17, v40, v5 row_newbcast:2 row_mask:0xf bank_mask:0xf
    v_and_b32_dpp v18, v40, v6 row_newbcast:2 row_mask:0xf bank_mask:0xf
    v_and_b32_dpp v19, v40, v7 row_newbcast:2 row_mask:0xf bank_mask:0xf
    s_waitcnt vmcnt(9)
    s_nop 0
    v_mfma_f32_16x16x32_bf16 v[12:15], v[16:19], v[80:83], v[12:15]
    buffer_load_dword v154, v150, s[44:47], s24 offen sc1
    s_memrealtime s[94:95]
    s_cmp_gt_u32 s4, 18
    s_cbranch_scc1 L_sk63
    s_cmp_gt_u32 s4, 2
    s_cbranch_scc1 L_sk63m
    s_waitcnt vmcnt(5)
L_sk63m:
    s_waitcnt vmcnt(8)
L_sk63:
    v_xor_b32 v45, s80, v2
    buffer_load_dwordx4 v[108:111], v45, s[28:31], 0 offen nt
    s_add_u32 s100, s100, 1
    v_readlane_b32 s101, v61, s100
    s_mov_b32 s80, s101
    v_add_u32 v159, 1, v159
    ds_write_b32 v160, v159 offset:21252
    v_and_b32_dpp v20, v40, v4 row_newbcast:10 row_mask:0xf bank_mask:0xf
    v_and_b32_dpp v21, v40, v5 row_newbcast:10 row_mask:0xf bank_mask:0xf
    v_and_b32_dpp v22, v40, v6 row_newbcast:10 row_mask:0xf bank_mask:0xf
    v_and_b32_dpp v23, v40, v7 row_newbcast:10 row_mask:0xf bank_mask:0xf
    s_waitcnt vmcnt(10)
    s_nop 0
    v_mfma_f32_16x16x32_bf16 v[12:15], v[20:23], v[84:87], v[12:15]
    s_waitcnt lgkmcnt(0)
    s_sub_u32 s79, s94, s99
    s_sub_u32 s79, s79, s98
    s_add_u32 s79, s79, s38
    s_sub_u32 s79, s79, 53
    s_and_b32 s79, s79, s97
    s_mul_i32 s79, s79, 3
    s_ashr_i32 s79, s79, 3
    s_ashr_i32 s7, s5, 5
    s_add_u32 s79, s79, s7
    s_add_u32 s79, s79, 43
    s_max_i32 s79, s79, 0
    s_min_i32 s79, s79, 64
    v_mov_b32 v157, s79
    ds_write_b32 v160, v157 offset:21248
    s_lshr_b32 s4, s79, 1
    s_cmp_gt_u32 s4, 26
    s_cbranch_scc1 L_sk64
    s_cmp_gt_u32 s4, 10
    s_cbranch_scc1 L_sk64m
    s_waitcnt vmcnt(4)
L_sk64m:
    s_waitcnt vmcnt(6)
L_sk64:
    v_xor_b32 v45, s80, v2
    buffer_load_dwordx4 v[112:115], v45, s[28:31], 0 offen nt
    s_xor_b32 s80, s101, 0x10100
    v_add_u32 v159, 1, v159
    ds_write_b32 v160, v159 offset:21252
    v_and_b32_dpp v16, v40, v4 row_newbcast:6 row_mask:0xf bank_mask:0xf
    v_and_b32_dpp v17, v40, v5 row_newbcast:6 row_mask:0xf bank_mask:0xf
    v_and_b32_dpp v18, v40, v6 row_newbcast:6 row_mask:0xf bank_mask:0xf
    v_and_b32_dpp v19, v40, v7 row_newbcast:6 row_mask:0xf bank_mask:0xf
    s_waitcnt vmcnt(10)
    s_nop 0
    v_mfma_f32_16x16x32_bf16 v[12:15], v[16:19], v[88:91], v[12:15]
    buffer_load_dword v155, v152, s[44:47], 0 offen sc1
    s_memrealtime s[94:95]
    s_cmp_gt_u32 s4, 22
    s_cbranch_scc1 L_sk65
    s_cmp_gt_u32 s4, 6
    s_cbranch_scc1 L_sk65m
    s_waitcnt vmcnt(5)
L_sk65m:
    s_waitcnt vmcnt(6)
L_sk65:
    v_xor_b32 v45, s80, v2
    buffer_load_dwordx4 v[116:119], v45, s[28:31], 0 offen nt
    s_xor_b32 s80, s101, 0x800
    v_add_u32 v159, 1, v159
    ds_write_b32 v160, v159 offset:21252
    v_and_b32_dpp v20, v40, v4 row_newbcast:14 row_mask:0xf bank_mask:0xf
    v_and_b32_dpp v21, v40, v5 row_newbcast:14 row_mask:0xf bank_mask:0xf
    v_and_b32_dpp v22, v40, v6 row_newbcast:14 row_mask:0xf bank_mask:0xf
    v_and_b32_dpp v23, v40, v7 row_newbcast:14 row_mask:0xf bank_mask:0xf
    s_waitcnt vmcnt(9)
    s_nop 0
    v_mfma_f32_16x16x32_bf16 v[12:15], v[20:23], v[92:95], v[12:15]
    s_waitcnt lgkmcnt(0)
    s_sub_u32 s79, s94, s99
    s_sub_u32 s79, s79, s98
    s_add_u32 s79, s79, s38
    s_sub_u32 s79, s79, 80
    s_and_b32 s79, s79, s97
    s_mul_i32 s79, s79, 3
    s_ashr_i32 s79, s79, 3
    s_ashr_i32 s7, s5, 5
    s_add_u32 s79, s79, s7
    s_add_u32 s79, s79, 43
    s_max_i32 s79, s79, 0
    s_min_i32 s79, s79, 64
    v_mov_b32 v157, s79
    ds_write_b32 v160, v157 offset:21248
    s_add_u32 s79, s79, 1
    s_lshr_b32 s4, s79, 1
    s_cmp_gt_u32 s4, 30
    s_cbranch_scc1 L_sk66
    s_cmp_gt_u32 s4, 14
    s_cbranch_scc1 L_sk66m
    s_waitcnt vmcnt(5)
L_sk66m:
    s_waitcnt vmcnt(6)
L_sk66:
    v_xor_b32 v45, s80, v2
    buffer_load_dwordx4 v[120:123], v45, s[28:31], 0 offen nt
    s_xor_b32 s80, s101, 0x10900
    v_add_u32 v159, 1, v159
    ds_write_b32 v160, v159 offset:21252
    v_and_b32_dpp v16, v40, v4 row_newbcast:1 row_mask:0xf bank_mask:0xf
    v_and_b32_dpp v17, v40, v5 row_newbcast:1 row_mask:0xf bank_mask:0xf
    v_and_b32_dpp v18, v40, v6 row_newbcast:1 row_mask:0xf bank_mask:0xf
    v_and_b32_dpp v19, v40, v7 row_newbcast:1 row_mask:0xf bank_mask:0xf
    s_waitcnt vmcnt(8)
    s_nop 0
    v_mfma_f32_16x16x32_bf16 v[12:15], v[16:19], v[96:99], v[12:15]
    s_memrealtime s[94:95]
    s_cmp_gt_u32 s4, 17
    s_cbranch_scc1 L_sk67
    s_cmp_gt_u32 s4, 1
    s_cbranch_scc1 L_sk67m
    s_waitcnt vmcnt(4)
L_sk67m:
    s_waitcnt vmcnt(6)
L_sk67:
    v_xor_b32 v45, s80, v2
    buffer_load_dwordx4 v[124:127], v45, s[28:31], 0 offen nt
    s_add_u32 s100, s100, 1
    v_readlane_b32 s101, v61, s100
    s_mov_b32 s80, s101
    v_add_u32 v159, 1, v159
    ds_write_b32 v160, v159 offset:21252
    v_and_b32_dpp v20, v40, v4 row_newbcast:9 row_mask:0xf bank_mask:0xf
    v_and_b32_dpp v21, v40, v5 row_newbcast:9 row_mask:0xf bank_mask:0xf
    v_and_b32_dpp v22, v40, v6 row_newbcast:9 row_mask:0xf bank_mask:0xf
    v_and_b32_dpp v23, v40, v7 row_newbcast:9 row_mask:0xf bank_mask:0xf
    s_waitcnt vmcnt(8)
    s_nop 0
    v_mfma_f32_16x16x32_bf16 v[12:15], v[20:23], v[100:103], v[12:15]
    s_waitcnt lgkmcnt(0)
    s_sub_u32 s79, s94, s99
    s_sub_u32 s79, s79, s98
    s_add_u32 s79, s79, s38
    s_sub_u32 s79, s79, 107
    s_and_b32 s79, s79, s97
    s_mul_i32 s79, s79, 3
    s_ashr_i32 s79, s79, 3
    s_ashr_i32 s7, s5, 5
    s_add_u32 s79, s79, s7
    s_add_u32 s79, s79, 43
    s_max_i32 s79, s79, 0
    s_min_i32 s79, s79, 64
    v_mov_b32 v157, s79
    ds_write_b32 v160, v157 offset:21248
    s_lshr_b32 s4, s79, 1
    s_cmp_gt_u32 s4, 25
    s_cbranch_scc1 L_sk68
    s_cmp_gt_u32 s4, 9
    s_cbranch_scc1 L_sk68m
    s_waitcnt vmcnt(4)
L_sk68m:
    s_waitcnt vmcnt(5)
L_sk68:
    v_xor_b32 v45, s80, v2
    buffer_load_dwordx4 v[64:67], v45, s[28:31], 0 offen nt
    s_xor_b32 s80, s101, 0x10100
    v_add_u32 v159, 1, v159
    ds_write_b32 v160, v159 offset:21252
    v_and_b32_dpp v16, v40, v4 row_newbcast:5 row_mask:0xf bank_mask:0xf
    v_and_b32_dpp v17, v40, v5 row_newbcast:5 row_mask:0xf bank_mask:0xf
    v_and_b32_dpp v18, v40, v6 row_newbcast:5 row_mask:0xf bank_mask:0xf
    v_and_b32_dpp v19, v40, v7 row_newbcast:5 row_mask:0xf bank_mask:0xf
    s_waitcnt vmcnt(8)
    s_nop 0
    v_mfma_f32_16x16x32_bf16 v[12:15], v[16:19], v[104:107], v[12:15]
    s_memrealtime s[94:95]
    s_and_b32 s7, s73, 7
    s_add_u32 s7, s7, 2
    s_cmp_lg_u32 s7, s81
    s_nop 2
    s_cbranch_scc1 L_nav210
    s_mov_b32 s79, 0x8000
    s_mov_b32 s7, 1388544
L_afchkv2:
    v_and_b32 v144, v144, v145
    v_and_b32 v146, v146, v147
    v_and_b32 v144, v144, v146
    v_cmp_ne_u32 vcc, 1, v144
    s_nop 3
    s_cbranch_vccz L_nav210
    s_sleep 8
    buffer_load_dwordx4 v[144:147], v148, s[44:47], s7 offen sc1
    s_waitcnt vmcnt(0)
    s_sub_u32 s79, s79, 1
    s_cmp_lg_u32 s79, 0
    s_cbranch_scc1 L_afchkv2
L_nav210:
    s_cmp_gt_u32 s4, 21
    s_cbranch_scc1 L_sk69
    s_cmp_gt_u32 s4, 5
    s_cbranch_scc1 L_sk69m
    s_waitcnt vmcnt(3)
L_sk69m:
    s_waitcnt vmcnt(5)
L_sk69:
    v_xor_b32 v45, s80, v2
    buffer_load_dwordx4 v[68:71], v45, s[28:31], 0 offen nt
    s_xor_b32 s80, s101, 0x800
    v_add_u32 v159, 1, v159
    ds_write_b32 v160, v159 offset:21252
    v_and_b32_dpp v20, v40, v4 row_newbcast:13 row_mask:0xf bank_mask:0xf
    v_and_b32_dpp v21, v40, v5 row_newbcast:13 row_mask:0xf bank_mask:0xf
    v_and_b32_dpp v22, v40, v6 row_newbcast:13 row_mask:0xf bank_mask:0xf
    v_and_b32_dpp v23, v40, v7 row_newbcast:13 row_mask:0xf bank_mask:0xf
    s_waitcnt vmcnt(7)
    s_nop 0
    v_mfma_f32_16x16x32_bf16 v[12:15], v[20:23], v[108:111], v[12:15]
    s_waitcnt lgkmcnt(0)
    s_sub_u32 s79, s94, s99
    s_sub_u32 s79, s79, s98
    s_add_u32 s79, s79, s38
    s_sub_u32 s79, s79, 134
    s_and_b32 s79, s79, s97
    s_mul_i32 s79, s79, 3
    s_ashr_i32 s79, s79, 3
    s_ashr_i32 s7, s5, 5
    s_add_u32 s79, s79, s7
    s_add_u32 s79, s79, 43
    s_max_i32 s79, s79, 0
    s_min_i32 s79, s79, 64
    v_mov_b32 v157, s79
    ds_write_b32 v160, v157 offset:21248
    s_add_u32 s79, s79, 1
    s_lshr_b32 s4, s79, 1
    s_cmp_gt_u32 s4, 29
    s_cbranch_scc1 L_sk70
    s_cmp_gt_u32 s4, 13
    s_cbranch_scc1 L_sk70m
    s_waitcnt vmcnt(3)
L_sk70m:
    s_waitcnt vmcnt(4)
L_sk70:
    v_xor_b32 v45, s80, v2
    buffer_load_dwordx4 v[72:75], v45, s[28:31], 0 offen nt
    s_xor_b32 s80, s101, 0x10900
    v_add_u32 v159, 1, v159
    ds_write_b32 v160, v159 offset:21252
    v_and_b32_dpp v16, v40, v4 row_newbcast:3 row_mask:0xf bank_mask:0xf
    v_and_b32_dpp v17, v40, v5 row_newbcast:3 row_mask:0xf bank_mask:0xf
    v_and_b32_dpp v18, v40, v6 row_newbcast:3 row_mask:0xf bank_mask:0xf
    v_and_b32_dpp v19, v40, v7 row_newbcast:3 row_mask:0xf bank_mask:0xf
    s_waitcnt vmcnt(7)
    s_nop 0
    v_mfma_f32_16x16x32_bf16 v[12:15], v[16:19], v[112:115], v[12:15]
    v_readlane_b32 s7, v154, 32
    v_sub_u32 v157, s96, v154
    v_cmp_eq_u32 vcc, -1, v154
    v_max_i32 v157, -200, v157
    v_min_i32 v157, 200, v157
    v_cndmask_b32 v157, v157, v160, vcc
    s_nop 1
    v_add_u32_dpp v157, v157, v157 quad_perm:[1,0,3,2] row_mask:0xf bank_mask:0xf
    s_nop 1
    v_add_u32_dpp v157, v157, v157 quad_perm:[2,3,0,1] row_mask:0xf bank_mask:0xf
    s_nop 1
    v_add_u32_dpp v157, v157, v157 row_half_mirror row_mask:0xf bank_mask:0xf
    s_nop 1
    v_add_u32_dpp v157, v157, v157 row_mirror row_mask:0xf bank_mask:0xf
    s_nop 0
    v_readlane_b32 s79, v157, 0
    v_readlane_b32 s98, v157, 16
    s_add_u32 s79, s79, s98
    s_ashr_i32 s79, s79, 5
    s_sub_u32 s98, s96, s79
    v_mov_b32 v162, s98
    s_mov_b32 s97, -1
    s_cmp_eq_u32 s7, -1
    s_cselect_b32 s98, s98, s7
    s_sub_u32 s7, s98, s38
    v_mov_b32 v154, s7
    ds_write_b32 v160, v154 offset:21256
    s_memrealtime s[94:95]
    s_cmp_gt_u32 s4, 19
    s_cbranch_scc1 L_sk71
    s_cmp_gt_u32 s4, 3
    s_cbranch_scc1 L_sk71m
    s_waitcnt vmcnt(3)
L_sk71m:
    s_waitcnt vmcnt(4)
L_sk71:
    v_xor_b32 v45, s80, v2
    buffer_load_dwordx4 v[76:79], v45, s[28:31], 0 offen nt
    s_add_u32 s100, s100, 1
    v_readlane_b32 s101, v61, s100
    s_mov_b32 s80, s101
    v_add_u32 v159, 1, v159
    ds_write_b32 v160, v159 offset:21252
    v_and_b32_dpp v20, v40, v4 row_newbcast:11 row_mask:0xf bank_mask:0xf
    v_and_b32_dpp v21, v40, v5 row_newbcast:11 row_mask:0xf bank_mask:0xf
    v_and_b32_dpp v22, v40, v6 row_newbcast:11 row_mask:0xf bank_mask:0xf
    v_and_b32_dpp v23, v40, v7 row_newbcast:11 row_mask:0xf bank_mask:0xf
    s_waitcnt vmcnt(6)
    s_nop 0
    v_mfma_f32_16x16x32_bf16 v[12:15], v[20:23], v[116:119], v[12:15]
    s_waitcnt lgkmcnt(0)
    s_sub_u32 s79, s94, s99
    s_sub_u32 s79, s79, s98
    s_add_u32 s79, s79, s38
    s_sub_u32 s79, s79, 161
    s_and_b32 s79, s79, s97
    s_mul_i32 s79, s79, 3
    s_ashr_i32 s79, s79, 3
    s_ashr_i32 s7, s5, 5
    s_add_u32 s79, s79, s7
    s_add_u32 s79, s79, 43
    s_max_i32 s79, s79, 0
    s_min_i32 s79, s79, 64
    v_mov_b32 v157, s79
    ds_write_b32 v160, v157 offset:21248
    s_lshr_b32 s4, s79, 1
    s_cmp_gt_u32 s4, 27
    s_cbranch_scc1 L_sk72
    s_cmp_gt_u32 s4, 11
    s_cbranch_scc1 L_sk72m
    s_waitcnt vmcnt(3)
L_sk72m:
    s_waitcnt vmcnt(4)
L_sk72:
    v_xor_b32 v45, s80, v2
    buffer_load_dwordx4 v[80:83], v45, s[28:31], 0 offen nt
    s_xor_b32 s80, s101, 0x10100
    v_add_u32 v159, 1, v159
    ds_write_b32 v160, v159 offset:21252
    v_and_b32_dpp v16, v40, v4 row_newbcast:7 row_mask:0xf bank_mask:0xf
    v_and_b32_dpp v17, v40, v5 row_newbcast:7 row_mask:0xf bank_mask:0xf
    v_and_b32_dpp v18, v40, v6 row_newbcast:7 row_mask:0xf bank_mask:0xf
    v_and_b32_dpp v19, v40, v7 row_newbcast:7 row_mask:0xf bank_mask:0xf
    s_waitcnt vmcnt(6)
    s_nop 0
    v_mfma_f32_16x16x32_bf16 v[12:15], v[16:19], v[120:123], v[12:15]
    s_mov_b32 m0, s72
    s_nop 0
    v_readlane_b32 s7, v155, m0
    s_nop 1
    v_sub_u32 v157, s7, v155
    v_cmp_eq_u32 vcc, -1, v155
    v_max_i32 v157, -200, v157
    v_min_i32 v157, 200, v157
    v_cndmask_b32 v157, v157, v160, vcc
    s_nop 1
    v_add_u32_dpp v157, v157, v157 quad_perm:[1,0,3,2] row_mask:0xf bank_mask:0xf
    s_nop 1
    v_add_u32_dpp v157, v157, v157 quad_perm:[2,3,0,1] row_mask:0xf bank_mask:0xf
    s_nop 1
    v_add_u32_dpp v157, v157, v157 row_half_mirror row_mask:0xf bank_mask:0xf
    s_nop 0
    v_readfirstlane_b32 s79, v157
    s_cmp_eq_u32 s7, -1
    s_nop 2
    s_cbranch_scc1 L_nog73
    s_ashr_i32 s79, s79, 3
    s_sub_u32 s7, s7, s79
    s_sub_u32 s79, s7, s36
    s_ashr_i32 s23, s39, 2
    s_sub_u32 s79, s79, s23
    s_max_i32 s79, s79, -6
    s_min_i32 s79, s79, 6
    s_cmp_eq_u32 s36, -1
    s_cselect_b32 s79, 0, s79
    s_mov_b32 s36, s7
    s_add_u32 s39, s39, s79
    s_max_i32 s39, s39, -64
    s_min_i32 s39, s39, 64
    s_mul_i32 s79, s39, 3
    s_ashr_i32 s79, s79, 2
    s_add_u32 s7, s7, s79
    v_mov_b32 v158, s7
L_nog73:
    s_memrealtime s[94:95]
    s_cmp_gt_u32 s4, 23
    s_cbranch_scc1 L_sk74
    s_cmp_gt_u32 s4, 7
    s_cbranch_scc1 L_sk74m
    s_waitcnt vmcnt(3)
L_sk74m:
    s_waitcnt vmcnt(4)
L_sk74:
    v_xor_b32 v45, s80, v2
    buffer_load_dwordx4 v[84:87], v45, s[28:31], 0 offen nt
    s_xor_b32 s80, s101, 0x800
    v_add_u32 v159, 1, v159
    ds_write_b32 v160, v159 offset:21252
    v_and_b32_dpp v20, v40, v4 row_newbcast:15 row_mask:0xf bank_mask:0xf
    v_and_b32_dpp v21, v40, v5 row_newbcast:15 row_mask:0xf bank_mask:0xf
    v_and_b32_dpp v22, v40, v6 row_newbcast:15 row_mask:0xf bank_mask:0xf
    v_and_b32_dpp v23, v40, v7 row_newbcast:15 row_mask:0xf bank_mask:0xf
    s_waitcnt vmcnt(6)
    s_nop 0
    v_mfma_f32_16x16x32_bf16 v[12:15], v[20:23], v[124:127], v[12:15]
    s_waitcnt lgkmcnt(0)
    s_sub_u32 s79, s94, s99
    s_sub_u32 s79, s79, s98
    s_add_u32 s79, s79, s38
    s_sub_u32 s79, s79, 188
    s_and_b32 s79, s79, s97
    s_mul_i32 s79, s79, 3
    s_ashr_i32 s79, s79, 3
    s_ashr_i32 s7, s5, 5
    s_add_u32 s79, s79, s7
    s_add_u32 s79, s79, 43
    s_max_i32 s79, s79, 0
    s_min_i32 s79, s79, 64
    v_mov_b32 v157, s79
    ds_write_b32 v160, v157 offset:21248
    s_add_u32 s79, s79, 1
    s_lshr_b32 s4, s79, 1
    s_cmp_gt_u32 s4, 31
    s_cbranch_scc1 L_sk75
    s_cmp_gt_u32 s4, 15
    s_cbranch_scc1 L_sk75m
    s_waitcnt vmcnt(3)
L_sk75m:
    s_waitcnt vmcnt(4)
L_sk75:
    v_xor_b32 v45, s80, v2
    buffer_load_dwordx4 v[88:91], v45, s[28:31], 0 offen nt
    s_xor_b32 s80, s101, 0x10900
    v_add_u32 v159, 1, v159
    ds_write_b32 v160, v159 offset:21252
    s_add_u32 s77, s77, 1
    s_add_u32 s81, s81, 1
    s_cmp_lt_u32 s81, 15
    s_cbranch_scc1 L_lpv2
    s_branch L_vend
L_v1:
    v_and_b32_dpp v16, v24, v4 row_newbcast:0 row_mask:0xf bank_mask:0xf
    v_and_b32_dpp v17, v24, v5 row_newbcast:0 row_mask:0xf bank_mask:0xf
    v_and_b32_dpp v18, v24, v6 row_newbcast:0 row_mask:0xf bank_mask:0xf
    v_and_b32_dpp v19, v24, v7 row_newbcast:0 row_mask:0xf bank_mask:0xf
    s_waitcnt vmcnt(14)
    s_nop 0
    v_mfma_f32_16x16x32_bf16 v[12:15], v[16:19], v[64:67], 0
    s_mul_i32 s99, s77, 215
    v_add_u32 v159, 1, v159
    ds_write_b32 v160, v159 offset:21252
    v_and_b32_dpp v20, v24, v4 row_newbcast:8 row_mask:0xf bank_mask:0xf
    v_and_b32_dpp v21, v24, v5 row_newbcast:8 row_mask:0xf bank_mask:0xf
    v_and_b32_dpp v22, v24, v6 row_newbcast:8 row_mask:0xf bank_mask:0xf
    v_and_b32_dpp v23, v24, v7 row_newbcast:8 row_mask:0xf bank_mask:0xf
    s_waitcnt vmcnt(13)
    s_nop 0
    v_mfma_f32_16x16x32_bf16 v[12:15], v[20:23], v[68:71], v[12:15]
    v_add_u32 v159, 1, v159
    ds_write_b32 v160, v159 offset:21252
    v_and_b32_dpp v16, v24, v4 row_newbcast:4 row_mask:0xf bank_mask:0xf
    v_and_b32_dpp v17, v24, v5 row_newbcast:4 row_mask:0xf bank_mask:0xf
    v_and_b32_dpp v18, v24, v6 row_newbcast:4 row_mask:0xf bank_mask:0xf
    v_and_b32_dpp v19, v24, v7 row_newbcast:4 row_mask:0xf bank_mask:0xf
    s_waitcnt vmcnt(12)
    s_nop 0
    v_mfma_f32_16x16x32_bf16 v[12:15], v[16:19], v[72:75], v[12:15]
    v_add_u32 v159, 1, v159
    ds_write_b32 v160, v159 offset:21252
    v_and_b32_dpp v20, v24, v4 row_newbcast:12 row_mask:0xf bank_mask:0xf
    v_and_b32_dpp v21, v24, v5 row_newbcast:12 row_mask:0xf bank_mask:0xf
    v_and_b32_dpp v22, v24, v6 row_newbcast:12 row_mask:0xf bank_mask:0xf
    v_and_b32_dpp v23, v24, v7 row_newbcast:12 row_mask:0xf bank_mask:0xf
    s_waitcnt vmcnt(11)
    s_nop 0
    v_mfma_f32_16x16x32_bf16 v[12:15], v[20:23], v[76:79], v[12:15]
    v_add_u32 v159, 1, v159
    ds_write_b32 v160, v159 offset:21252
    v_and_b32_dpp v16, v24, v4 row_newbcast:2 row_mask:0xf bank_mask:0xf
    v_and_b32_dpp v17, v24, v5 row_newbcast:2 row_mask:0xf bank_mask:0xf
    v_and_b32_dpp v18, v24, v6 row_newbcast:2 row_mask:0xf bank_mask:0xf
    v_and_b32_dpp v19, v24, v7 row_newbcast:2 row_mask:0xf bank_mask:0xf
    s_waitcnt vmcnt(10)
    s_nop 0
    v_mfma_f32_16x16x32_bf16 v[12:15], v[16:19], v[80:83], v[12:15]
    v_add_u32 v159, 1, v159
    ds_write_b32 v160, v159 offset:21252
    v_and_b32_dpp v20, v24, v4 row_newbcast:10 row_mask:0xf bank_mask:0xf
    v_and_b32_dpp v21, v24, v5 row_newbcast:10 row_mask:0xf bank_mask:0xf
    v_and_b32_dpp v22, v24, v6 row_newbcast:10 row_mask:0xf bank_mask:0xf
    v_and_b32_dpp v23, v24, v7 row_newbcast:10 row_mask:0xf bank_mask:0xf
    s_waitcnt vmcnt(9)
    s_nop 0
    v_mfma_f32_16x16x32_bf16 v[12:15], v[20:23], v[84:87], v[12:15]
    v_add_u32 v159, 1, v159
    ds_write_b32 v160, v159 offset:21252
    v_and_b32_dpp v16, v24, v4 row_newbcast:6 row_mask:0xf bank_mask:0xf
    v_and_b32_dpp v17, v24, v5 row_newbcast:6 row_mask:0xf bank_mask:0xf
    v_and_b32_dpp v18, v24, v6 row_newbcast:6 row_mask:0xf bank_mask:0xf
    v_and_b32_dpp v19, v24, v7 row_newbcast:6 row_mask:0xf bank_mask:0xf
    s_waitcnt vmcnt(8)
    s_nop 0
    v_mfma_f32_16x16x32_bf16 v[12:15], v[16:19], v[88:91], v[12:15]
    v_add_u32 v159, 1, v159
    ds_write_b32 v160, v159 offset:21252
    v_and_b32_dpp v20, v24, v4 row_newbcast:14 row_mask:0xf bank_mask:0xf
    v_and_b32_dpp v21, v24, v5 row_newbcast:14 row_mask:0xf bank_mask:0xf
    v_and_b32_dpp v22, v24, v6 row_newbcast:14 row_mask:0xf bank_mask:0xf
    v_and_b32_dpp v23, v24, v7 row_newbcast:14 row_mask:0xf bank_mask:0xf
    s_waitcnt vmcnt(6)
    s_nop 0
    v_mfma_f32_16x16x32_bf16 v[12:15], v[20:23], v[92:95], v[12:15]
    s_cmp_gt_u32 s4, 30
    s_cbranch_scc1 L_sk76
    s_cmp_gt_u32 s4, 14
    s_cbranch_scc1 L_sk76m
    s_waitcnt vmcnt(3)
L_sk76m:
    s_waitcnt vmcnt(4)
L_sk76:
    v_xor_b32 v45, s80, v2
    buffer_load_dwordx4 v[120:123], v45, s[28:31], 0 offen nt
    s_xor_b32 s80, s101, 0x10900
    v_add_u32 v159, 1, v159
    ds_write_b32 v160, v159 offset:21252
    v_and_b32_dpp v16, v24, v4 row_newbcast:1 row_mask:0xf bank_mask:0xf
    v_and_b32_dpp v17, v24, v5 row_newbcast:1 row_mask:0xf bank_mask:0xf
    v_and_b32_dpp v18, v24, v6 row_newbcast:1 row_mask:0xf bank_mask:0xf
    v_and_b32_dpp v19, v24, v7 row_newbcast:1 row_mask:0xf bank_mask:0xf
    s_waitcnt vmcnt(6)
    s_nop 0
    v_mfma_f32_16x16x32_bf16 v[12:15], v[16:19], v[96:99], v[12:15]
    s_cmp_gt_u32 s4, 17
    s_cbranch_scc1 L_sk77
    s_cmp_gt_u32 s4, 1
    s_cbranch_scc1 L_sk77m
    s_waitcnt vmcnt(3)
L_sk77m:
    s_waitcnt vmcnt(4)
L_sk77:
    v_xor_b32 v45, s80, v2
    buffer_load_dwordx4 v[124:127], v45, s[28:31], 0 offen nt
    s_add_u32 s100, s100, 1
    v_readlane_b32 s101, v61, s100
    s_mov_b32 s80, s101
    v_add_u32 v159, 1, v159
    ds_write_b32 v160, v159 offset:21252
    v_and_b32_dpp v20, v24, v4 row_newbcast:9 row_mask:0xf bank_mask:0xf
    v_and_b32_dpp v21, v24, v5 row_newbcast:9 row_mask:0xf bank_mask:0xf
    v_and_b32_dpp v22, v24, v6 row_newbcast:9 row_mask:0xf bank_mask:0xf
    v_and_b32_dpp v23, v24, v7 row_newbcast:9 row_mask:0xf bank_mask:0xf
    s_waitcnt vmcnt(6)
    s_nop 0
    v_mfma_f32_16x16x32_bf16 v[12:15], v[20:23], v[100:103], v[12:15]
    s_cmp_gt_u32 s4, 25
    s_cbranch_scc1 L_sk78
    s_cmp_gt_u32 s4, 9
    s_cbranch_scc1 L_sk78m
    s_waitcnt vmcnt(3)
L_sk78m:
    s_waitcnt vmcnt(4)
L_sk78:
    v_xor_b32 v45, s80, v2
    buffer_load_dwordx4 v[64:67], v45, s[28:31], 0 offen nt
    s_xor_b32 s80, s101, 0x10100
    v_add_u32 v159, 1, v159
    ds_write_b32 v160, v159 offset:21252
    v_and_b32_dpp v16, v24, v4 row_newbcast:5 row_mask:0xf bank_mask:0xf
    v_and_b32_dpp v17, v24, v5 row_newbcast:5 row_mask:0xf bank_mask:0xf
    v_and_b32_dpp v18, v24, v6 row_newbcast:5 row_mask:0xf bank_mask:0xf
    v_and_b32_dpp v19, v24, v7 row_newbcast:5 row_mask:0xf bank_mask:0xf
    s_waitcnt vmcnt(6)
    s_nop 0
    v_mfma_f32_16x16x32_bf16 v[12:15], v[16:19], v[104:107], v[12:15]
    s_memrealtime s[94:95]
    s_cmp_gt_u32 s4, 21
    s_cbranch_scc1 L_sk79
    s_cmp_gt_u32 s4, 5
    s_cbranch_scc1 L_sk79m
    s_waitcnt vmcnt(3)
L_sk79m:
    s_waitcnt vmcnt(4)
L_sk79:
    v_xor_b32 v45, s80, v2
    buffer_load_dwordx4 v[68:71], v45, s[28:31], 0 offen nt
    s_xor_b32 s80, s101, 0x800
    v_add_u32 v159, 1, v159
    ds_write_b32 v160, v159 offset:21252
    v_and_b32_dpp v20, v24, v4 row_newbcast:13 row_mask:0xf bank_mask:0xf
    v_and_b32_dpp v21, v24, v5 row_newbcast:13 row_mask:0xf bank_mask:0xf
    v_and_b32_dpp v22, v24, v6 row_newbcast:13 row_mask:0xf bank_mask:0xf
    v_and_b32_dpp v23, v24, v7 row_newbcast:13 row_mask:0xf bank_mask:0xf
    s_waitcnt vmcnt(6)
    s_nop 0
    v_mfma_f32_16x16x32_bf16 v[12:15], v[20:23], v[108:111], v[12:15]
    s_waitcnt lgkmcnt(0)
    s_sub_u32 s79, s94, s99
    s_sub_u32 s79, s79, s98
    s_add_u32 s79, s79, s38
    s_sub_u32 s79, s79, 134
    s_and_b32 s79, s79, s97
    s_mul_i32 s79, s79, 3
    s_ashr_i32 s79, s79, 3
    s_ashr_i32 s7, s5, 5
    s_add_u32 s79, s79, s7
    s_add_u32 s79, s79, 43
    s_max_i32 s79, s79, 0
    s_min_i32 s79, s79, 64
    v_mov_b32 v157, s79
    ds_write_b32 v160, v157 offset:21248
    s_add_u32 s79, s79, 1
    s_lshr_b32 s4, s79, 1
    s_cmp_gt_u32 s4, 29
    s_cbranch_scc1 L_sk80
    s_cmp_gt_u32 s4, 13
    s_cbranch_scc1 L_sk80m
    s_waitcnt vmcnt(3)
L_sk80m:
    s_waitcnt vmcnt(4)
L_sk80:
    v_xor_b32 v45, s80, v2
    buffer_load_dwordx4 v[72:75], v45, s[28:31], 0 offen nt
    s_xor_b32 s80, s101, 0x10900
    v_add_u32 v159, 1, v159
    ds_write_b32 v160, v159 offset:21252
    v_and_b32_dpp v16, v24, v4 row_newbcast:3 row_mask:0xf bank_mask:0xf
    v_and_b32_dpp v17, v24, v5 row_newbcast:3 row_mask:0xf bank_mask:0xf
    v_and_b32_dpp v18, v24, v6 row_newbcast:3 row_mask:0xf bank_mask:0xf
    v_and_b32_dpp v19, v24, v7 row_newbcast:3 row_mask:0xf bank_mask:0xf
    s_waitcnt vmcnt(6)
    s_nop 0
    v_mfma_f32_16x16x32_bf16 v[12:15], v[16:19], v[112:115], v[12:15]
    s_memrealtime s[94:95]
    s_cmp_gt_u32 s4, 19
    s_cbranch_scc1 L_sk81
    s_cmp_gt_u32 s4, 3
    s_cbranch_scc1 L_sk81m
    s_waitcnt vmcnt(3)
L_sk81m:
    s_waitcnt vmcnt(4)
L_sk81:
    v_xor_b32 v45, s80, v2
    buffer_load_dwordx4 v[76:79], v45, s[28:31], 0 offen nt
    s_add_u32 s100, s100, 1
    v_readlane_b32 s101, v61, s100
    s_mov_b32 s80, s101
    v_add_u32 v159, 1, v159
    ds_write_b32 v160, v159 offset:21252
    v_and_b32_dpp v20, v24, v4 row_newbcast:11 row_mask:0xf bank_mask:0xf
    v_and_b32_dpp v21, v24, v5 row_newbcast:11 row_mask:0xf bank_mask:0xf
    v_and_b32_dpp v22, v24, v6 row_newbcast:11 row_mask:0xf bank_mask:0xf
    v_and_b32_dpp v23, v24, v7 row_newbcast:11 row_mask:0xf bank_mask:0xf
    s_waitcnt vmcnt(6)
    s_nop 0
    v_mfma_f32_16x16x32_bf16 v[12:15], v[20:23], v[116:119], v[12:15]
    s_waitcnt lgkmcnt(0)
    s_sub_u32 s79, s94, s99
    s_sub_u32 s79, s79, s98
    s_add_u32 s79, s79, s38
    s_sub_u32 s79, s79, 161
    s_and_b32 s79, s79, s97
    s_mul_i32 s79, s79, 3
    s_ashr_i32 s79, s79, 3
    s_ashr_i32 s7, s5, 5
    s_add_u32 s79, s79, s7
    s_add_u32 s79, s79, 43
    s_max_i32 s79, s79, 0
    s_min_i32 s79, s79, 64
    v_mov_b32 v157, s79
    ds_write_b32 v160, v157 offset:21248
    s_lshr_b32 s4, s79, 1
    s_cmp_gt_u32 s4, 27
    s_cbranch_scc1 L_sk82
    s_cmp_gt_u32 s4, 11
    s_cbranch_scc1 L_sk82m
    s_waitcnt vmcnt(3)
L_sk82m:
    s_waitcnt vmcnt(4)
L_sk82:
    v_xor_b32 v45, s80, v2
    buffer_load_dwordx4 v[80:83], v45, s[28:31], 0 offen nt
    s_xor_b32 s80, s101, 0x10100
    v_add_u32 v159, 1, v159
    ds_write_b32 v160, v159 offset:21252
    v_and_b32_dpp v16, v24, v4 row_newbcast:7 row_mask:0xf bank_mask:0xf
    v_and_b32_dpp v17, v24, v5 row_newbcast:7 row_mask:0xf bank_mask:0xf
    v_and_b32_dpp v18, v24, v6 row_newbcast:7 row_mask:0xf bank_mask:0xf
    v_and_b32_dpp v19, v24, v7 row_newbcast:7 row_mask:0xf bank_mask:0xf
    s_waitcnt vmcnt(6)
    s_nop 0
    v_mfma_f32_16x16x32_bf16 v[12:15], v[16:19], v[120:123], v[12:15]
    s_memrealtime s[94:95]
    s_cmp_gt_u32 s4, 23
    s_cbranch_scc1 L_sk83
    s_cmp_gt_u32 s4, 7
    s_cbranch_scc1 L_sk83m
    s_waitcnt vmcnt(3)
L_sk83m:
    s_waitcnt vmcnt(4)
L_sk83:
    v_xor_b32 v45, s80, v2
    buffer_load_dwordx4 v[84:87], v45, s[28:31], 0 offen nt
    s_xor_b32 s80, s101, 0x800
    v_add_u32 v159, 1, v159
    ds_write_b32 v160, v159 offset:21252
    v_and_b32_dpp v20, v24, v4 row_newbcast:15 row_mask:0xf bank_mask:0xf
    v_and_b32_dpp v21, v24, v5 row_newbcast:15 row_mask:0xf bank_mask:0xf
    v_and_b32_dpp v22, v24, v6 row_newbcast:15 row_mask:0xf bank_mask:0xf
    v_and_b32_dpp v23, v24, v7 row_newbcast:15 row_mask:0xf bank_mask:0xf
    s_waitcnt vmcnt(6)
    s_nop 0
    v_mfma_f32_16x16x32_bf16 v[12:15], v[20:23], v[124:127], v[12:15]
    s_waitcnt lgkmcnt(0)
    s_sub_u32 s79, s94, s99
    s_sub_u32 s79, s79, s98
    s_add_u32 s79, s79, s38
    s_sub_u32 s79, s79, 188
    s_and_b32 s79, s79, s97
    s_mul_i32 s79, s79, 3
    s_ashr_i32 s79, s79, 3
    s_ashr_i32 s7, s5, 5
    s_add_u32 s79, s79, s7
    s_add_u32 s79, s79, 43
    s_max_i32 s79, s79, 0
    s_min_i32 s79, s79, 64
    v_mov_b32 v157, s79
    ds_write_b32 v160, v157 offset:21248
    s_add_u32 s79, s79, 1
    s_lshr_b32 s4, s79, 1
    s_cmp_gt_u32 s4, 31
    s_cbranch_scc1 L_sk84
    s_cmp_gt_u32 s4, 15
    s_cbranch_scc1 L_sk84m
    s_waitcnt vmcnt(3)
L_sk84m:
    s_waitcnt vmcnt(4)
L_sk84:
    v_xor_b32 v45, s80, v2
    buffer_load_dwordx4 v[88:91], v45, s[28:31], 0 offen nt
    s_xor_b32 s80, s101, 0x10900
    v_add_u32 v159, 1, v159
    ds_write_b32 v160, v159 offset:21252
    s_add_u32 s77, s77, 1
    s_mov_b32 s81, 1
L_lpv1:
    s_waitcnt lgkmcnt(0)
    v_mov_b32 v40, v42
    ds_read_b32 v42, v44
    v_add_u32 v44, 256, v44
    v_and_b32_dpp v16, v40, v4 row_newbcast:0 row_mask:0xf bank_mask:0xf
    v_and_b32_dpp v17, v40, v5 row_newbcast:0 row_mask:0xf bank_mask:0xf
    v_and_b32_dpp v18, v40, v6 row_newbcast:0 row_mask:0xf bank_mask:0xf
    v_and_b32_dpp v19, v40, v7 row_newbcast:0 row_mask:0xf bank_mask:0xf
    s_waitcnt vmcnt(6)
    s_nop 0
    v_mfma_f32_16x16x32_bf16 v[12:15], v[16:19], v[64:67], v[12:15]
    s_mul_i32 s99, s77, 215
    s_memrealtime s[94:95]
    s_cmp_gt_u32 s4, 16
    s_cbranch_scc1 L_sk85
    s_cmp_gt_u32 s4, 0
    s_cbranch_scc1 L_sk85m
    s_waitcnt vmcnt(3)
L_sk85m:
    s_waitcnt vmcnt(4)
L_sk85:
    v_xor_b32 v45, s80, v2
    buffer_load_dwordx4 v[92:95], v45, s[28:31], 0 offen nt
    s_add_u32 s100, s100, 1
    v_readlane_b32 s101, v61, s100
    s_mov_b32 s80, s101
    v_add_u32 v159, 1, v159
    ds_write_b32 v160, v159 offset:21252
    v_and_b32_dpp v20, v40, v4 row_newbcast:8 row_mask:0xf bank_mask:0xf
    v_and_b32_dpp v21, v40, v5 row_newbcast:8 row_mask:0xf bank_mask:0xf
    v_and_b32_dpp v22, v40, v6 row_newbcast:8 row_mask:0xf bank_mask:0xf
    v_and_b32_dpp v23, v40, v7 row_newbcast:8 row_mask:0xf bank_mask:0xf
    s_waitcnt vmcnt(6)
    s_nop 0
    v_mfma_f32_16x16x32_bf16 v[12:15], v[20:23], v[68:71], v[12:15]
    s_waitcnt lgkmcnt(0)
    s_sub_u32 s79, s94, s99
    s_mov_b32 s96, s79
    v_mov_b32 v153, s79
    buffer_store_dword v153, v151, s[44:47], s25 offen
    s_sub_u32 s79, s79, s98
    s_add_u32 s79, s79, s38
    s_and_b32 s79, s79, s97
    s_max_i32 s7, s79, -40
    s_min_i32 s7, s7, 40
    s_add_u32 s5, s5, s7
    s_max_i32 s5, s5, -512
    s_min_i32 s5, s5, 512
    s_mul_i32 s79, s79, 3
    s_ashr_i32 s79, s79, 3
    s_ashr_i32 s7, s5, 5
    s_add_u32 s79, s79, s7
    s_add_u32 s79, s79, 43
    s_max_i32 s79, s79, 0
    s_min_i32 s79, s79, 64
    v_mov_b32 v157, s79
    ds_write_b32 v160, v157 offset:21248
    s_lshr_b32 s4, s79, 1
    s_cmp_gt_u32 s4, 24
    s_cbranch_scc1 L_sk86
    s_cmp_gt_u32 s4, 8
    s_cbranch_scc1 L_sk86m
    s_waitcnt vmcnt(4)
L_sk86m:
    s_waitcnt vmcnt(5)
L_sk86:
    v_xor_b32 v45, s80, v2
    buffer_load_dwordx4 v[96:99], v45, s[28:31], 0 offen nt
    s_xor_b32 s80, s101, 0x10100
    v_add_u32 v159, 1, v159
    ds_write_b32 v160, v159 offset:21252
    v_and_b32_dpp v16, v40, v4 row_newbcast:4 row_mask:0xf bank_mask:0xf
    v_and_b32_dpp v17, v40, v5 row_newbcast:4 row_mask:0xf bank_mask:0xf
    v_and_b32_dpp v18, v40, v6 row_newbcast:4 row_mask:0xf bank_mask:0xf
    v_and_b32_dpp v19, v40, v7 row_newbcast:4 row_mask:0xf bank_mask:0xf
    s_waitcnt vmcnt(7)
    s_nop 0
    v_mfma_f32_16x16x32_bf16 v[12:15], v[16:19], v[72:75], v[12:15]
    s_memrealtime s[94:95]
    s_and_b32 s7, s73, 7
    s_add_u32 s7, s7, 2
    s_cmp_lg_u32 s7, s81
    s_nop 2
    s_cbranch_scc1 L_nav12
    v_lshrrev_b32 v148, 1, v1
    v_mul_u32_u24 v148, 4224, v148
    v_and_b32 v149, 1, v1
    v_lshl_add_u32 v148, v149, 4, v148
    s_mov_b32 s7, 1388544
    buffer_load_dwordx4 v[144:147], v148, s[44:47], s7 offen sc1
L_nav12:
    s_cmp_gt_u32 s4, 20
    s_cbranch_scc1 L_sk87
    s_cmp_gt_u32 s4, 4
    s_cbranch_scc1 L_sk87m
    s_waitcnt vmcnt(4)
L_sk87m:
    s_waitcnt vmcnt(5)
L_sk87:
    v_xor_b32 v45, s80, v2
    buffer_load_dwordx4 v[100:103], v45, s[28:31], 0 offen nt
    s_xor_b32 s80, s101, 0x800
    v_add_u32 v159, 1, v159
    ds_write_b32 v160, v159 offset:21252
    v_and_b32_dpp v20, v40, v4 row_newbcast:12 row_mask:0xf bank_mask:0xf
    v_and_b32_dpp v21, v40, v5 row_newbcast:12 row_mask:0xf bank_mask:0xf
    v_and_b32_dpp v22, v40, v6 row_newbcast:12 row_mask:0xf bank_mask:0xf
    v_and_b32_dpp v23, v40, v7 row_newbcast:12 row_mask:0xf bank_mask:0xf
    s_waitcnt vmcnt(7)
    s_nop 0
    v_mfma_f32_16x16x32_bf16 v[12:15], v[20:23], v[76:79], v[12:15]
    s_waitcnt lgkmcnt(0)
    s_sub_u32 s79, s94, s99
    s_sub_u32 s79, s79, s98
    s_add_u32 s79, s79, s38
    s_sub_u32 s79, s79, 26
    s_and_b32 s79, s79, s97
    s_mul_i32 s79, s79, 3
    s_ashr_i32 s79, s79, 3
    s_ashr_i32 s7, s5, 5
    s_add_u32 s79, s79, s7
    s_add_u32 s79, s79, 43
    s_max_i32 s79, s79, 0
    s_min_i32 s79, s79, 64
    v_mov_b32 v157, s79
    ds_write_b32 v160, v157 offset:21248
    s_add_u32 s79, s79, 1
    s_lshr_b32 s4, s79, 1
    s_cmp_gt_u32 s4, 28
    s_cbranch_scc1 L_sk88
    s_cmp_gt_u32 s4, 12
    s_cbranch_scc1 L_sk88m
    s_waitcnt vmcnt(4)
L_sk88m:
    s_waitcnt vmcnt(5)
L_sk88:
    v_xor_b32 v45, s80, v2
    buffer_load_dwordx4 v[104:107], v45, s[28:31], 0 offen nt
    s_xor_b32 s80, s101, 0x10900
    v_add_u32 v159, 1, v159
    ds_write_b32 v160, v159 offset:21252
    v_and_b32_dpp v16, v40, v4 row_newbcast:2 row_mask:0xf bank_mask:0xf
    v_and_b32_dpp v17, v40, v5 row_newbcast:2 row_mask:0xf bank_mask:0xf
    v_and_b32_dpp v18, v40, v6 row_newbcast:2 row_mask:0xf bank_mask:0xf
    v_and_b32_dpp v19, v40, v7 row_newbcast:2 row_mask:0xf bank_mask:0xf
    s_waitcnt vmcnt(7)
    s_nop 0
    v_mfma_f32_16x16x32_bf16 v[12:15], v[16:19], v[80:83], v[12:15]
    buffer_load_dword v154, v150, s[44:47], s24 offen sc1
    s_memrealtime s[94:95]
    s_cmp_gt_u32 s4, 18
    s_cbranch_scc1 L_sk89
    s_cmp_gt_u32 s4, 2
    s_cbranch_scc1 L_sk89m
    s_waitcnt vmcnt(5)
L_sk89m:
    s_waitcnt vmcnt(6)
L_sk89:
    v_xor_b32 v45, s80, v2
    buffer_load_dwordx4 v[108:111], v45, s[28:31], 0 offen nt
    s_add_u32 s100, s100, 1
    v_readlane_b32 s101, v61, s100
    s_mov_b32 s80, s101
    v_add_u32 v159, 1, v159
    ds_write_b32 v160, v159 offset:21252
    v_and_b32_dpp v20, v40, v4 row_newbcast:10 row_mask:0xf bank_mask:0xf
    v_and_b32_dpp v21, v40, v5 row_newbcast:10 row_mask:0xf bank_mask:0xf
    v_and_b32_dpp v22, v40, v6 row_newbcast:10 row_mask:0xf bank_mask:0xf
    v_and_b32_dpp v23, v40, v7 row_newbcast:10 row_mask:0xf bank_mask:0xf
    s_waitcnt vmcnt(8)
    s_nop 0
    v_mfma_f32_16x16x32_bf16 v[12:15], v[20:23], v[84:87], v[12:15]
    s_waitcnt lgkmcnt(0)
    s_sub_u32 s79, s94, s99
    s_sub_u32 s79, s79, s98
    s_add_u32 s79, s79, s38
    s_sub_u32 s79, s79, 53
    s_and_b32 s79, s79, s97
    s_mul_i32 s79, s79, 3
    s_ashr_i32 s79, s79, 3
    s_ashr_i32 s7, s5, 5
    s_add_u32 s79, s79, s7
    s_add_u32 s79, s79, 43
    s_max_i32 s79, s79, 0
    s_min_i32 s79, s79, 64
    v_mov_b32 v157, s79
    ds_write_b32 v160, v157 offset:21248
    s_lshr_b32 s4, s79, 1
    s_cmp_gt_u32 s4, 26
    s_cbranch_scc1 L_sk90
    s_cmp_gt_u32 s4, 10
    s_cbranch_scc1 L_sk90m
    s_waitcnt vmcnt(4)
L_sk90m:
    s_waitcnt vmcnt(6)
L_sk90:
    v_xor_b32 v45, s80, v2
    buffer_load_dwordx4 v[112:115], v45, s[28:31], 0 offen nt
    s_xor_b32 s80, s101, 0x10100
    v_add_u32 v159, 1, v159
    ds_write_b32 v160, v159 offset:21252
    v_and_b32_dpp v16, v40, v4 row_newbcast:6 row_mask:0xf bank_mask:0xf
    v_and_b32_dpp v17, v40, v5 row_newbcast:6 row_mask:0xf bank_mask:0xf
    v_and_b32_dpp v18, v40, v6 row_newbcast:6 row_mask:0xf bank_mask:0xf
    v_and_b32_dpp v19, v40, v7 row_newbcast:6 row_mask:0xf bank_mask:0xf
    s_waitcnt vmcnt(8)
    s_nop 0
    v_mfma_f32_16x16x32_bf16 v[12:15], v[16:19], v[88:91], v[12:15]
    s_memrealtime s[94:95]
    s_cmp_gt_u32 s4, 22
    s_cbranch_scc1 L_sk91
    s_cmp_gt_u32 s4, 6
    s_cbranch_scc1 L_sk91m
    s_waitcnt vmcnt(4)
L_sk91m:
    s_waitcnt vmcnt(5)
L_sk91:
    v_xor_b32 v45, s80, v2
    buffer_load_dwordx4 v[116:119], v45, s[28:31], 0 offen nt
    s_xor_b32 s80, s101, 0x800
    v_add_u32 v159, 1, v159
    ds_write_b32 v160, v159 offset:21252
    v_and_b32_dpp v20, v40, v4 row_newbcast:14 row_mask:0xf bank_mask:0xf
    v_and_b32_dpp v21, v40, v5 row_newbcast:14 row_mask:0xf bank_mask:0xf
    v_and_b32_dpp v22, v40, v6 row_newbcast:14 row_mask:0xf bank_mask:0xf
    v_and_b32_dpp v23, v40, v7 row_newbcast:14 row_mask:0xf bank_mask:0xf
    s_waitcnt vmcnt(8)
    s_nop 0
    v_mfma_f32_16x16x32_bf16 v[12:15], v[20:23], v[92:95], v[12:15]
    s_waitcnt lgkmcnt(0)
    s_sub_u32 s79, s94, s99
    s_sub_u32 s79, s79, s98
    s_add_u32 s79, s79, s38
    s_sub_u32 s79, s79, 80
    s_and_b32 s79, s79, s97
    s_mul_i32 s79, s79, 3
    s_ashr_i32 s79, s79, 3
    s_ashr_i32 s7, s5, 5
    s_add_u32 s79, s79, s7
    s_add_u32 s79, s79, 43
    s_max_i32 s79, s79, 0
    s_min_i32 s79, s79, 64
    v_mov_b32 v157, s79
    ds_write_b32 v160, v157 offset:21248
    s_add_u32 s79, s79, 1
    s_lshr_b32 s4, s79, 1
    s_cmp_gt_u32 s4, 30
    s_cbranch_scc1 L_sk92
    s_cmp_gt_u32 s4, 14
    s_cbranch_scc1 L_sk92m
    s_waitcnt vmcnt(4)
L_sk92m:
    s_waitcnt vmcnt(5)
L_sk92:
    v_xor_b32 v45, s80, v2
    buffer_load_dwordx4 v[120:123], v45, s[28:31], 0 offen nt
    s_xor_b32 s80, s101, 0x10900
    v_add_u32 v159, 1, v159
    ds_write_b32 v160, v159 offset:21252
    v_and_b32_dpp v16, v40, v4 row_newbcast:1 row_mask:0xf bank_mask:0xf
    v_and_b32_dpp v17, v40, v5 row_newbcast:1 row_mask:0xf bank_mask:0xf
    v_and_b32_dpp v18, v40, v6 row_newbcast:1 row_mask:0xf bank_mask:0xf
    v_and_b32_dpp v19, v40, v7 row_newbcast:1 row_mask:0xf bank_mask:0xf
    s_waitcnt vmcnt(7)
    s_nop 0
    v_mfma_f32_16x16x32_bf16 v[12:15], v[16:19], v[96:99], v[12:15]
    s_memrealtime s[94:95]
    s_cmp_gt_u32 s4, 17
    s_cbranch_scc1 L_sk93
    s_cmp_gt_u32 s4, 1
    s_cbranch_scc1 L_sk93m
    s_waitcnt vmcnt(3)
L_sk93m:
    s_waitcnt vmcnt(5)
L_sk93:
    v_xor_b32 v45, s80, v2
    buffer_load_dwordx4 v[124:127], v45, s[28:31], 0 offen nt
    s_add_u32 s100, s100, 1
    v_readlane_b32 s101, v61, s100
    s_mov_b32 s80, s101
    v_add_u32 v159, 1, v159
    ds_write_b32 v160, v159 offset:21252
    v_and_b32_dpp v20, v40, v4 row_newbcast:9 row_mask:0xf bank_mask:0xf
    v_and_b32_dpp v21, v40, v5 row_newbcast:9 row_mask:0xf bank_mask:0xf
    v_and_b32_dpp v22, v40, v6 row_newbcast:9 row_mask:0xf bank_mask:0xf
    v_and_b32_dpp v23, v40, v7 row_newbcast:9 row_mask:0xf bank_mask:0xf
    s_waitcnt vmcnt(7)
    s_nop 0
    v_mfma_f32_16x16x32_bf16 v[12:15], v[20:23], v[100:103], v[12:15]
    s_waitcnt lgkmcnt(0)
    s_sub_u32 s79, s94, s99
    s_sub_u32 s79, s79, s98
    s_add_u32 s79, s79, s38
    s_sub_u32 s79, s79, 107
    s_and_b32 s79, s79, s97
    s_mul_i32 s79, s79, 3
    s_ashr_i32 s79, s79, 3
    s_ashr_i32 s7, s5, 5
    s_add_u32 s79, s79, s7
    s_add_u32 s79, s79, 43
    s_max_i32 s79, s79, 0
    s_min_i32 s79, s79, 64
    v_mov_b32 v157, s79
    ds_write_b32 v160, v157 offset:21248
    s_lshr_b32 s4, s79, 1
    s_cmp_gt_u32 s4, 25
    s_cbranch_scc1 L_sk94
    s_cmp_gt_u32 s4, 9
    s_cbranch_scc1 L_sk94m
    s_waitcnt vmcnt(3)
L_sk94m:
    s_waitcnt vmcnt(4)
L_sk94:
    v_xor_b32 v45, s80, v2
    buffer_load_dwordx4 v[64:67], v45, s[28:31], 0 offen nt
    s_xor_b32 s80, s101, 0x10100
    v_add_u32 v159, 1, v159
    ds_write_b32 v160, v159 offset:21252
    v_and_b32_dpp v16, v40, v4 row_newbcast:5 row_mask:0xf bank_mask:0xf
    v_and_b32_dpp v17, v40, v5 row_newbcast:5 row_mask:0xf bank_mask:0xf
    v_and_b32_dpp v18, v40, v6 row_newbcast:5 row_mask:0xf bank_mask:0xf
    v_and_b32_dpp v19, v40, v7 row_newbcast:5 row_mask:0xf bank_mask:0xf
    s_waitcnt vmcnt(7)
    s_nop 0
    v_mfma_f32_16x16x32_bf16 v[12:15], v[16:19], v[104:107], v[12:15]
    s_memrealtime s[94:95]
    s_and_b32 s7, s73, 7
    s_add_u32 s7, s7, 2
    s_cmp_lg_u32 s7, s81
    s_nop 2
    s_cbranch_scc1 L_nav110
    s_mov_b32 s79, 0x8000
    s_mov_b32 s7, 1388544
L_afchkv1:
    v_and_b32 v144, v144, v145
    v_and_b32 v146, v146, v147
    v_and_b32 v144, v144, v146
    v_cmp_ne_u32 vcc, 1, v144
    s_nop 3
    s_cbranch_vccz L_nav110
    s_sleep 8
    buffer_load_dwordx4 v[144:147], v148, s[44:47], s7 offen sc1
    s_waitcnt vmcnt(0)
    s_sub_u32 s79, s79, 1
    s_cmp_lg_u32 s79, 0
    s_cbranch_scc1 L_afchkv1
L_nav110:
    s_cmp_gt_u32 s4, 21
    s_cbranch_scc1 L_sk95
    s_cmp_gt_u32 s4, 5
    s_cbranch_scc1 L_sk95m
    s_waitcnt vmcnt(3)
L_sk95m:
    s_waitcnt vmcnt(4)
L_sk95:
    v_xor_b32 v45, s80, v2
    buffer_load_dwordx4 v[68:71], v45, s[28:31], 0 offen nt
    s_xor_b32 s80, s101, 0x800
    v_add_u32 v159, 1, v159
    ds_write_b32 v160, v159 offset:21252
    v_and_b32_dpp v20, v40, v4 row_newbcast:13 row_mask:0xf bank_mask:0xf
    v_and_b32_dpp v21, v40, v5 row_newbcast:13 row_mask:0xf bank_mask:0xf
    v_and_b32_dpp v22, v40, v6 row_newbcast:13 row_mask:0xf bank_mask:0xf
    v_and_b32_dpp v23, v40, v7 row_newbcast:13 row_mask:0xf bank_mask:0xf
    s_waitcnt vmcnt(6)
    s_nop 0
    v_mfma_f32_16x16x32_bf16 v[12:15], v[20:23], v[108:111], v[12:15]
    s_waitcnt lgkmcnt(0)
    s_sub_u32 s79, s94, s99
    s_sub_u32 s79, s79, s98
    s_add_u32 s79, s79, s38
    s_sub_u32 s79, s79, 134
    s_and_b32 s79, s79, s97
    s_mul_i32 s79, s79, 3
    s_ashr_i32 s79, s79, 3
    s_ashr_i32 s7, s5, 5
    s_add_u32 s79, s79, s7
    s_add_u32 s79, s79, 43
    s_max_i32 s79, s79, 0
    s_min_i32 s79, s79, 64
    v_mov_b32 v157, s79
    ds_write_b32 v160, v157 offset:21248
    s_add_u32 s79, s79, 1
    s_lshr_b32 s4, s79, 1
    s_cmp_gt_u32 s4, 29
    s_cbranch_scc1 L_sk96
    s_cmp_gt_u32 s4, 13
    s_cbranch_scc1 L_sk96m
    s_waitcnt vmcnt(3)
L_sk96m:
    s_waitcnt vmcnt(4)
L_sk96:
    v_xor_b32 v45, s80, v2
    buffer_load_dwordx4 v[72:75], v45, s[28:31], 0 offen nt
    s_xor_b32 s80, s101, 0x10900
    v_add_u32 v159, 1, v159
    ds_write_b32 v160, v159 offset:21252
    v_and_b32_dpp v16, v40, v4 row_newbcast:3 row_mask:0xf bank_mask:0xf
    v_and_b32_dpp v17, v40, v5 row_newbcast:3 row_mask:0xf bank_mask:0xf
    v_and_b32_dpp v18, v40, v6 row_newbcast:3 row_mask:0xf bank_mask:0xf
    v_and_b32_dpp v19, v40, v7 row_newbcast:3 row_mask:0xf bank_mask:0xf
    s_waitcnt vmcnt(6)
    s_nop 0
    v_mfma_f32_16x16x32_bf16 v[12:15], v[16:19], v[112:115], v[12:15]
    v_readlane_b32 s7, v154, 32
    s_cmp_eq_u32 s7, -1
    s_cselect_b32 s98, s98, s7
    s_sub_u32 s7, s98, s38
    v_mov_b32 v154, s7
    ds_write_b32 v160, v154 offset:21256
    s_memrealtime s[94:95]
    s_cmp_gt_u32 s4, 19
    s_cbranch_scc1 L_sk97
    s_cmp_gt_u32 s4, 3
    s_cbranch_scc1 L_sk97m
    s_waitcnt vmcnt(3)
L_sk97m:
    s_waitcnt vmcnt(4)
L_sk97:
    v_xor_b32 v45, s80, v2
    buffer_load_dwordx4 v[76:79], v45, s[28:31], 0 offen nt
    s_add_u32 s100, s100, 1
    v_readlane_b32 s101, v61, s100
    s_mov_b32 s80, s101
    v_add_u32 v159, 1, v159
    ds_write_b32 v160, v159 offset:21252
    v_and_b32_dpp v20, v40, v4 row_newbcast:11 row_mask:0xf bank_mask:0xf
    v_and_b32_dpp v21, v40, v5 row_newbcast:11 row_mask:0xf bank_mask:0xf
    v_and_b32_dpp v22, v40, v6 row_newbcast:11 row_mask:0xf bank_mask:0xf
    v_and_b32_dpp v23, v40, v7 row_newbcast:11 row_mask:0xf bank_mask:0xf
    s_waitcnt vmcnt(6)
    s_nop 0
    v_mfma_f32_16x16x32_bf16 v[12:15], v[20:23], v[116:119], v[12:15]
    s_waitcnt lgkmcnt(0)
    s_sub_u32 s79, s94, s99
    s_sub_u32 s79, s79, s98
    s_add_u32 s79, s79, s38
    s_sub_u32 s79, s79, 161
    s_and_b32 s79, s79, s97
    s_mul_i32 s79, s79, 3
    s_ashr_i32 s79, s79, 3
    s_ashr_i32 s7, s5, 5
    s_add_u32 s79, s79, s7
    s_add_u32 s79, s79, 43
    s_max_i32 s79, s79, 0
    s_min_i32 s79, s79, 64
    v_mov_b32 v157, s79
    ds_write_b32 v160, v157 offset:21248
    s_lshr_b32 s4, s79, 1
    s_cmp_gt_u32 s4, 27
    s_cbranch_scc1 L_sk98
    s_cmp_gt_u32 s4, 11
    s_cbranch_scc1 L_sk98m
    s_waitcnt vmcnt(3)
L_sk98m:
    s_waitcnt vmcnt(4)
L_sk98:
    v_xor_b32 v45, s80, v2
    buffer_load_dwordx4 v[80:83], v45, s[28:31], 0 offen nt
    s_xor_b32 s80, s101, 0x10100
    v_add_u32 v159, 1, v159
    ds_write_b32 v160, v159 offset:21252
    v_and_b32_dpp v16, v40, v4 row_newbcast:7 row_mask:0xf bank_mask:0xf
    v_and_b32_dpp v17, v40, v5 row_newbcast:7 row_mask:0xf bank_mask:0xf
    v_and_b32_dpp v18, v40, v6 row_newbcast:7 row_mask:0xf bank_mask:0xf
    v_and_b32_dpp v19, v40, v7 row_newbcast:7 row_mask:0xf bank_mask:0xf
    s_waitcnt vmcnt(6)
    s_nop 0
    v_mfma_f32_16x16x32_bf16 v[12:15], v[16:19], v[120:123], v[12:15]
    s_memrealtime s[94:95]
    s_cmp_gt_u32 s4, 23
    s_cbranch_scc1 L_sk99
    s_cmp_gt_u32 s4, 7
    s_cbranch_scc1 L_sk99m
    s_waitcnt vmcnt(3)
L_sk99m:
    s_waitcnt vmcnt(4)
L_sk99:
    v_xor_b32 v45, s80, v2
    buffer_load_dwordx4 v[84:87], v45, s[28:31], 0 offen nt
    s_xor_b32 s80, s101, 0x800
    v_add_u32 v159, 1, v159
    ds_write_b32 v160, v159 offset:21252
    v_and_b32_dpp v20, v40, v4 row_newbcast:15 row_mask:0xf bank_mask:0xf
    v_and_b32_dpp v21, v40, v5 row_newbcast:15 row_mask:0xf bank_mask:0xf
    v_and_b32_dpp v22, v40, v6 row_newbcast:15 row_mask:0xf bank_mask:0xf
    v_and_b32_dpp v23, v40, v7 row_newbcast:15 row_mask:0xf bank_mask:0xf
    s_waitcnt vmcnt(6)
    s_nop 0
    v_mfma_f32_16x16x32_bf16 v[12:15], v[20:23], v[124:127], v[12:15]
    s_waitcnt lgkmcnt(0)
    s_sub_u32 s79, s94, s99
    s_sub_u32 s79, s79, s98
    s_add_u32 s79, s79, s38
    s_sub_u32 s79, s79, 188
    s_and_b32 s79, s79, s97
    s_mul_i32 s79, s79, 3
    s_ashr_i32 s79, s79, 3
    s_ashr_i32 s7, s5, 5
    s_add_u32 s79, s79, s7
    s_add_u32 s79, s79, 43
    s_max_i32 s79, s79, 0
    s_min_i32 s79, s79, 64
    v_mov_b32 v157, s79
    ds_write_b32 v160, v157 offset:21248
    s_add_u32 s79, s79, 1
    s_lshr_b32 s4, s79, 1
    s_cmp_gt_u32 s4, 31
    s_cbranch_scc1 L_sk100
    s_cmp_gt_u32 s4, 15
    s_cbranch_scc1 L_sk100m
    s_waitcnt vmcnt(3)
L_sk100m:
    s_waitcnt vmcnt(4)
L_sk100:
    v_xor_b32 v45, s80, v2
    buffer_load_dwordx4 v[88:91], v45, s[28:31], 0 offen nt
    s_xor_b32 s80, s101, 0x10900
    v_add_u32 v159, 1, v159
    ds_write_b32 v160, v159 offset:21252
    s_add_u32 s77, s77, 1
    s_add_u32 s81, s81, 1
    s_cmp_lt_u32 s81, 15
    s_cbranch_scc1 L_lpv1
    s_branch L_vend
L_v0:
    v_and_b32_dpp v16, v24, v4 row_newbcast:0 row_mask:0xf bank_mask:0xf
    v_and_b32_dpp v17, v24, v5 row_newbcast:0 row_mask:0xf bank_mask:0xf
    v_and_b32_dpp v18, v24, v6 row_newbcast:0 row_mask:0xf bank_mask:0xf
    v_and_b32_dpp v19, v24, v7 row_newbcast:0 row_mask:0xf bank_mask:0xf
    s_waitcnt vmcnt(14)
    s_nop 0
    v_mfma_f32_16x16x32_bf16 v[12:15], v[16:19], v[64:67], 0
    ds_read_b64 v[162:163], v160 offset:21248
    v_and_b32_dpp v20, v24, v4 row_newbcast:8 row_mask:0xf bank_mask:0xf
    v_and_b32_dpp v21, v24, v5 row_newbcast:8 row_mask:0xf bank_mask:0xf
    v_and_b32_dpp v22, v24, v6 row_newbcast:8 row_mask:0xf bank_mask:0xf
    v_and_b32_dpp v23, v24, v7 row_newbcast:8 row_mask:0xf bank_mask:0xf
    s_waitcnt vmcnt(13)
    s_nop 0
    v_mfma_f32_16x16x32_bf16 v[12:15], v[20:23], v[68:71], v[12:15]
    s_waitcnt lgkmcnt(0)
    v_readfirstlane_b32 s4, v162
    v_readfirstlane_b32 s79, v163
    s_lshl_b32 s7, s77, 4
    s_sub_u32 s79, s79, s7
    s_mul_i32 s79, s79, 4
    s_add_u32 s4, s4, s79
    s_max_i32 s4, s4, 0
    s_min_i32 s4, s4, 64
    s_lshr_b32 s4, s4, 1
    v_and_b32_dpp v16, v24, v4 row_newbcast:4 row_mask:0xf bank_mask:0xf
    v_and_b32_dpp v17, v24, v5 row_newbcast:4 row_mask:0xf bank_mask:0xf
    v_and_b32_dpp v18, v24, v6 row_newbcast:4 row_mask:0xf bank_mask:0xf
    v_and_b32_dpp v19, v24, v7 row_newbcast:4 row_mask:0xf bank_mask:0xf
    s_waitcnt vmcnt(12)
    s_nop 0
    v_mfma_f32_16x16x32_bf16 v[12:15], v[16:19], v[72:75], v[12:15]
    ds_read_b64 v[162:163], v160 offset:21248
    v_and_b32_dpp v20, v24, v4 row_newbcast:12 row_mask:0xf bank_mask:0xf
    v_and_b32_dpp v21, v24, v5 row_newbcast:12 row_mask:0xf bank_mask:0xf
    v_and_b32_dpp v22, v24, v6 row_newbcast:12 row_mask:0xf bank_mask:0xf
    v_and_b32_dpp v23, v24, v7 row_newbcast:12 row_mask:0xf bank_mask:0xf
    s_waitcnt vmcnt(11)
    s_nop 0
    v_mfma_f32_16x16x32_bf16 v[12:15], v[20:23], v[76:79], v[12:15]
    s_waitcnt lgkmcnt(0)
    v_readfirstlane_b32 s4, v162
    v_readfirstlane_b32 s79, v163
    s_lshl_b32 s7, s77, 4
    s_sub_u32 s79, s79, s7
    s_sub_u32 s79, s79, 2
    s_mul_i32 s79, s79, 4
    s_add_u32 s4, s4, s79
    s_max_i32 s4, s4, 0
    s_min_i32 s4, s4, 64
    s_add_u32 s4, s4, 1
    s_lshr_b32 s4, s4, 1
    v_and_b32_dpp v16, v24, v4 row_newbcast:2 row_mask:0xf bank_mask:0xf
    v_and_b32_dpp v17, v24, v5 row_newbcast:2 row_mask:0xf bank_mask:0xf
    v_and_b32_dpp v18, v24, v6 row_newbcast:2 row_mask:0xf bank_mask:0xf
    v_and_b32_dpp v19, v24, v7 row_newbcast:2 row_mask:0xf bank_mask:0xf
    s_waitcnt vmcnt(10)
    s_nop 0
    v_mfma_f32_16x16x32_bf16 v[12:15], v[16:19], v[80:83], v[12:15]
    ds_read_b64 v[162:163], v160 offset:21248
    v_and_b32_dpp v20, v24, v4 row_newbcast:10 row_mask:0xf bank_mask:0xf
    v_and_b32_dpp v21, v24, v5 row_newbcast:10 row_mask:0xf bank_mask:0xf
    v_and_b32_dpp v22, v24, v6 row_newbcast:10 row_mask:0xf bank_mask:0xf
    v_and_b32_dpp v23, v24, v7 row_newbcast:10 row_mask:0xf bank_mask:0xf
    s_waitcnt vmcnt(9)
    s_nop 0
    v_mfma_f32_16x16x32_bf16 v[12:15], v[20:23], v[84:87], v[12:15]
    s_waitcnt lgkmcnt(0)
    v_readfirstlane_b32 s4, v162
    v_readfirstlane_b32 s79, v163
    s_lshl_b32 s7, s77, 4
    s_sub_u32 s79, s79, s7
    s_sub_u32 s79, s79, 4
    s_mul_i32 s79, s79, 4
    s_add_u32 s4, s4, s79
    s_max_i32 s4, s4, 0
    s_min_i32 s4, s4, 64
    s_lshr_b32 s4, s4, 1
    v_and_b32_dpp v16, v24, v4 row_newbcast:6 row_mask:0xf bank_mask:0xf
    v_and_b32_dpp v17, v24, v5 row_newbcast:6 row_mask:0xf bank_mask:0xf
    v_and_b32_dpp v18, v24, v6 row_newbcast:6 row_mask:0xf bank_mask:0xf
    v_and_b32_dpp v19, v24, v7 row_newbcast:6 row_mask:0xf bank_mask:0xf
    s_waitcnt vmcnt(8)
    s_nop 0
    v_mfma_f32_16x16x32_bf16 v[12:15], v[16:19], v[88:91], v[12:15]
    ds_read_b64 v[162:163], v160 offset:21248
    v_and_b32_dpp v20, v24, v4 row_newbcast:14 row_mask:0xf bank_mask:0xf
    v_and_b32_dpp v21, v24, v5 row_newbcast:14 row_mask:0xf bank_mask:0xf
    v_and_b32_dpp v22, v24, v6 row_newbcast:14 row_mask:0xf bank_mask:0xf
    v_and_b32_dpp v23, v24, v7 row_newbcast:14 row_mask:0xf bank_mask:0xf
    s_waitcnt vmcnt(6)
    s_nop 0
    v_mfma_f32_16x16x32_bf16 v[12:15], v[20:23], v[92:95], v[12:15]
    s_waitcnt lgkmcnt(0)
    v_readfirstlane_b32 s4, v162
    v_readfirstlane_b32 s79, v163
    s_lshl_b32 s7, s77, 4
    s_sub_u32 s79, s79, s7
    s_sub_u32 s79, s79, 6
    s_mul_i32 s79, s79, 4
    s_add_u32 s4, s4, s79
    s_max_i32 s4, s4, 0
    s_min_i32 s4, s4, 64
    s_add_u32 s4, s4, 1
    s_lshr_b32 s4, s4, 1
    s_cmp_gt_u32 s4, 30
    s_cbranch_scc1 L_sk101
    s_cmp_gt_u32 s4, 14
    s_cbranch_scc1 L_sk101m
    s_waitcnt vmcnt(3)
L_sk101m:
    s_waitcnt vmcnt(4)
L_sk101:
    v_xor_b32 v45, s80, v2
    buffer_load_dwordx4 v[120:123], v45, s[28:31], 0 offen nt
    s_xor_b32 s80, s101, 0x10900
    v_and_b32_dpp v16, v24, v4 row_newbcast:1 row_mask:0xf bank_mask:0xf
    v_and_b32_dpp v17, v24, v5 row_newbcast:1 row_mask:0xf bank_mask:0xf
    v_and_b32_dpp v18, v24, v6 row_newbcast:1 row_mask:0xf bank_mask:0xf
    v_and_b32_dpp v19, v24, v7 row_newbcast:1 row_mask:0xf bank_mask:0xf
    s_waitcnt vmcnt(6)
    s_nop 0
    v_mfma_f32_16x16x32_bf16 v[12:15], v[16:19], v[96:99], v[12:15]
    ds_read_b64 v[162:163], v160 offset:21248
    s_cmp_gt_u32 s4, 17
    s_cbranch_scc1 L_sk102
    s_cmp_gt_u32 s4, 1
    s_cbranch_scc1 L_sk102m
    s_waitcnt vmcnt(3)
L_sk102m:
    s_waitcnt vmcnt(4)
L_sk102:
    v_xor_b32 v45, s80, v2
    buffer_load_dwordx4 v[124:127], v45, s[28:31], 0 offen nt
    s_add_u32 s100, s100, 1
    v_readlane_b32 s101, v61, s100
    s_mov_b32 s80, s101
    v_and_b32_dpp v20, v24, v4 row_newbcast:9 row_mask:0xf bank_mask:0xf
    v_and_b32_dpp v21, v24, v5 row_newbcast:9 row_mask:0xf bank_mask:0xf
    v_and_b32_dpp v22, v24, v6 row_newbcast:9 row_mask:0xf bank_mask:0xf
    v_and_b32_dpp v23, v24, v7 row_newbcast:9 row_mask:0xf bank_mask:0xf
    s_waitcnt vmcnt(6)
    s_nop 0
    v_mfma_f32_16x16x32_bf16 v[12:15], v[20:23], v[100:103], v[12:15]
    s_waitcnt lgkmcnt(0)
    v_readfirstlane_b32 s4, v162
    v_readfirstlane_b32 s79, v163
    s_lshl_b32 s7, s77, 4
    s_sub_u32 s79, s79, s7
    s_sub_u32 s79, s79, 8
    s_mul_i32 s79, s79, 4
    s_add_u32 s4, s4, s79
    s_max_i32 s4, s4, 0
    s_min_i32 s4, s4, 64
    s_lshr_b32 s4, s4, 1
    s_cmp_gt_u32 s4, 25
    s_cbranch_scc1 L_sk103
    s_cmp_gt_u32 s4, 9
    s_cbranch_scc1 L_sk103m
    s_waitcnt vmcnt(3)
L_sk103m:
    s_waitcnt vmcnt(4)
L_sk103:
    v_xor_b32 v45, s80, v2
    buffer_load_dwordx4 v[64:67], v45, s[28:31], 0 offen nt
    s_xor_b32 s80, s101, 0x10100
    v_and_b32_dpp v16, v24, v4 row_newbcast:5 row_mask:0xf bank_mask:0xf
    v_and_b32_dpp v17, v24, v5 row_newbcast:5 row_mask:0xf bank_mask:0xf
    v_and_b32_dpp v18, v24, v6 row_newbcast:5 row_mask:0xf bank_mask:0xf
    v_and_b32_dpp v19, v24, v7 row_newbcast:5 row_mask:0xf bank_mask:0xf
    s_waitcnt vmcnt(6)
    s_nop 0
    v_mfma_f32_16x16x32_bf16 v[12:15], v[16:19], v[104:107], v[12:15]
    ds_read_b64 v[162:163], v160 offset:21248
    s_cmp_gt_u32 s4, 21
    s_cbranch_scc1 L_sk104
    s_cmp_gt_u32 s4, 5
    s_cbranch_scc1 L_sk104m
    s_waitcnt vmcnt(3)
L_sk104m:
    s_waitcnt vmcnt(4)
L_sk104:
    v_xor_b32 v45, s80, v2
    buffer_load_dwordx4 v[68:71], v45, s[28:31], 0 offen nt
    s_xor_b32 s80, s101, 0x800
    v_and_b32_dpp v20, v24, v4 row_newbcast:13 row_mask:0xf bank_mask:0xf
    v_and_b32_dpp v21, v24, v5 row_newbcast:13 row_mask:0xf bank_mask:0xf
    v_and_b32_dpp v22, v24, v6 row_newbcast:13 row_mask:0xf bank_mask:0xf
    v_and_b32_dpp v23, v24, v7 row_newbcast:13 row_mask:0xf bank_mask:0xf
    s_waitcnt vmcnt(6)
    s_nop 0
    v_mfma_f32_16x16x32_bf16 v[12:15], v[20:23], v[108:111], v[12:15]
    s_waitcnt lgkmcnt(0)
    v_readfirstlane_b32 s4, v162
    v_readfirstlane_b32 s79, v163
    s_lshl_b32 s7, s77, 4
    s_sub_u32 s79, s79, s7
    s_sub_u32 s79, s79, 10
    s_mul_i32 s79, s79, 4
    s_add_u32 s4, s4, s79
    s_max_i32 s4, s4, 0
    s_min_i32 s4, s4, 64
    s_add_u32 s4, s4, 1
    s_lshr_b32 s4, s4, 1
    s_cmp_gt_u32 s4, 29
    s_cbranch_scc1 L_sk105
    s_cmp_gt_u32 s4, 13
    s_cbranch_scc1 L_sk105m
    s_waitcnt vmcnt(3)
L_sk105m:
    s_waitcnt vmcnt(4)
L_sk105:
    v_xor_b32 v45, s80, v2
    buffer_load_dwordx4 v[72:75], v45, s[28:31], 0 offen nt
    s_xor_b32 s80, s101, 0x10900
    v_and_b32_dpp v16, v24, v4 row_newbcast:3 row_mask:0xf bank_mask:0xf
    v_and_b32_dpp v17, v24, v5 row_newbcast:3 row_mask:0xf bank_mask:0xf
    v_and_b32_dpp v18, v24, v6 row_newbcast:3 row_mask:0xf bank_mask:0xf
    v_and_b32_dpp v19, v24, v7 row_newbcast:3 row_mask:0xf bank_mask:0xf
    s_waitcnt vmcnt(6)
    s_nop 0
    v_mfma_f32_16x16x32_bf16 v[12:15], v[16:19], v[112:115], v[12:15]
    ds_read_b64 v[162:163], v160 offset:21248
    s_cmp_gt_u32 s4, 19
    s_cbranch_scc1 L_sk106
    s_cmp_gt_u32 s4, 3
    s_cbranch_scc1 L_sk106m
    s_waitcnt vmcnt(3)
L_sk106m:
    s_waitcnt vmcnt(4)
L_sk106:
    v_xor_b32 v45, s80, v2
    buffer_load_dwordx4 v[76:79], v45, s[28:31], 0 offen nt
    s_add_u32 s100, s100, 1
    v_readlane_b32 s101, v61, s100
    s_mov_b32 s80, s101
    v_and_b32_dpp v20, v24, v4 row_newbcast:11 row_mask:0xf bank_mask:0xf
    v_and_b32_dpp v21, v24, v5 row_newbcast:11 row_mask:0xf bank_mask:0xf
    v_and_b32_dpp v22, v24, v6 row_newbcast:11 row_mask:0xf bank_mask:0xf
    v_and_b32_dpp v23, v24, v7 row_newbcast:11 row_mask:0xf bank_mask:0xf
    s_waitcnt vmcnt(6)
    s_nop 0
    v_mfma_f32_16x16x32_bf16 v[12:15], v[20:23], v[116:119], v[12:15]
    s_waitcnt lgkmcnt(0)
    v_readfirstlane_b32 s4, v162
    v_readfirstlane_b32 s79, v163
    s_lshl_b32 s7, s77, 4
    s_sub_u32 s79, s79, s7
    s_sub_u32 s79, s79, 12
    s_mul_i32 s79, s79, 4
    s_add_u32 s4, s4, s79
    s_max_i32 s4, s4, 0
    s_min_i32 s4, s4, 64
    s_lshr_b32 s4, s4, 1
    s_cmp_gt_u32 s4, 27
    s_cbranch_scc1 L_sk107
    s_cmp_gt_u32 s4, 11
    s_cbranch_scc1 L_sk107m
    s_waitcnt vmcnt(3)
L_sk107m:
    s_waitcnt vmcnt(4)
L_sk107:
    v_xor_b32 v45, s80, v2
    buffer_load_dwordx4 v[80:83], v45, s[28:31], 0 offen nt
    s_xor_b32 s80, s101, 0x10100
    v_and_b32_dpp v16, v24, v4 row_newbcast:7 row_mask:0xf bank_mask:0xf
    v_and_b32_dpp v17, v24, v5 row_newbcast:7 row_mask:0xf bank_mask:0xf
    v_and_b32_dpp v18, v24, v6 row_newbcast:7 row_mask:0xf bank_mask:0xf
    v_and_b32_dpp v19, v24, v7 row_newbcast:7 row_mask:0xf bank_mask:0xf
    s_waitcnt vmcnt(6)
    s_nop 0
    v_mfma_f32_16x16x32_bf16 v[12:15], v[16:19], v[120:123], v[12:15]
    ds_read_b64 v[162:163], v160 offset:21248
    s_cmp_gt_u32 s4, 23
    s_cbranch_scc1 L_sk108
    s_cmp_gt_u32 s4, 7
    s_cbranch_scc1 L_sk108m
    s_waitcnt vmcnt(3)
L_sk108m:
    s_waitcnt vmcnt(4)
L_sk108:
    v_xor_b32 v45, s80, v2
    buffer_load_dwordx4 v[84:87], v45, s[28:31], 0 offen nt
    s_xor_b32 s80, s101, 0x800
    v_and_b32_dpp v20, v24, v4 row_newbcast:15 row_mask:0xf bank_mask:0xf
    v_and_b32_dpp v21, v24, v5 row_newbcast:15 row_mask:0xf bank_mask:0xf
    v_and_b32_dpp v22, v24, v6 row_newbcast:15 row_mask:0xf bank_mask:0xf
    v_and_b32_dpp v23, v24, v7 row_newbcast:15 row_mask:0xf bank_mask:0xf
    s_waitcnt vmcnt(6)
    s_nop 0
    v_mfma_f32_16x16x32_bf16 v[12:15], v[20:23], v[124:127], v[12:15]
    s_waitcnt lgkmcnt(0)
    v_readfirstlane_b32 s4, v162
    v_readfirstlane_b32 s79, v163
    s_lshl_b32 s7, s77, 4
    s_sub_u32 s79, s79, s7
    s_sub_u32 s79, s79, 14
    s_mul_i32 s79, s79, 4
    s_add_u32 s4, s4, s79
    s_max_i32 s4, s4, 0
    s_min_i32 s4, s4, 64
    s_add_u32 s4, s4, 1
    s_lshr_b32 s4, s4, 1
    s_cmp_gt_u32 s4, 31
    s_cbranch_scc1 L_sk109
    s_cmp_gt_u32 s4, 15
    s_cbranch_scc1 L_sk109m
    s_waitcnt vmcnt(3)
L_sk109m:
    s_waitcnt vmcnt(4)
L_sk109:
    v_xor_b32 v45, s80, v2
    buffer_load_dwordx4 v[88:91], v45, s[28:31], 0 offen nt
    s_xor_b32 s80, s101, 0x10900
    s_add_u32 s77, s77, 1
    s_mov_b32 s81, 1
L_lpv0:
    s_waitcnt lgkmcnt(0)
    v_mov_b32 v40, v42
    ds_read_b32 v42, v44
    v_add_u32 v44, 256, v44
    v_and_b32_dpp v16, v40, v4 row_newbcast:0 row_mask:0xf bank_mask:0xf
    v_and_b32_dpp v17, v40, v5 row_newbcast:0 row_mask:0xf bank_mask:0xf
    v_and_b32_dpp v18, v40, v6 row_newbcast:0 row_mask:0xf bank_mask:0xf
    v_and_b32_dpp v19, v40, v7 row_newbcast:0 row_mask:0xf bank_mask:0xf
    s_waitcnt vmcnt(6)
    s_nop 0
    v_mfma_f32_16x16x32_bf16 v[12:15], v[16:19], v[64:67], v[12:15]
    ds_read_b64 v[162:163], v160 offset:21248
    s_cmp_gt_u32 s4, 16
    s_cbranch_scc1 L_sk110
    s_cmp_gt_u32 s4, 0
    s_cbranch_scc1 L_sk110m
    s_waitcnt vmcnt(3)
L_sk110m:
    s_waitcnt vmcnt(4)
L_sk110:
    v_xor_b32 v45, s80, v2
    buffer_load_dwordx4 v[92:95], v45, s[28:31], 0 offen nt
    s_add_u32 s100, s100, 1
    v_readlane_b32 s101, v61, s100
    s_mov_b32 s80, s101
    v_and_b32_dpp v20, v40, v4 row_newbcast:8 row_mask:0xf bank_mask:0xf
    v_and_b32_dpp v21, v40, v5 row_newbcast:8 row_mask:0xf bank_mask:0xf
    v_and_b32_dpp v22, v40, v6 row_newbcast:8 row_mask:0xf bank_mask:0xf
    v_and_b32_dpp v23, v40, v7 row_newbcast:8 row_mask:0xf bank_mask:0xf
    s_waitcnt vmcnt(6)
    s_nop 0
    v_mfma_f32_16x16x32_bf16 v[12:15], v[20:23], v[68:71], v[12:15]
    s_waitcnt lgkmcnt(0)
    v_readfirstlane_b32 s4, v162
    v_readfirstlane_b32 s79, v163
    s_lshl_b32 s7, s77, 4
    s_sub_u32 s79, s79, s7
    s_mul_i32 s79, s79, 4
    s_add_u32 s4, s4, s79
    s_max_i32 s4, s4, 0
    s_min_i32 s4, s4, 64
    s_lshr_b32 s4, s4, 1
    s_cmp_gt_u32 s4, 24
    s_cbranch_scc1 L_sk111
    s_cmp_gt_u32 s4, 8
    s_cbranch_scc1 L_sk111m
    s_waitcnt vmcnt(3)
L_sk111m:
    s_waitcnt vmcnt(4)
L_sk111:
    v_xor_b32 v45, s80, v2
    buffer_load_dwordx4 v[96:99], v45, s[28:31], 0 offen nt
    s_xor_b32 s80, s101, 0x10100
    v_and_b32_dpp v16, v40, v4 row_newbcast:4 row_mask:0xf bank_mask:0xf
    v_and_b32_dpp v17, v40, v5 row_newbcast:4 row_mask:0xf bank_mask:0xf
    v_and_b32_dpp v18, v40, v6 row_newbcast:4 row_mask:0xf bank_mask:0xf
    v_and_b32_dpp v19, v40, v7 row_newbcast:4 row_mask:0xf bank_mask:0xf
    s_waitcnt vmcnt(6)
    s_nop 0
    v_mfma_f32_16x16x32_bf16 v[12:15], v[16:19], v[72:75], v[12:15]
    ds_read_b64 v[162:163], v160 offset:21248
    s_cmp_gt_u32 s4, 20
    s_cbranch_scc1 L_sk112
    s_cmp_gt_u32 s4, 4
    s_cbranch_scc1 L_sk112m
    s_waitcnt vmcnt(3)
L_sk112m:
    s_waitcnt vmcnt(4)
L_sk112:
    v_xor_b32 v45, s80, v2
    buffer_load_dwordx4 v[100:103], v45, s[28:31], 0 offen nt
    s_xor_b32 s80, s101, 0x800
    v_and_b32_dpp v20, v40, v4 row_newbcast:12 row_mask:0xf bank_mask:0xf
    v_and_b32_dpp v21, v40, v5 row_newbcast:12 row_mask:0xf bank_mask:0xf
    v_and_b32_dpp v22, v40, v6 row_newbcast:12 row_mask:0xf bank_mask:0xf
    v_and_b32_dpp v23, v40, v7 row_newbcast:12 row_mask:0xf bank_mask:0xf
    s_waitcnt vmcnt(6)
    s_nop 0
    v_mfma_f32_16x16x32_bf16 v[12:15], v[20:23], v[76:79], v[12:15]
    s_waitcnt lgkmcnt(0)
    v_readfirstlane_b32 s4, v162
    v_readfirstlane_b32 s79, v163
    s_lshl_b32 s7, s77, 4
    s_sub_u32 s79, s79, s7
    s_sub_u32 s79, s79, 2
    s_mul_i32 s79, s79, 4
    s_add_u32 s4, s4, s79
    s_max_i32 s4, s4, 0
    s_min_i32 s4, s4, 64
    s_add_u32 s4, s4, 1
    s_lshr_b32 s4, s4, 1
    s_cmp_gt_u32 s4, 28
    s_cbranch_scc1 L_sk113
    s_cmp_gt_u32 s4, 12
    s_cbranch_scc1 L_sk113m
    s_waitcnt vmcnt(3)
L_sk113m:
    s_waitcnt vmcnt(4)
L_sk113:
    v_xor_b32 v45, s80, v2
    buffer_load_dwordx4 v[104:107], v45, s[28:31], 0 offen nt
    s_xor_b32 s80, s101, 0x10900
    v_and_b32_dpp v16, v40, v4 row_newbcast:2 row_mask:0xf bank_mask:0xf
    v_and_b32_dpp v17, v40, v5 row_newbcast:2 row_mask:0xf bank_mask:0xf
    v_and_b32_dpp v18, v40, v6 row_newbcast:2 row_mask:0xf bank_mask:0xf
    v_and_b32_dpp v19, v40, v7 row_newbcast:2 row_mask:0xf bank_mask:0xf
    s_waitcnt vmcnt(6)
    s_nop 0
    v_mfma_f32_16x16x32_bf16 v[12:15], v[16:19], v[80:83], v[12:15]
    ds_read_b64 v[162:163], v160 offset:21248
    s_cmp_gt_u32 s4, 18
    s_cbranch_scc1 L_sk114
    s_cmp_gt_u32 s4, 2
    s_cbranch_scc1 L_sk114m
    s_waitcnt vmcnt(3)
L_sk114m:
    s_waitcnt vmcnt(4)
L_sk114:
    v_xor_b32 v45, s80, v2
    buffer_load_dwordx4 v[108:111], v45, s[28:31], 0 offen nt
    s_add_u32 s100, s100, 1
    v_readlane_b32 s101, v61, s100
    s_mov_b32 s80, s101
    v_and_b32_dpp v20, v40, v4 row_newbcast:10 row_mask:0xf bank_mask:0xf
    v_and_b32_dpp v21, v40, v5 row_newbcast:10 row_mask:0xf bank_mask:0xf
    v_and_b32_dpp v22, v40, v6 row_newbcast:10 row_mask:0xf bank_mask:0xf
    v_and_b32_dpp v23, v40, v7 row_newbcast:10 row_mask:0xf bank_mask:0xf
    s_waitcnt vmcnt(6)
    s_nop 0
    v_mfma_f32_16x16x32_bf16 v[12:15], v[20:23], v[84:87], v[12:15]
    s_waitcnt lgkmcnt(0)
    v_readfirstlane_b32 s4, v162
    v_readfirstlane_b32 s79, v163
    s_lshl_b32 s7, s77, 4
    s_sub_u32 s79, s79, s7
    s_sub_u32 s79, s79, 4
    s_mul_i32 s79, s79, 4
    s_add_u32 s4, s4, s79
    s_max_i32 s4, s4, 0
    s_min_i32 s4, s4, 64
    s_lshr_b32 s4, s4, 1
    s_cmp_gt_u32 s4, 26
    s_cbranch_scc1 L_sk115
    s_cmp_gt_u32 s4, 10
    s_cbranch_scc1 L_sk115m
    s_waitcnt vmcnt(3)
L_sk115m:
    s_waitcnt vmcnt(4)
L_sk115:
    v_xor_b32 v45, s80, v2
    buffer_load_dwordx4 v[112:115], v45, s[28:31], 0 offen nt
    s_xor_b32 s80, s101, 0x10100
    v_and_b32_dpp v16, v40, v4 row_newbcast:6 row_mask:0xf bank_mask:0xf
    v_and_b32_dpp v17, v40, v5 row_newbcast:6 row_mask:0xf bank_mask:0xf
    v_and_b32_dpp v18, v40, v6 row_newbcast:6 row_mask:0xf bank_mask:0xf
    v_and_b32_dpp v19, v40, v7 row_newbcast:6 row_mask:0xf bank_mask:0xf
    s_waitcnt vmcnt(6)
    s_nop 0
    v_mfma_f32_16x16x32_bf16 v[12:15], v[16:19], v[88:91], v[12:15]
    ds_read_b64 v[162:163], v160 offset:21248
    s_cmp_gt_u32 s4, 22
    s_cbranch_scc1 L_sk116
    s_cmp_gt_u32 s4, 6
    s_cbranch_scc1 L_sk116m
    s_waitcnt vmcnt(3)
L_sk116m:
    s_waitcnt vmcnt(4)
L_sk116:
    v_xor_b32 v45, s80, v2
    buffer_load_dwordx4 v[116:119], v45, s[28:31], 0 offen nt
    s_xor_b32 s80, s101, 0x800
    v_and_b32_dpp v20, v40, v4 row_newbcast:14 row_mask:0xf bank_mask:0xf
    v_and_b32_dpp v21, v40, v5 row_newbcast:14 row_mask:0xf bank_mask:0xf
    v_and_b32_dpp v22, v40, v6 row_newbcast:14 row_mask:0xf bank_mask:0xf
    v_and_b32_dpp v23, v40, v7 row_newbcast:14 row_mask:0xf bank_mask:0xf
    s_waitcnt vmcnt(6)
    s_nop 0
    v_mfma_f32_16x16x32_bf16 v[12:15], v[20:23], v[92:95], v[12:15]
    s_waitcnt lgkmcnt(0)
    v_readfirstlane_b32 s4, v162
    v_readfirstlane_b32 s79, v163
    s_lshl_b32 s7, s77, 4
    s_sub_u32 s79, s79, s7
    s_sub_u32 s79, s79, 6
    s_mul_i32 s79, s79, 4
    s_add_u32 s4, s4, s79
    s_max_i32 s4, s4, 0
    s_min_i32 s4, s4, 64
    s_add_u32 s4, s4, 1
    s_lshr_b32 s4, s4, 1
    s_cmp_gt_u32 s4, 30
    s_cbranch_scc1 L_sk117
    s_cmp_gt_u32 s4, 14
    s_cbranch_scc1 L_sk117m
    s_waitcnt vmcnt(3)
L_sk117m:
    s_waitcnt vmcnt(4)
L_sk117:
    v_xor_b32 v45, s80, v2
    buffer_load_dwordx4 v[120:123], v45, s[28:31], 0 offen nt
    s_xor_b32 s80, s101, 0x10900
    v_and_b32_dpp v16, v40, v4 row_newbcast:1 row_mask:0xf bank_mask:0xf
    v_and_b32_dpp v17, v40, v5 row_newbcast:1 row_mask:0xf bank_mask:0xf
    v_and_b32_dpp v18, v40, v6 row_newbcast:1 row_mask:0xf bank_mask:0xf
    v_and_b32_dpp v19, v40, v7 row_newbcast:1 row_mask:0xf bank_mask:0xf
    s_waitcnt vmcnt(6)
    s_nop 0
    v_mfma_f32_16x16x32_bf16 v[12:15], v[16:19], v[96:99], v[12:15]
    ds_read_b64 v[162:163], v160 offset:21248
    s_cmp_gt_u32 s4, 17
    s_cbranch_scc1 L_sk118
    s_cmp_gt_u32 s4, 1
    s_cbranch_scc1 L_sk118m
    s_waitcnt vmcnt(3)
L_sk118m:
    s_waitcnt vmcnt(4)
L_sk118:
    v_xor_b32 v45, s80, v2
    buffer_load_dwordx4 v[124:127], v45, s[28:31], 0 offen nt
    s_add_u32 s100, s100, 1
    v_readlane_b32 s101, v61, s100
    s_mov_b32 s80, s101
    v_and_b32_dpp v20, v40, v4 row_newbcast:9 row_mask:0xf bank_mask:0xf
    v_and_b32_dpp v21, v40, v5 row_newbcast:9 row_mask:0xf bank_mask:0xf
    v_and_b32_dpp v22, v40, v6 row_newbcast:9 row_mask:0xf bank_mask:0xf
    v_and_b32_dpp v23, v40, v7 row_newbcast:9 row_mask:0xf bank_mask:0xf
    s_waitcnt vmcnt(6)
    s_nop 0
    v_mfma_f32_16x16x32_bf16 v[12:15], v[20:23], v[100:103], v[12:15]
    s_waitcnt lgkmcnt(0)
    v_readfirstlane_b32 s4, v162
    v_readfirstlane_b32 s79, v163
    s_lshl_b32 s7, s77, 4
    s_sub_u32 s79, s79, s7
    s_sub_u32 s79, s79, 8
    s_mul_i32 s79, s79, 4
    s_add_u32 s4, s4, s79
    s_max_i32 s4, s4, 0
    s_min_i32 s4, s4, 64
    s_lshr_b32 s4, s4, 1
    s_cmp_gt_u32 s4, 25
    s_cbranch_scc1 L_sk119
    s_cmp_gt_u32 s4, 9
    s_cbranch_scc1 L_sk119m
    s_waitcnt vmcnt(3)
L_sk119m:
    s_waitcnt vmcnt(4)
L_sk119:
    v_xor_b32 v45, s80, v2
    buffer_load_dwordx4 v[64:67], v45, s[28:31], 0 offen nt
    s_xor_b32 s80, s101, 0x10100
    v_and_b32_dpp v16, v40, v4 row_newbcast:5 row_mask:0xf bank_mask:0xf
    v_and_b32_dpp v17, v40, v5 row_newbcast:5 row_mask:0xf bank_mask:0xf
    v_and_b32_dpp v18, v40, v6 row_newbcast:5 row_mask:0xf bank_mask:0xf
    v_and_b32_dpp v19, v40, v7 row_newbcast:5 row_mask:0xf bank_mask:0xf
    s_waitcnt vmcnt(6)
    s_nop 0
    v_mfma_f32_16x16x32_bf16 v[12:15], v[16:19], v[104:107], v[12:15]
    ds_read_b64 v[162:163], v160 offset:21248
    s_cmp_gt_u32 s4, 21
    s_cbranch_scc1 L_sk120
    s_cmp_gt_u32 s4, 5
    s_cbranch_scc1 L_sk120m
    s_waitcnt vmcnt(3)
L_sk120m:
    s_waitcnt vmcnt(4)
L_sk120:
    v_xor_b32 v45, s80, v2
    buffer_load_dwordx4 v[68:71], v45, s[28:31], 0 offen nt
    s_xor_b32 s80, s101, 0x800
    v_and_b32_dpp v20, v40, v4 row_newbcast:13 row_mask:0xf bank_mask:0xf
    v_and_b32_dpp v21, v40, v5 row_newbcast:13 row_mask:0xf bank_mask:0xf
    v_and_b32_dpp v22, v40, v6 row_newbcast:13 row_mask:0xf bank_mask:0xf
    v_and_b32_dpp v23, v40, v7 row_newbcast:13 row_mask:0xf bank_mask:0xf
    s_waitcnt vmcnt(6)
    s_nop 0
    v_mfma_f32_16x16x32_bf16 v[12:15], v[20:23], v[108:111], v[12:15]
    s_waitcnt lgkmcnt(0)
    v_readfirstlane_b32 s4, v162
    v_readfirstlane_b32 s79, v163
    s_lshl_b32 s7, s77, 4
    s_sub_u32 s79, s79, s7
    s_sub_u32 s79, s79, 10
    s_mul_i32 s79, s79, 4
    s_add_u32 s4, s4, s79
    s_max_i32 s4, s4, 0
    s_min_i32 s4, s4, 64
    s_add_u32 s4, s4, 1
    s_lshr_b32 s4, s4, 1
    s_cmp_gt_u32 s4, 29
    s_cbranch_scc1 L_sk121
    s_cmp_gt_u32 s4, 13
    s_cbranch_scc1 L_sk121m
    s_waitcnt vmcnt(3)
L_sk121m:
    s_waitcnt vmcnt(4)
L_sk121:
    v_xor_b32 v45, s80, v2
    buffer_load_dwordx4 v[72:75], v45, s[28:31], 0 offen nt
    s_xor_b32 s80, s101, 0x10900
    v_and_b32_dpp v16, v40, v4 row_newbcast:3 row_mask:0xf bank_mask:0xf
    v_and_b32_dpp v17, v40, v5 row_newbcast:3 row_mask:0xf bank_mask:0xf
    v_and_b32_dpp v18, v40, v6 row_newbcast:3 row_mask:0xf bank_mask:0xf
    v_and_b32_dpp v19, v40, v7 row_newbcast:3 row_mask:0xf bank_mask:0xf
    s_waitcnt vmcnt(6)
    s_nop 0
    v_mfma_f32_16x16x32_bf16 v[12:15], v[16:19], v[112:115], v[12:15]
    ds_read_b64 v[162:163], v160 offset:21248
    s_cmp_gt_u32 s4, 19
    s_cbranch_scc1 L_sk122
    s_cmp_gt_u32 s4, 3
    s_cbranch_scc1 L_sk122m
    s_waitcnt vmcnt(3)
L_sk122m:
    s_waitcnt vmcnt(4)
L_sk122:
    v_xor_b32 v45, s80, v2
    buffer_load_dwordx4 v[76:79], v45, s[28:31], 0 offen nt
    s_add_u32 s100, s100, 1
    v_readlane_b32 s101, v61, s100
    s_mov_b32 s80, s101
    v_and_b32_dpp v20, v40, v4 row_newbcast:11 row_mask:0xf bank_mask:0xf
    v_and_b32_dpp v21, v40, v5 row_newbcast:11 row_mask:0xf bank_mask:0xf
    v_and_b32_dpp v22, v40, v6 row_newbcast:11 row_mask:0xf bank_mask:0xf
    v_and_b32_dpp v23, v40, v7 row_newbcast:11 row_mask:0xf bank_mask:0xf
    s_waitcnt vmcnt(6)
    s_nop 0
    v_mfma_f32_16x16x32_bf16 v[12:15], v[20:23], v[116:119], v[12:15]
    s_waitcnt lgkmcnt(0)
    v_readfirstlane_b32 s4, v162
    v_readfirstlane_b32 s79, v163
    s_lshl_b32 s7, s77, 4
    s_sub_u32 s79, s79, s7
    s_sub_u32 s79, s79, 12
    s_mul_i32 s79, s79, 4
    s_add_u32 s4, s4, s79
    s_max_i32 s4, s4, 0
    s_min_i32 s4, s4, 64
    s_lshr_b32 s4, s4, 1
    s_cmp_gt_u32 s4, 27
    s_cbranch_scc1 L_sk123
    s_cmp_gt_u32 s4, 11
    s_cbranch_scc1 L_sk123m
    s_waitcnt vmcnt(3)
L_sk123m:
    s_waitcnt vmcnt(4)
L_sk123:
    v_xor_b32 v45, s80, v2
    buffer_load_dwordx4 v[80:83], v45, s[28:31], 0 offen nt
    s_xor_b32 s80, s101, 0x10100
    v_and_b32_dpp v16, v40, v4 row_newbcast:7 row_mask:0xf bank_mask:0xf
    v_and_b32_dpp v17, v40, v5 row_newbcast:7 row_mask:0xf bank_mask:0xf
    v_and_b32_dpp v18, v40, v6 row_newbcast:7 row_mask:0xf bank_mask:0xf
    v_and_b32_dpp v19, v40, v7 row_newbcast:7 row_mask:0xf bank_mask:0xf
    s_waitcnt vmcnt(6)
    s_nop 0
    v_mfma_f32_16x16x32_bf16 v[12:15], v[16:19], v[120:123], v[12:15]
    ds_read_b64 v[162:163], v160 offset:21248
    s_cmp_gt_u32 s4, 23
    s_cbranch_scc1 L_sk124
    s_cmp_gt_u32 s4, 7
    s_cbranch_scc1 L_sk124m
    s_waitcnt vmcnt(3)
L_sk124m:
    s_waitcnt vmcnt(4)
L_sk124:
    v_xor_b32 v45, s80, v2
    buffer_load_dwordx4 v[84:87], v45, s[28:31], 0 offen nt
    s_xor_b32 s80, s101, 0x800
    v_and_b32_dpp v20, v40, v4 row_newbcast:15 row_mask:0xf bank_mask:0xf
    v_and_b32_dpp v21, v40, v5 row_newbcast:15 row_mask:0xf bank_mask:0xf
    v_and_b32_dpp v22, v40, v6 row_newbcast:15 row_mask:0xf bank_mask:0xf
    v_and_b32_dpp v23, v40, v7 row_newbcast:15 row_mask:0xf bank_mask:0xf
    s_waitcnt vmcnt(6)
    s_nop 0
    v_mfma_f32_16x16x32_bf16 v[12:15], v[20:23], v[124:127], v[12:15]
    s_waitcnt lgkmcnt(0)
    v_readfirstlane_b32 s4, v162
    v_readfirstlane_b32 s79, v163
    s_lshl_b32 s7, s77, 4
    s_sub_u32 s79, s79, s7
    s_sub_u32 s79, s79, 14
    s_mul_i32 s79, s79, 4
    s_add_u32 s4, s4, s79
    s_max_i32 s4, s4, 0
    s_min_i32 s4, s4, 64
    s_add_u32 s4, s4, 1
    s_lshr_b32 s4, s4, 1
    s_cmp_gt_u32 s4, 31
    s_cbranch_scc1 L_sk125
    s_cmp_gt_u32 s4, 15
    s_cbranch_scc1 L_sk125m
    s_waitcnt vmcnt(3)
L_sk125m:
    s_waitcnt vmcnt(4)
L_sk125:
    v_xor_b32 v45, s80, v2
    buffer_load_dwordx4 v[88:91], v45, s[28:31], 0 offen nt
    s_xor_b32 s80, s101, 0x10900
    s_add_u32 s77, s77, 1
    s_add_u32 s81, s81, 1
    s_cmp_lt_u32 s81, 15
    s_cbranch_scc1 L_lpv0
L_vend:
    ds_read_b32 v154, v160 offset:21256
    s_waitcnt lgkmcnt(0)
    v_mov_b32 v40, v42
    v_readfirstlane_b32 s98, v154
    s_cmp_eq_u32 s3, 0
    s_cselect_b32 s7, s25, 2130706432
    v_and_b32_dpp v16, v40, v4 row_newbcast:0 row_mask:0xf bank_mask:0xf
    v_and_b32_dpp v17, v40, v5 row_newbcast:0 row_mask:0xf bank_mask:0xf
    v_and_b32_dpp v18, v40, v6 row_newbcast:0 row_mask:0xf bank_mask:0xf
    v_and_b32_dpp v19, v40, v7 row_newbcast:0 row_mask:0xf bank_mask:0xf
    s_waitcnt vmcnt(6)
    s_nop 0
    v_mfma_f32_16x16x32_bf16 v[12:15], v[16:19], v[64:67], v[12:15]
    s_memrealtime s[94:95]
    s_cmp_gt_u32 s4, 16
    s_cbranch_scc1 L_sk126
    s_cmp_gt_u32 s4, 0
    s_cbranch_scc1 L_sk126m
    s_waitcnt vmcnt(3)
L_sk126m:
    s_waitcnt vmcnt(4)
L_sk126:
    v_xor_b32 v45, s80, v2
    buffer_load_dwordx4 v[92:95], v45, s[28:31], 0 offen nt
    s_add_u32 s100, s100, 1
    v_readlane_b32 s101, v61, s100
    s_mov_b32 s80, s101
    v_and_b32_dpp v20, v40, v4 row_newbcast:8 row_mask:0xf bank_mask:0xf
    v_and_b32_dpp v21, v40, v5 row_newbcast:8 row_mask:0xf bank_mask:0xf
    v_and_b32_dpp v22, v40, v6 row_newbcast:8 row_mask:0xf bank_mask:0xf
    v_and_b32_dpp v23, v40, v7 row_newbcast:8 row_mask:0xf bank_mask:0xf
    v_lshlrev_b32 v57, 5, v47
    v_and_b32 v59, 1, v46
    v_lshl_add_u32 v57, v59, 4, v57
    v_lshrrev_b32 v59, 1, v46
    v_lshl_add_u32 v58, v59, 9, v57
    s_lshl_b32 s14, s3, 10
    v_add_u32 v58, s14, v58
    s_lshl_b32 s14, s3, 9
    v_add_u32 v57, s14, v57
    s_waitcnt vmcnt(6)
    v_mfma_f32_16x16x32_bf16 v[12:15], v[20:23], v[68:71], v[12:15]
    s_waitcnt lgkmcnt(0)
    s_sub_u32 s79, s94, s98
    s_sub_u32 s79, s79, 6665
    s_mul_i32 s79, s79, 8
    s_ashr_i32 s79, s79, 4
    s_add_u32 s79, s79, 21
    s_max_i32 s79, s79, 0
    s_min_i32 s4, s79, 32
    s_cmp_gt_u32 s4, 24
    s_cbranch_scc1 L_sk127
    s_cmp_gt_u32 s4, 8
    s_cbranch_scc1 L_sk127m
    s_waitcnt vmcnt(3)
L_sk127m:
    s_waitcnt vmcnt(4)
L_sk127:
    v_xor_b32 v45, s80, v2
    buffer_load_dwordx4 v[96:99], v45, s[28:31], 0 offen nt
    s_xor_b32 s80, s101, 0x10100
    v_and_b32_dpp v16, v40, v4 row_newbcast:4 row_mask:0xf bank_mask:0xf
    v_and_b32_dpp v17, v40, v5 row_newbcast:4 row_mask:0xf bank_mask:0xf
    v_and_b32_dpp v18, v40, v6 row_newbcast:4 row_mask:0xf bank_mask:0xf
    v_and_b32_dpp v19, v40, v7 row_newbcast:4 row_mask:0xf bank_mask:0xf
    v_mov_b32 v54, 2130706432
    v_lshlrev_b32 v56, 4, v1
    v_add_u32 v53, 93184, v56
    v_cmp_gt_u32 vcc, 32, v1
    s_nop 1
    v_cndmask_b32 v55, v54, v57, vcc
    v_cndmask_b32 v57, v53, v57, vcc
    v_and_b32 v56, 31, v1
    v_lshlrev_b32 v56, 2, v56
    s_lshl_b32 s14, s3, 7
    s_waitcnt vmcnt(6)
    v_mfma_f32_16x16x32_bf16 v[12:15], v[16:19], v[72:75], v[12:15]
    s_cmp_gt_u32 s4, 20
    s_cbranch_scc1 L_sk128
    s_cmp_gt_u32 s4, 4
    s_cbranch_scc1 L_sk128m
    s_waitcnt vmcnt(3)
L_sk128m:
    s_waitcnt vmcnt(4)
L_sk128:
    v_xor_b32 v45, s80, v2
    buffer_load_dwordx4 v[100:103], v45, s[28:31], 0 offen nt
    s_xor_b32 s80, s101, 0x800
    v_and_b32_dpp v20, v40, v4 row_newbcast:12 row_mask:0xf bank_mask:0xf
    v_and_b32_dpp v21, v40, v5 row_newbcast:12 row_mask:0xf bank_mask:0xf
    v_and_b32_dpp v22, v40, v6 row_newbcast:12 row_mask:0xf bank_mask:0xf
    v_and_b32_dpp v23, v40, v7 row_newbcast:12 row_mask:0xf bank_mask:0xf
    v_add_u32 v56, s14, v56
    v_add_u32 v53, 2048, v56
    v_cndmask_b32 v54, v54, v53, vcc
    s_lshl_b32 s14, s3, 2
    v_add_u32 v59, s14, v47
    v_and_b32 v59, 15, v59
    v_lshlrev_b32 v59, 5, v59
    v_lshl_add_u32 v59, v46, 3, v59
    v_mov_b32 v32, 0
    s_waitcnt vmcnt(6)
    v_mfma_f32_16x16x32_bf16 v[12:15], v[20:23], v[76:79], v[12:15]
    s_memrealtime s[94:95]
    s_cmp_gt_u32 s4, 28
    s_cbranch_scc1 L_sk129
    s_cmp_gt_u32 s4, 12
    s_cbranch_scc1 L_sk129m
    s_waitcnt vmcnt(3)
L_sk129m:
    s_waitcnt vmcnt(4)
L_sk129:
    v_xor_b32 v45, s80, v2
    buffer_load_dwordx4 v[104:107], v45, s[28:31], 0 offen nt
    s_xor_b32 s80, s101, 0x10900
    v_and_b32_dpp v16, v40, v4 row_newbcast:2 row_mask:0xf bank_mask:0xf
    v_and_b32_dpp v17, v40, v5 row_newbcast:2 row_mask:0xf bank_mask:0xf
    v_and_b32_dpp v18, v40, v6 row_newbcast:2 row_mask:0xf bank_mask:0xf
    v_and_b32_dpp v19, v40, v7 row_newbcast:2 row_mask:0xf bank_mask:0xf
    v_mov_b32 v33, 0x41f00000
    v_mov_b32 v37, 0x3ff00000
    v_cmp_gt_u32 vcc, 4, v47
    s_nop 1
    v_cndmask_b32 v33, v33, v37, vcc
    v_and_b32 v36, 3, v47
    v_xor_b32 v37, 1, v36
    v_lshl_or_b32 v36, v37, 2, v36
    v_lshl_or_b32 v36, v36, 4, v36
    v_lshl_or_b32 v36, v36, 8, v36
    s_waitcnt vmcnt(6)
    v_mfma_f32_16x16x32_bf16 v[12:15], v[16:19], v[80:83], v[12:15]
    s_waitcnt lgkmcnt(0)
    s_sub_u32 s79, s94, s98
    s_sub_u32 s79, s79, 6705
    s_mul_i32 s79, s79, 8
    s_ashr_i32 s79, s79, 4
    s_add_u32 s79, s79, 21
    s_max_i32 s79, s79, 0
    s_min_i32 s4, s79, 32
    s_cmp_gt_u32 s4, 18
    s_cbranch_scc1 L_sk130
    s_cmp_gt_u32 s4, 2
    s_cbranch_scc1 L_sk130m
    s_waitcnt vmcnt(3)
L_sk130m:
    s_waitcnt vmcnt(4)
L_sk130:
    v_xor_b32 v45, s80, v2
    buffer_load_dwordx4 v[108:111], v45, s[28:31], 0 offen nt
    s_add_u32 s100, s100, 1
    v_readlane_b32 s101, v61, s100
    s_mov_b32 s80, s101
    v_and_b32_dpp v20, v40, v4 row_newbcast:10 row_mask:0xf bank_mask:0xf
    v_and_b32_dpp v21, v40, v5 row_newbcast:10 row_mask:0xf bank_mask:0xf
    v_and_b32_dpp v22, v40, v6 row_newbcast:10 row_mask:0xf bank_mask:0xf
    v_and_b32_dpp v23, v40, v7 row_newbcast:10 row_mask:0xf bank_mask:0xf
    v_mov_b32 v41, 0
    v_mov_b32 v43, 0
    s_mul_i32 s22, s76, 2560
    v_mov_b64 v[128:129], 0
    v_mov_b64 v[130:131], 0
    v_mov_b64 v[132:133], 0
    v_mov_b64 v[134:135], 0
    v_mov_b64 v[176:177], 0
    v_mov_b64 v[178:179], 0
    s_waitcnt vmcnt(6)
    v_mfma_f32_16x16x32_bf16 v[12:15], v[20:23], v[84:87], v[12:15]
    s_cmp_gt_u32 s4, 26
    s_cbranch_scc1 L_sk131
    s_cmp_gt_u32 s4, 10
    s_cbranch_scc1 L_sk131m
    s_waitcnt vmcnt(3)
L_sk131m:
    s_waitcnt vmcnt(4)
L_sk131:
    v_xor_b32 v45, s80, v2
    buffer_load_dwordx4 v[112:115], v45, s[28:31], 0 offen nt
    s_xor_b32 s80, s101, 0x10100
    v_and_b32_dpp v16, v40, v4 row_newbcast:6 row_mask:0xf bank_mask:0xf
    v_and_b32_dpp v17, v40, v5 row_newbcast:6 row_mask:0xf bank_mask:0xf
    v_and_b32_dpp v18, v40, v6 row_newbcast:6 row_mask:0xf bank_mask:0xf
    v_and_b32_dpp v19, v40, v7 row_newbcast:6 row_mask:0xf bank_mask:0xf
    v_mov_b64 v[180:181], 0
    v_mov_b64 v[182:183], 0
    v_mov_b64 v[184:185], 0
    v_mov_b64 v[186:187], 0
    v_mov_b64 v[188:189], 0
    v_mov_b64 v[190:191], 0
    v_mov_b64 v[192:193], 0
    v_mov_b64 v[194:195], 0
    v_mov_b64 v[196:197], 0
    s_waitcnt vmcnt(6)
    v_mfma_f32_16x16x32_bf16 v[12:15], v[16:19], v[88:91], v[12:15]
    s_memrealtime s[94:95]
    s_cmp_gt_u32 s4, 22
    s_cbranch_scc1 L_sk132
    s_cmp_gt_u32 s4, 6
    s_cbranch_scc1 L_sk132m
    s_waitcnt vmcnt(3)
L_sk132m:
    s_waitcnt vmcnt(4)
L_sk132:
    v_xor_b32 v45, s80, v2
    buffer_load_dwordx4 v[116:119], v45, s[28:31], 0 offen nt
    s_xor_b32 s80, s101, 0x800
    v_and_b32_dpp v20, v40, v4 row_newbcast:14 row_mask:0xf bank_mask:0xf
    v_and_b32_dpp v21, v40, v5 row_newbcast:14 row_mask:0xf bank_mask:0xf
    v_and_b32_dpp v22, v40, v6 row_newbcast:14 row_mask:0xf bank_mask:0xf
    v_and_b32_dpp v23, v40, v7 row_newbcast:14 row_mask:0xf bank_mask:0xf
    v_mov_b64 v[198:199], 0
    v_mov_b64 v[200:201], 0
    v_mov_b64 v[202:203], 0
    v_mov_b64 v[204:205], 0
    v_mov_b64 v[206:207], 0
    v_mov_b64 v[208:209], 0
    v_mov_b64 v[210:211], 0
    v_mov_b64 v[212:213], 0
    v_mov_b64 v[214:215], 0
    s_waitcnt vmcnt(6)
    v_mfma_f32_16x16x32_bf16 v[12:15], v[20:23], v[92:95], v[12:15]
    s_waitcnt lgkmcnt(0)
    s_sub_u32 s79, s94, s98
    s_sub_u32 s79, s79, 6745
    s_mul_i32 s79, s79, 8
    s_ashr_i32 s79, s79, 4
    s_add_u32 s79, s79, 21
    s_max_i32 s79, s79, 0
    s_min_i32 s4, s79, 32
    s_cmp_gt_u32 s4, 30
    s_cbranch_scc1 L_sk133
    s_cmp_gt_u32 s4, 14
    s_cbranch_scc1 L_sk133m
    s_waitcnt vmcnt(3)
L_sk133m:
    s_waitcnt vmcnt(4)
L_sk133:
    v_xor_b32 v45, s80, v2
    buffer_load_dwordx4 v[120:123], v45, s[28:31], 0 offen nt
    s_xor_b32 s80, s101, 0x10900
    v_and_b32_dpp v16, v40, v4 row_newbcast:1 row_mask:0xf bank_mask:0xf
    v_and_b32_dpp v17, v40, v5 row_newbcast:1 row_mask:0xf bank_mask:0xf
    v_and_b32_dpp v18, v40, v6 row_newbcast:1 row_mask:0xf bank_mask:0xf
    v_and_b32_dpp v19, v40, v7 row_newbcast:1 row_mask:0xf bank_mask:0xf
    v_mov_b64 v[216:217], 0
    v_mov_b64 v[218:219], 0
    v_mov_b64 v[220:221], 0
    v_mov_b64 v[222:223], 0
    v_mov_b64 v[224:225], 0
    v_mov_b64 v[226:227], 0
    v_mov_b64 v[228:229], 0
    v_mov_b64 v[230:231], 0
    v_mov_b64 v[232:233], 0
    s_waitcnt vmcnt(6)
    v_mfma_f32_16x16x32_bf16 v[12:15], v[16:19], v[96:99], v[12:15]
    s_cmp_gt_u32 s4, 17
    s_cbranch_scc1 L_sk134
    s_cmp_gt_u32 s4, 1
    s_cbranch_scc1 L_sk134m
    s_waitcnt vmcnt(3)
L_sk134m:
    s_waitcnt vmcnt(4)
L_sk134:
    v_xor_b32 v45, s80, v2
    buffer_load_dwordx4 v[124:127], v45, s[28:31], 0 offen nt
    s_add_u32 s100, s100, 1
    v_readlane_b32 s101, v61, s100
    s_mov_b32 s80, s101
    v_and_b32_dpp v20, v40, v4 row_newbcast:9 row_mask:0xf bank_mask:0xf
    v_and_b32_dpp v21, v40, v5 row_newbcast:9 row_mask:0xf bank_mask:0xf
    v_and_b32_dpp v22, v40, v6 row_newbcast:9 row_mask:0xf bank_mask:0xf
    v_and_b32_dpp v23, v40, v7 row_newbcast:9 row_mask:0xf bank_mask:0xf
    v_mov_b64 v[234:235], 0
    v_mov_b64 v[236:237], 0
    v_mov_b64 v[238:239], 0
L_e3:
    s_waitcnt vmcnt(6)
    v_mfma_f32_16x16x32_bf16 v[12:15], v[20:23], v[100:103], v[12:15]
    v_and_b32_dpp v16, v40, v4 row_newbcast:5 row_mask:0xf bank_mask:0xf
    v_and_b32_dpp v17, v40, v5 row_newbcast:5 row_mask:0xf bank_mask:0xf
    v_and_b32_dpp v18, v40, v6 row_newbcast:5 row_mask:0xf bank_mask:0xf
    v_and_b32_dpp v19, v40, v7 row_newbcast:5 row_mask:0xf bank_mask:0xf
    s_waitcnt vmcnt(5)
    s_nop 0
    v_mfma_f32_16x16x32_bf16 v[12:15], v[16:19], v[104:107], v[12:15]
    v_and_b32_dpp v20, v40, v4 row_newbcast:13 row_mask:0xf bank_mask:0xf
    v_and_b32_dpp v21, v40, v5 row_newbcast:13 row_mask:0xf bank_mask:0xf
    v_and_b32_dpp v22, v40, v6 row_newbcast:13 row_mask:0xf bank_mask:0xf
    v_and_b32_dpp v23, v40, v7 row_newbcast:13 row_mask:0xf bank_mask:0xf
    s_waitcnt vmcnt(4)
    s_nop 0
    v_mfma_f32_16x16x32_bf16 v[12:15], v[20:23], v[108:111], v[12:15]
    v_and_b32_dpp v16, v40, v4 row_newbcast:3 row_mask:0xf bank_mask:0xf
    v_and_b32_dpp v17, v40, v5 row_newbcast:3 row_mask:0xf bank_mask:0xf
    v_and_b32_dpp v18, v40, v6 row_newbcast:3 row_mask:0xf bank_mask:0xf
    v_and_b32_dpp v19, v40, v7 row_newbcast:3 row_mask:0xf bank_mask:0xf
    s_waitcnt vmcnt(3)
    s_nop 0
    v_mfma_f32_16x16x32_bf16 v[12:15], v[16:19], v[112:115], v[12:15]
    v_and_b32_dpp v20, v40, v4 row_newbcast:11 row_mask:0xf bank_mask:0xf
    v_and_b32_dpp v21, v40, v5 row_newbcast:11 row_mask:0xf bank_mask:0xf
    v_and_b32_dpp v22, v40, v6 row_newbcast:11 row_mask:0xf bank_mask:0xf
    v_and_b32_dpp v23, v40, v7 row_newbcast:11 row_mask:0xf bank_mask:0xf
    s_waitcnt vmcnt(2)
    s_nop 0
    v_mfma_f32_16x16x32_bf16 v[12:15], v[20:23], v[116:119], v[12:15]
    v_and_b32_dpp v16, v40, v4 row_newbcast:7 row_mask:0xf bank_mask:0xf
    v_and_b32_dpp v17, v40, v5 row_newbcast:7 row_mask:0xf bank_mask:0xf
    v_and_b32_dpp v18, v40, v6 row_newbcast:7 row_mask:0xf bank_mask:0xf
    v_and_b32_dpp v19, v40, v7 row_newbcast:7 row_mask:0xf bank_mask:0xf
    s_waitcnt vmcnt(1)
    s_nop 0
    v_mfma_f32_16x16x32_bf16 v[12:15], v[16:19], v[120:123], v[12:15]
    v_and_b32_dpp v20, v40, v4 row_newbcast:15 row_mask:0xf bank_mask:0xf
    v_and_b32_dpp v21, v40, v5 row_newbcast:15 row_mask:0xf bank_mask:0xf
    v_and_b32_dpp v22, v40, v6 row_newbcast:15 row_mask:0xf bank_mask:0xf
    v_and_b32_dpp v23, v40, v7 row_newbcast:15 row_mask:0xf bank_mask:0xf
    s_waitcnt vmcnt(0)
    s_nop 0
    v_mfma_f32_16x16x32_bf16 v[12:15], v[20:23], v[124:127], v[12:15]
L_eend:
    s_nop 7
    ds_write_b128 v58, v[12:15] offset:0
    s_waitcnt lgkmcnt(0)
    s_barrier
    ds_read2st64_b64 v[24:27], v59 offset0:0 offset1:2
    ds_read2st64_b64 v[28:31], v59 offset0:4 offset1:6
    s_waitcnt lgkmcnt(1)
    v_pk_add_f32 v[24:25], v[24:25], v[26:27]
    s_waitcnt lgkmcnt(0)
    v_pk_add_f32 v[28:29], v[28:29], v[30:31]
    v_pk_add_f32 v[24:25], v[24:25], v[28:29]
    v_cvt_pk_bf16_f32 v40, v24, 0
    v_cvt_pk_bf16_f32 v42, v25, 0
    s_nop 0
    v_fmac_f64_dpp v[176:177], v[40:41], v[32:33] row_newbcast:0 row_mask:0xf bank_mask:0xf
    v_fmac_f64_dpp v[178:179], v[42:43], v[32:33] row_newbcast:0 row_mask:0xf bank_mask:0xf
    v_fmac_f64_dpp v[180:181], v[40:41], v[32:33] row_newbcast:1 row_mask:0xf bank_mask:0xf
    v_fmac_f64_dpp v[182:183], v[42:43], v[32:33] row_newbcast:1 row_mask:0xf bank_mask:0xf
    v_smfmac_f32_16x16x64_bf16 v[132:135], v[176:179], a[128:135], v36
    v_fmac_f64_dpp v[184:185], v[40:41], v[32:33] row_newbcast:2 row_mask:0xf bank_mask:0xf
    v_fmac_f64_dpp v[186:187], v[42:43], v[32:33] row_newbcast:2 row_mask:0xf bank_mask:0xf
    v_smfmac_f32_16x16x64_bf16 v[128:131], v[176:179], a[0:7], v36
    v_fmac_f64_dpp v[188:189], v[40:41], v[32:33] row_newbcast:3 row_mask:0xf bank_mask:0xf
    v_fmac_f64_dpp v[190:191], v[42:43], v[32:33] row_newbcast:3 row_mask:0xf bank_mask:0xf
    v_smfmac_f32_16x16x64_bf16 v[132:135], v[180:183], a[136:143], v36
    v_fmac_f64_dpp v[192:193], v[40:41], v[32:33] row_newbcast:4 row_mask:0xf bank_mask:0xf
    v_fmac_f64_dpp v[194:195], v[42:43], v[32:33] row_newbcast:4 row_mask:0xf bank_mask:0xf
    v_smfmac_f32_16x16x64_bf16 v[128:131], v[180:183], a[8:15], v36
    v_fmac_f64_dpp v[196:197], v[40:41], v[32:33] row_newbcast:5 row_mask:0xf bank_mask:0xf
    v_fmac_f64_dpp v[198:199], v[42:43], v[32:33] row_newbcast:5 row_mask:0xf bank_mask:0xf
    v_smfmac_f32_16x16x64_bf16 v[132:135], v[184:187], a[144:151], v36
    v_fmac_f64_dpp v[200:201], v[40:41], v[32:33] row_newbcast:6 row_mask:0xf bank_mask:0xf
    v_fmac_f64_dpp v[202:203], v[42:43], v[32:33] row_newbcast:6 row_mask:0xf bank_mask:0xf
    v_smfmac_f32_16x16x64_bf16 v[128:131], v[184:187], a[16:23], v36
    v_fmac_f64_dpp v[204:205], v[40:41], v[32:33] row_newbcast:7 row_mask:0xf bank_mask:0xf
    v_fmac_f64_dpp v[206:207], v[42:43], v[32:33] row_newbcast:7 row_mask:0xf bank_mask:0xf
    v_smfmac_f32_16x16x64_bf16 v[132:135], v[188:191], a[152:159], v36
    v_fmac_f64_dpp v[208:209], v[40:41], v[32:33] row_newbcast:8 row_mask:0xf bank_mask:0xf
    v_fmac_f64_dpp v[210:211], v[42:43], v[32:33] row_newbcast:8 row_mask:0xf bank_mask:0xf
    v_smfmac_f32_16x16x64_bf16 v[128:131], v[188:191], a[24:31], v36
    v_fmac_f64_dpp v[212:213], v[40:41], v[32:33] row_newbcast:9 row_mask:0xf bank_mask:0xf
    v_fmac_f64_dpp v[214:215], v[42:43], v[32:33] row_newbcast:9 row_mask:0xf bank_mask:0xf
    v_smfmac_f32_16x16x64_bf16 v[128:131], v[192:195], a[32:39], v36
    v_fmac_f64_dpp v[216:217], v[40:41], v[32:33] row_newbcast:10 row_mask:0xf bank_mask:0xf
    v_fmac_f64_dpp v[218:219], v[42:43], v[32:33] row_newbcast:10 row_mask:0xf bank_mask:0xf
    v_smfmac_f32_16x16x64_bf16 v[128:131], v[196:199], a[40:47], v36
    v_fmac_f64_dpp v[220:221], v[40:41], v[32:33] row_newbcast:11 row_mask:0xf bank_mask:0xf
    v_fmac_f64_dpp v[222:223], v[42:43], v[32:33] row_newbcast:11 row_mask:0xf bank_mask:0xf
    ds_write_b128 v57, v[132:135] offset:21504
    v_smfmac_f32_16x16x64_bf16 v[128:131], v[200:203], a[48:55], v36
    v_fmac_f64_dpp v[224:225], v[40:41], v[32:33] row_newbcast:12 row_mask:0xf bank_mask:0xf
    v_fmac_f64_dpp v[226:227], v[42:43], v[32:33] row_newbcast:12 row_mask:0xf bank_mask:0xf
    v_smfmac_f32_16x16x64_bf16 v[128:131], v[204:207], a[56:63], v36
    v_fmac_f64_dpp v[228:229], v[40:41], v[32:33] row_newbcast:13 row_mask:0xf bank_mask:0xf
    v_fmac_f64_dpp v[230:231], v[42:43], v[32:33] row_newbcast:13 row_mask:0xf bank_mask:0xf
    v_smfmac_f32_16x16x64_bf16 v[128:131], v[208:211], a[64:71], v36
    v_fmac_f64_dpp v[232:233], v[40:41], v[32:33] row_newbcast:14 row_mask:0xf bank_mask:0xf
    v_fmac_f64_dpp v[234:235], v[42:43], v[32:33] row_newbcast:14 row_mask:0xf bank_mask:0xf
    v_smfmac_f32_16x16x64_bf16 v[128:131], v[212:215], a[72:79], v36
    v_fmac_f64_dpp v[236:237], v[40:41], v[32:33] row_newbcast:15 row_mask:0xf bank_mask:0xf
    v_fmac_f64_dpp v[238:239], v[42:43], v[32:33] row_newbcast:15 row_mask:0xf bank_mask:0xf
    s_waitcnt lgkmcnt(0)
    s_barrier
    ds_read2st64_b32 v[64:65], v56 offset0:84 offset1:86
    ds_read2st64_b32 v[66:67], v56 offset0:88 offset1:90
    v_smfmac_f32_16x16x64_bf16 v[128:131], v[216:219], a[80:87], v36
    v_smfmac_f32_16x16x64_bf16 v[128:131], v[220:223], a[88:95], v36
    v_smfmac_f32_16x16x64_bf16 v[128:131], v[224:227], a[96:103], v36
    v_smfmac_f32_16x16x64_bf16 v[128:131], v[228:231], a[104:111], v36
    s_waitcnt lgkmcnt(0)
    v_pk_add_f32 v[64:65], v[64:65], v[66:67]
    v_smfmac_f32_16x16x64_bf16 v[128:131], v[232:235], a[112:119], v36
    v_add_f32 v64, v64, v65
    v_smfmac_f32_16x16x64_bf16 v[128:131], v[236:239], a[120:127], v36
    buffer_store_dword v64, v54, s[44:47], s22 offen sc1
    s_nop 6
    buffer_store_dwordx4 v[128:131], v55, s[44:47], s22 offen sc1
    s_sub_u32 s14, s73, 13
    s_cmp_ge_u32 s14, 11
    s_cbranch_scc1 L_nohelp
    s_lshl_b32 s14, s14, 2
    s_add_u32 s14, s14, s3
    s_load_dwordx2 s[64:65], s[0:1], 64
    s_mov_b32 s60, s14
    v_mul_u32_u24 v170, 3456, v1
    s_mov_b32 s42, 2211840
    s_bitcmp1_b32 s14, 0
    s_cselect_b32 s40, s56, s52
    s_cselect_b32 s41, s57, s53
    s_bfe_u32 s15, s14, 0x20001
    s_lshl_b32 s15, s15, 3
    s_add_u32 s15, s15, s72
    s_lshr_b32 s17, s14, 3
    s_add_u32 s17, s17, 2
    s_mul_i32 s17, s17, 221184
    s_lshl_b32 s23, s15, 7
    s_add_u32 s17, s17, s23
    s_cmp_lt_u32 s15, 27
    s_cselect_b32 s17, s17, 2130706432
    s_cmp_lt_u32 s14, 64
    s_cselect_b32 s17, s17, 2130706432
    buffer_load_dword v171, v170, s[40:43], s17 offen offset:0
    s_add_u32 s14, s14, 44
    s_bitcmp1_b32 s14, 0
    s_cselect_b32 s40, s56, s52
    s_cselect_b32 s41, s57, s53
    s_bfe_u32 s15, s14, 0x20001
    s_lshl_b32 s15, s15, 3
    s_add_u32 s15, s15, s72
    s_lshr_b32 s17, s14, 3
    s_add_u32 s17, s17, 2
    s_mul_i32 s17, s17, 221184
    s_lshl_b32 s23, s15, 7
    s_add_u32 s17, s17, s23
    s_cmp_lt_u32 s15, 27
    s_cselect_b32 s17, s17, 2130706432
    s_cmp_lt_u32 s14, 64
    s_cselect_b32 s17, s17, 2130706432
    buffer_load_dword v172, v170, s[40:43], s17 offen offset:0
    v_mul_u32_u24 v170, 1280, v1
    s_mov_b32 s66, 2211840
    s_waitcnt lgkmcnt(0)
    s_waitcnt vmcnt(0)
    s_and_b32 s15, s60, 1
    s_lshl_b32 s15, s15, 3
    s_add_u32 s15, s15, s72
    s_lshr_b32 s17, s60, 1
    s_sub_u32 s17, 26, s17
    s_mul_i32 s17, s17, 81920
    s_lshl_b32 s23, s15, 7
    s_add_u32 s17, s17, s23
    s_cmp_lt_u32 s15, 10
    s_cselect_b32 s17, s17, 2130706432
    s_cmp_lt_u32 s60, 54
    s_cselect_b32 s17, s17, 2130706432
    buffer_load_dword v174, v170, s[64:67], s17 offen
    s_add_u32 s60, s60, 44
    s_and_b32 s15, s60, 1
    s_lshl_b32 s15, s15, 3
    s_add_u32 s15, s15, s72
    s_lshr_b32 s17, s60, 1
    s_sub_u32 s17, 26, s17
    s_mul_i32 s17, s17, 81920
    s_lshl_b32 s23, s15, 7
    s_add_u32 s17, s17, s23
    s_cmp_lt_u32 s15, 10
    s_cselect_b32 s17, s17, 2130706432
    s_cmp_lt_u32 s60, 54
    s_cselect_b32 s17, s17, 2130706432
    buffer_load_dword v175, v170, s[64:67], s17 offen
    s_waitcnt vmcnt(0)
L_nohelp:
    s_cmp_eq_u32 s19, 0
    s_cbranch_scc1 L_fin
    s_cmp_eq_u32 s19, 2
    s_cbranch_scc1 L_late_done
    s_cmp_eq_u32 s19, 3
    s_cbranch_scc1 L_late_down
    s_mov_b32 m0, s63
    s_add_u32 s23, s63, 40960
    buffer_load_dwordx4 v60, s[52:55], s60 offen nt lds
    s_mov_b32 m0, s23
    s_add_u32 s63, s63, 4096
    buffer_load_dwordx4 v60, s[56:59], s60 offen nt lds
    s_add_u32 s60, s60, s62
    s_mov_b32 m0, s63
    s_add_u32 s23, s63, 40960
    buffer_load_dwordx4 v60, s[52:55], s60 offen nt lds
    s_mov_b32 m0, s23
    s_add_u32 s63, s63, 4096
    buffer_load_dwordx4 v60, s[56:59], s60 offen nt lds
    s_add_u32 s60, s60, s62
    s_mov_b32 m0, s63
    s_add_u32 s23, s63, 40960
    buffer_load_dwordx4 v60, s[52:55], s60 offen nt lds
    s_mov_b32 m0, s23
    s_add_u32 s63, s63, 4096
    buffer_load_dwordx4 v60, s[56:59], s60 offen nt lds
    s_add_u32 s60, s60, s62
    s_mov_b32 m0, s63
    s_add_u32 s23, s63, 40960
    buffer_load_dwordx4 v60, s[52:55], s60 offen nt lds
    s_mov_b32 m0, s23
    s_add_u32 s63, s63, 4096
    buffer_load_dwordx4 v60, s[56:59], s60 offen nt lds
    s_add_u32 s60, s60, s62
    s_mov_b32 m0, s63
    s_add_u32 s23, s63, 40960
    buffer_load_dwordx4 v60, s[52:55], s60 offen nt lds
    s_mov_b32 m0, s23
    s_add_u32 s63, s63, 4096
    buffer_load_dwordx4 v60, s[56:59], s60 offen nt lds
    s_add_u32 s60, s60, s62
    s_mov_b32 m0, s63
    s_add_u32 s23, s63, 40960
    buffer_load_dwordx4 v60, s[52:55], s60 offen nt lds
    s_mov_b32 m0, s23
    s_add_u32 s63, s63, 4096
    buffer_load_dwordx4 v60, s[56:59], s60 offen nt lds
    s_add_u32 s60, s60, s62
    s_mov_b32 m0, s63
    s_add_u32 s23, s63, 40960
    buffer_load_dwordx4 v60, s[52:55], s60 offen nt lds
    s_mov_b32 m0, s23
    s_add_u32 s63, s63, 4096
    buffer_load_dwordx4 v60, s[56:59], s60 offen nt lds
    s_add_u32 s60, s60, s62
    s_mov_b32 m0, s63
    s_add_u32 s23, s63, 40960
    buffer_load_dwordx4 v60, s[52:55], s60 offen nt lds
    s_mov_b32 m0, s23
    s_add_u32 s63, s63, 4096
    buffer_load_dwordx4 v60, s[56:59], s60 offen nt lds
    s_add_u32 s60, s60, s62
    s_mov_b32 m0, s63
    s_add_u32 s23, s63, 40960
    buffer_load_dwordx4 v60, s[52:55], s60 offen nt lds
    s_mov_b32 m0, s23
    s_add_u32 s63, s63, 4096
    buffer_load_dwordx4 v60, s[56:59], s60 offen nt lds
    s_add_u32 s60, s60, s62
    s_mov_b32 m0, s63
    s_add_u32 s23, s63, 40960
    buffer_load_dwordx4 v60, s[52:55], s60 offen nt lds
    s_mov_b32 m0, s23
    s_add_u32 s63, s63, 4096
    buffer_load_dwordx4 v60, s[56:59], s60 offen nt lds
    s_add_u32 s60, s60, s62
    s_branch L_late_done
L_late_down:
    s_load_dwordx4 s[36:39], s[0:1], 48
    s_and_b32 s14, s73, 3
    s_lshl_b32 s14, s14, 2
    s_add_u32 s14, s14, s3
    v_mul_u32_u24 v170, 3456, v1
    s_mov_b32 s42, 2211840
    s_bfe_u32 s15, s14, 0x20001
    s_lshl_b32 s15, s15, 3
    s_add_u32 s15, s15, s72
    s_sub_u32 s17, s15, 8
    s_cmp_lt_u32 s15, 27
    s_cselect_b32 s15, s15, s17
    s_lshr_b32 s17, s14, 3
    s_add_u32 s17, s17, 0
    s_mul_i32 s17, s17, 221184
    s_lshl_b32 s23, s15, 7
    s_add_u32 s17, s17, s23
    s_bitcmp1_b32 s14, 0
    s_waitcnt lgkmcnt(0)
    s_cselect_b32 s40, s38, s36
    s_cselect_b32 s41, s39, s37
    buffer_load_dword v171, v170, s[40:43], s17 offen
    s_waitcnt vmcnt(0)
    s_mov_b32 m0, s63
    s_add_u32 s63, s63, 1024
    buffer_load_dwordx4 v60, s[52:55], s60 offen nt lds
    s_add_u32 s60, s60, s62
    s_mov_b32 m0, s63
    s_add_u32 s63, s63, 1024
    buffer_load_dwordx4 v60, s[52:55], s60 offen nt lds
    s_add_u32 s60, s60, s62
    s_mov_b32 m0, s63
    s_add_u32 s63, s63, 1024
    buffer_load_dwordx4 v60, s[52:55], s60 offen nt lds
    s_add_u32 s60, s60, s62
    s_mov_b32 m0, s63
    s_add_u32 s63, s63, 1024
    buffer_load_dwordx4 v60, s[52:55], s60 offen nt lds
    s_add_u32 s60, s60, s62
    s_mov_b32 m0, s63
    s_add_u32 s63, s63, 1024
    buffer_load_dwordx4 v60, s[52:55], s60 offen nt lds
    s_add_u32 s60, s60, s62
    s_mov_b32 m0, s63
    s_add_u32 s63, s63, 1024
    buffer_load_dwordx4 v60, s[52:55], s60 offen nt lds
    s_add_u32 s60, s60, s62
    s_mov_b32 m0, s63
    s_add_u32 s63, s63, 1024
    buffer_load_dwordx4 v60, s[52:55], s60 offen nt lds
    s_add_u32 s60, s60, s62
    s_mov_b32 m0, s63
    s_add_u32 s63, s63, 1024
    buffer_load_dwordx4 v60, s[52:55], s60 offen nt lds
    s_add_u32 s60, s60, s62
    s_mov_b32 m0, s63
    s_add_u32 s63, s63, 1024
    buffer_load_dwordx4 v60, s[52:55], s60 offen nt lds
    s_add_u32 s60, s60, s62
    s_mov_b32 m0, s63
    s_add_u32 s63, s63, 1024
    buffer_load_dwordx4 v60, s[52:55], s60 offen nt lds
    s_add_u32 s60, s60, s62
    s_mov_b32 m0, s63
    s_add_u32 s63, s63, 1024
    buffer_load_dwordx4 v60, s[52:55], s60 offen nt lds
    s_add_u32 s60, s60, s62
    s_mov_b32 m0, s63
    s_add_u32 s63, s63, 1024
    buffer_load_dwordx4 v60, s[52:55], s60 offen nt lds
    s_add_u32 s60, s60, s62
    s_mov_b32 m0, s63
    s_add_u32 s63, s63, 1024
    buffer_load_dwordx4 v60, s[52:55], s60 offen nt lds
    s_add_u32 s60, s60, s62
    s_mov_b32 m0, s63
    s_add_u32 s63, s63, 1024
    buffer_load_dwordx4 v60, s[52:55], s60 offen nt lds
    s_add_u32 s60, s60, s62
L_late_done:
    s_cmp_eq_u32 s19, 2
    s_cbranch_scc1 L_reducer
    s_cmp_eq_u32 s19, 3
    s_cbranch_scc1 L_down
L_f1:
    v_and_b32 v56, 7, v47
    v_mul_u32_u24 v57, 1280, v56
    v_lshrrev_b32 v58, 3, v47
    v_lshlrev_b32 v59, 6, v58
    v_lshlrev_b32 v60, 4, v46
    v_add3_u32 v57, v57, v59, v60
    s_lshl_b32 s14, s3, 7
    s_lshr_b32 s15, s18, 1
    s_and_b32 s15, s15, 7
    s_mul_i32 s15, s15, 10752
    s_add_u32 s14, s14, s15
    s_add_u32 s14, s14, 655360
    s_add_u32 s15, s14, 1024
    s_cmp_lt_u32 s3, 2
    s_cselect_b32 s15, s15, 2130706432
    v_and_b32 v40, 3, v47
    v_lshrrev_b32 v41, 2, v47
    v_lshl_add_u32 v41, v46, 3, v41
    v_lshlrev_b32 v41, 6, v41
    v_lshrrev_b32 v42, 1, v40
    v_mul_u32_u24 v42, 40960, v42
    v_and_b32 v40, 1, v40
    v_lshl_add_u32 v41, v40, 3, v41
    v_xor_b32 v43, s3, v46
    v_lshlrev_b32 v43, 4, v43
    v_add3_u32 v44, v41, v42, v43
    v_add_u32 v44, 32768, v44
    v_lshlrev_b32 v51, 4, v1
    v_lshlrev_b32 v54, 6, v56
    v_lshl_add_u32 v53, v58, 5, v54
    s_lshl_b32 s22, s3, 3
    v_add_u32 v53, s22, v53
    v_lshlrev_b32 v55, 4, v56
    v_and_b32 v59, 1, v46
    v_lshl_add_u32 v55, v59, 3, v55
    v_lshl_add_u32 v55, v58, 2, v55
    v_lshrrev_b32 v59, 1, v46
    v_mul_u32_u24 v59, 27648, v59
    v_add_u32 v55, v55, v59
    s_lshl_b32 s21, s18, 2
    s_add_u32 s21, s21, s3
    s_lshl_b32 s21, s21, 7
    s_mov_b32 s23, 0xbdd2d3e8
    s_mov_b32 s24, 0xc0135761
    s_mov_b32 s25, 0x3acccccd
    s_xor_b32 s22, s3, 0
    s_lshl_b32 s17, s22, 12
    v_add_u32 v40, s17, v44
    s_lshl_b32 s17, s22, 10
    v_add_u32 v52, s17, v51
    s_xor_b32 s22, s3, 1
    s_lshl_b32 s17, s22, 12
    v_add_u32 v41, s17, v44
    s_lshl_b32 s17, s22, 10
    v_add_u32 v48, s17, v51
    s_xor_b32 s22, s3, 2
    s_lshl_b32 s17, s22, 12
    v_add_u32 v42, s17, v44
    s_lshl_b32 s17, s22, 10
    v_add_u32 v49, s17, v51
    s_xor_b32 s22, s3, 3
    s_lshl_b32 s17, s22, 12
    v_add_u32 v43, s17, v44
    s_lshl_b32 s17, s22, 10
    v_add_u32 v50, s17, v51
    v_mov_b32 v246, 0x3f803f80
    v_mov_b32 v247, 0x3f803f80
    v_mov_b32 v248, 0x3f803f80
    v_mov_b32 v249, 0x3f803f80
    v_mov_b32 v250, s24
    s_mov_b32 vcc_lo, 0x00f0000f
    s_mov_b32 vcc_hi, 0xf0000f00
    v_lshlrev_b32 v59, 3, v1
    v_add_u32 v59, 114688, v59
    v_add_u32 v53, 16384, v53
    v_cndmask_b32 v53, v59, v53, vcc
    s_add_u32 s26, s21, 55296
    s_add_u32 s38, s26, 55296
    s_add_u32 s39, s38, 55296
    v_mov_b32 v252, s23
    v_mov_b32 v254, 1.0
    s_mov_b32 s20, 0x8000
    s_waitcnt vmcnt(0)
    s_barrier
    ds_read_b64_tr_b16 v[160:161], v40 offset:0
    ds_read_b64_tr_b16 v[162:163], v40 offset:256
    ds_read_b64_tr_b16 v[164:165], v40 offset:2048
    ds_read_b64_tr_b16 v[166:167], v40 offset:2304
    ds_read_b64_tr_b16 v[168:169], v40 offset:16384
    ds_read_b64_tr_b16 v[170:171], v40 offset:16640
    ds_read_b64_tr_b16 v[172:173], v40 offset:18432
    ds_read_b64_tr_b16 v[174:175], v40 offset:18688
    ds_read_b64_tr_b16 v[176:177], v41 offset:0
    ds_read_b64_tr_b16 v[178:179], v41 offset:256
    ds_read_b64_tr_b16 v[180:181], v41 offset:2048
    ds_read_b64_tr_b16 v[182:183], v41 offset:2304
    ds_read_b64_tr_b16 v[184:185], v42 offset:0
    ds_read_b64_tr_b16 v[186:187], v42 offset:256
    ds_read_b64_tr_b16 v[188:189], v42 offset:2048
    ds_read_b64_tr_b16 v[190:191], v42 offset:2304
    s_waitcnt lgkmcnt(12)
    v_mfma_f32_16x16x32_bf16 v[240:243], v[160:163], v[246:249], 0
    ds_read_b64_tr_b16 v[192:193], v43 offset:0
    ds_read_b64_tr_b16 v[194:195], v43 offset:256
    v_mfma_f32_16x16x32_bf16 v[240:243], v[164:167], v[246:249], v[240:243]
    ds_read_b64_tr_b16 v[196:197], v43 offset:2048
    ds_read_b64_tr_b16 v[198:199], v43 offset:2304
    s_waitcnt lgkmcnt(12)
    v_mfma_f32_16x16x32_bf16 v[240:243], v[168:171], v[246:249], v[240:243]
    ds_read_b64_tr_b16 v[200:201], v41 offset:16384
    ds_read_b64_tr_b16 v[202:203], v41 offset:16640
    v_mfma_f32_16x16x32_bf16 v[240:243], v[172:175], v[246:249], v[240:243]
    ds_read_b64_tr_b16 v[204:205], v41 offset:18432
    ds_read_b64_tr_b16 v[206:207], v41 offset:18688
    buffer_load_dwordx4 v[64:67], v57, s[44:47], s14 offen sc1
    buffer_load_dwordx4 v[68:71], v57, s[44:47], s14 offen offset:512 sc1
    buffer_load_dwordx4 v[72:75], v57, s[44:47], s15 offen sc1
    s_waitcnt lgkmcnt(12)
    v_mfma_f32_16x16x32_bf16 v[240:243], v[176:179], v[246:249], v[240:243]
    ds_read_b64_tr_b16 v[208:209], v42 offset:16384
    ds_read_b64_tr_b16 v[210:211], v42 offset:16640
    v_mfma_f32_16x16x32_bf16 v[240:243], v[180:183], v[246:249], v[240:243]
    ds_read_b64_tr_b16 v[212:213], v42 offset:18432
    ds_read_b64_tr_b16 v[214:215], v42 offset:18688
    s_waitcnt lgkmcnt(12)
    v_mfma_f32_16x16x32_bf16 v[240:243], v[184:187], v[246:249], v[240:243]
    ds_read_b64_tr_b16 v[216:217], v43 offset:16384
    ds_read_b64_tr_b16 v[218:219], v43 offset:16640
    v_mfma_f32_16x16x32_bf16 v[240:243], v[188:191], v[246:249], v[240:243]
    ds_read_b64_tr_b16 v[220:221], v43 offset:18432
    ds_read_b64_tr_b16 v[222:223], v43 offset:18688
    s_waitcnt lgkmcnt(12)
    v_mfma_f32_16x16x32_bf16 v[240:243], v[192:195], v[246:249], v[240:243]
    ds_read_b64_tr_b16 v[224:225], v44 offset:32768
    ds_read_b64_tr_b16 v[226:227], v44 offset:33024
    v_mfma_f32_16x16x32_bf16 v[240:243], v[196:199], v[246:249], v[240:243]
    ds_read_b64_tr_b16 v[228:229], v44 offset:34816
    ds_read_b64_tr_b16 v[230:231], v44 offset:35072
    s_waitcnt lgkmcnt(12)
    v_mfma_f32_16x16x32_bf16 v[240:243], v[200:203], v[246:249], v[240:243]
    ds_read_b64_tr_b16 v[232:233], v44 offset:36864
    ds_read_b64_tr_b16 v[234:235], v44 offset:37120
    v_mfma_f32_16x16x32_bf16 v[240:243], v[204:207], v[246:249], v[240:243]
    ds_read_b64_tr_b16 v[236:237], v44 offset:38912
    ds_read_b64_tr_b16 v[238:239], v44 offset:39168
    s_waitcnt lgkmcnt(12)
    v_mfma_f32_16x16x32_bf16 v[240:243], v[208:211], v[246:249], v[240:243]
    v_mfma_f32_16x16x32_bf16 v[240:243], v[212:215], v[246:249], v[240:243]
    s_waitcnt lgkmcnt(8)
    v_mfma_f32_16x16x32_bf16 v[240:243], v[216:219], v[246:249], v[240:243]
    v_mfma_f32_16x16x32_bf16 v[240:243], v[220:223], v[246:249], v[240:243]
    s_waitcnt lgkmcnt(4)
    v_mfma_f32_16x16x32_bf16 v[240:243], v[224:227], v[246:249], v[240:243]
    v_mfma_f32_16x16x32_bf16 v[240:243], v[228:231], v[246:249], v[240:243]
    s_waitcnt lgkmcnt(0)
    v_mfma_f32_16x16x32_bf16 v[240:243], v[232:235], v[246:249], v[240:243]
    v_mfma_f32_16x16x32_bf16 v[240:243], v[236:239], v[246:249], v[240:243]
    v_cmp_gt_u32 vcc, 8, v47
    s_nop 6
    v_cndmask_b32 v244, v242, v240, vcc
    v_cndmask_b32 v245, v243, v241, vcc
    s_waitcnt vmcnt(0)
L_hpoll:
    v_pk_mul_f32 v[24:25], v[64:65], v[66:67]
    v_pk_fma_f32 v[24:25], v[68:69], v[70:71], v[24:25]
    v_pk_fma_f32 v[24:25], v[72:73], v[74:75], v[24:25]
    v_cmp_u_f32 vcc, v24, v25
    s_cbranch_vccz L_hok0
    s_cmp_lt_u32 s20, 32704
    s_cbranch_scc1 L_hex0
L_hre0:
    v_pk_mul_f32 v[26:27], v[64:65], v[66:67]
    v_pk_mul_f32 v[28:29], v[68:69], v[70:71]
    v_pk_mul_f32 v[30:31], v[72:73], v[74:75]
    v_cmp_u_f32 s[28:29], v26, v27
    v_cmp_u_f32 s[30:31], v28, v29
    v_cmp_u_f32 s[36:37], v30, v31
    s_sleep 2
    s_mov_b64 exec, s[28:29]
    buffer_load_dwordx4 v[64:67], v57, s[44:47], s14 offen sc1
    s_mov_b64 exec, s[30:31]
    buffer_load_dwordx4 v[68:71], v57, s[44:47], s14 offen offset:512 sc1
    s_mov_b64 exec, s[36:37]
    buffer_load_dwordx4 v[72:75], v57, s[44:47], s15 offen sc1
    s_mov_b64 exec, -1
    s_sub_u32 s20, s20, 1
    s_cmp_lg_u32 s20, 0
    s_waitcnt vmcnt(0)
    s_cbranch_scc1 L_hpoll
L_hok0:
    v_mfma_f32_16x16x32_bf16 v[156:159], v[64:67], v[64:67], 0
    ds_write_b128 v52, v[64:67] offset:4096
    v_mfma_f32_16x16x32_bf16 v[156:159], v[68:71], v[68:71], v[156:159]
    ds_write_b128 v52, v[68:71] offset:8192
    v_mfma_f32_16x16x32_bf16 v[156:159], v[72:75], v[72:75], v[156:159]
    ds_write_b128 v52, v[72:75] offset:12288
    v_mfma_f32_16x16x32_bf16 v[152:155], v[246:249], v[64:67], 0
    v_mfma_f32_16x16x32_bf16 v[152:155], v[246:249], v[68:71], v[152:155]
    v_mfma_f32_16x16x32_bf16 v[152:155], v[246:249], v[72:75], v[152:155]
    s_nop 3
    v_cndmask_b32 v24, v156, v157, s[12:13]
    v_cndmask_b32 v25, v158, v159, s[12:13]
    v_mfma_f32_16x16x32_bf16 v[144:147], v[160:163], v[64:67], 0
    v_cndmask_b32 v25, v24, v25, s[10:11]
    v_mfma_f32_16x16x32_bf16 v[148:151], v[164:167], v[64:67], 0
    ds_write2_b32 v53, v152, v25 offset0:0 offset1:1
    v_mfma_f32_16x16x32_bf16 v[144:147], v[168:171], v[68:71], v[144:147]
    v_mfma_f32_16x16x32_bf16 v[148:151], v[172:175], v[68:71], v[148:151]
L_hjoin:
    s_waitcnt lgkmcnt(0)
    s_barrier
    ds_read_b128 v[112:115], v48 offset:4096
    ds_read_b128 v[116:119], v49 offset:4096
    ds_read_b128 v[24:27], v54 offset:16384
    ds_read_b128 v[28:31], v54 offset:16400
    ds_read_b128 v[32:35], v54 offset:16416
    ds_read_b128 v[36:39], v54 offset:16432
    ds_read_b128 v[120:123], v50 offset:4096
    ds_read_b128 v[124:127], v48 offset:8192
    ds_read_b128 v[128:131], v49 offset:8192
    ds_read_b128 v[132:135], v50 offset:8192
    ds_read_b128 v[136:139], v51 offset:12288
    ds_read_b128 v[140:143], v51 offset:13312
    s_waitcnt lgkmcnt(11)
    v_mfma_f32_16x16x32_bf16 v[144:147], v[176:179], v[112:115], v[144:147]
    v_mfma_f32_16x16x32_bf16 v[148:151], v[180:183], v[112:115], v[148:151]
    s_waitcnt lgkmcnt(10)
    v_mfma_f32_16x16x32_bf16 v[144:147], v[184:187], v[116:119], v[144:147]
    v_mfma_f32_16x16x32_bf16 v[148:151], v[188:191], v[116:119], v[148:151]
    s_waitcnt lgkmcnt(6)
    s_waitcnt lgkmcnt(5)
    v_mfma_f32_16x16x32_bf16 v[144:147], v[192:195], v[120:123], v[144:147]
    v_pk_add_f32 v[24:25], v[24:25], v[26:27]
    v_pk_add_f32 v[28:29], v[28:29], v[30:31]
    v_mfma_f32_16x16x32_bf16 v[148:151], v[196:199], v[120:123], v[148:151]
    v_pk_add_f32 v[32:33], v[32:33], v[34:35]
    v_pk_add_f32 v[36:37], v[36:37], v[38:39]
    s_waitcnt lgkmcnt(4)
    v_mfma_f32_16x16x32_bf16 v[144:147], v[200:203], v[124:127], v[144:147]
    v_pk_add_f32 v[24:25], v[24:25], v[28:29]
    v_pk_add_f32 v[32:33], v[32:33], v[36:37]
    v_mfma_f32_16x16x32_bf16 v[148:151], v[204:207], v[124:127], v[148:151]
    v_pk_add_f32 v[24:25], v[24:25], v[32:33]
    v_mul_f32 v24, s25, v24
    s_waitcnt lgkmcnt(3)
    v_mfma_f32_16x16x32_bf16 v[144:147], v[208:211], v[128:131], v[144:147]
    v_mul_f32 v25, s25, v25
    v_fma_f32 v25, -v24, v24, v25
    v_mfma_f32_16x16x32_bf16 v[148:151], v[212:215], v[128:131], v[148:151]
    v_max_f32 v25, 0, v25
    v_cvt_pk_bf16_f32 v27, v24, v24
    s_waitcnt lgkmcnt(2)
    v_mfma_f32_16x16x32_bf16 v[144:147], v[216:219], v[132:135], v[144:147]
    v_lshlrev_b32 v24, 16, v27
    v_cvt_pk_bf16_f32 v27, v25, v25
    v_mfma_f32_16x16x32_bf16 v[148:151], v[220:223], v[132:135], v[148:151]
    v_lshlrev_b32 v25, 16, v27
    v_add_f32 v25, 0x3727c5ac, v25
    s_waitcnt lgkmcnt(1)
    v_mfma_f32_16x16x32_bf16 v[144:147], v[224:227], v[136:139], v[144:147]
    v_cvt_pk_bf16_f32 v27, v25, v25
    v_lshlrev_b32 v25, 16, v27
    v_mfma_f32_16x16x32_bf16 v[148:151], v[228:231], v[136:139], v[148:151]
    v_sqrt_f32 v25, v25
    s_nop 0
    v_cvt_pk_bf16_f32 v27, v25, v25
    s_waitcnt lgkmcnt(0)
    v_mfma_f32_16x16x32_bf16 v[144:147], v[232:235], v[140:143], v[144:147]
    v_lshlrev_b32 v25, 16, v27
    v_rcp_f32 v26, v25
    v_mfma_f32_16x16x32_bf16 v[148:151], v[236:239], v[140:143], v[148:151]
    s_nop 7
    v_add_f32_dpp v28, v148, v144 row_ror:8 row_mask:0xf bank_mask:0x3
    v_add_f32_dpp v29, v149, v145 row_ror:8 row_mask:0xf bank_mask:0x3
    s_nop 0
    v_add_f32_dpp v28, v146, v150 row_ror:8 row_mask:0xf bank_mask:0xc
    v_add_f32_dpp v29, v147, v151 row_ror:8 row_mask:0xf bank_mask:0xc
    v_pk_fma_f32 v[28:29], v[24:25], v[244:245], v[28:29] op_sel_hi:[0,1,1] neg_lo:[1,0,0] neg_hi:[1,0,0]
    v_pk_mul_f32 v[28:29], v[28:29], v[26:27] op_sel_hi:[1,0]
    v_cvt_pk_bf16_f32 v30, v28, v29
    v_cvt_pk_bf16_f32 v31, v28, v29
    s_nop 1
    v_permlane32_swap_b32 v30, v31
    v_lshlrev_b32 v28, 16, v30
    v_and_b32 v29, 0xffff0000, v30
    v_pk_mul_f32 v[32:33], v[28:29], v[28:29]
    v_pk_fma_f32 v[32:33], v[32:33], v[252:253], v[250:251] op_sel_hi:[1,0,0]
    v_pk_mul_f32 v[32:33], v[32:33], v[28:29]
    v_exp_f32 v32, v32
    v_exp_f32 v33, v33
    v_lshlrev_b32 v34, 16, v31
    v_pk_add_f32 v[32:33], v[32:33], v[254:255] op_sel_hi:[1,0]
    v_rcp_f32 v32, v32
    v_rcp_f32 v33, v33
    v_and_b32 v35, 0xffff0000, v31
    v_pk_mul_f32 v[28:29], v[28:29], v[32:33]
    v_cvt_pk_bf16_f32 v30, v28, v29
    v_lshlrev_b32 v28, 16, v30
    v_and_b32 v29, 0xffff0000, v30
    v_pk_mul_f32 v[28:29], v[28:29], v[34:35]
    v_cvt_pk_bf16_f32 v30, v28, v29
    buffer_store_dword v30, v55, s[32:35], s21 offen sc1
    buffer_store_dword v30, v55, s[32:35], s26 offen sc1
    s_branch L_fin
L_reducer:
    v_lshrrev_b32 v59, 3, v1
    v_mul_u32_u24 v56, 2560, v59
    v_and_b32 v57, 7, v1
    v_lshlrev_b32 v58, 4, v57
    v_add_u32 v56, v56, v58
    v_mul_u32_u24 v59, 10752, v59
    v_lshl_add_u32 v57, v57, 3, v59
    s_mul_i32 s14, s72, 79360
    s_lshl_b32 s15, s20, 1
    s_add_u32 s14, s14, s15
    s_add_u32 s15, s14, 20480
    s_add_u32 s17, s14, 40960
    s_add_u32 s19, s14, 61440
    s_waitcnt vmcnt(0)
    s_mov_b32 s21, 0x8000
    buffer_load_dwordx4 v[80:83], v56, s[44:47], s14 offen sc1
    buffer_load_dwordx4 v[84:87], v56, s[44:47], s15 offen sc1
    buffer_load_dwordx4 v[88:91], v56, s[44:47], s17 offen sc1
    buffer_load_dwordx4 v[92:95], v56, s[44:47], s19 offen sc1
    s_sleep 2
    buffer_load_dwordx4 v[96:99], v56, s[44:47], s14 offen sc1
    buffer_load_dwordx4 v[100:103], v56, s[44:47], s15 offen sc1
    buffer_load_dwordx4 v[104:107], v56, s[44:47], s17 offen sc1
    buffer_load_dwordx4 v[108:111], v56, s[44:47], s19 offen sc1
    v_and_b32 v57, 7, v1
    v_lshlrev_b32 v57, 3, v57
    v_lshrrev_b32 v58, 5, v1
    v_lshl_add_u32 v57, v58, 2, v57
    v_bfe_u32 v61, v1, 3, 2
    v_mul_u32_u24 v59, 10752, v61
    v_add_u32 v57, v57, v59
    v_cmp_eq_u32 vcc, 0, v58
    v_and_b32 v58, 1, v46
    v_mov_b32 v60, 2130706432
    v_cndmask_b32 v62, v63, v62, vcc
    v_cmp_eq_u32 vcc, 0, v58
    v_lshlrev_b32 v63, 16, v62
    v_and_b32 v62, 0xffff0000, v62
    v_cndmask_b32 v62, v62, v63, vcc
    v_cmp_gt_u32 vcc, 1, v61
    s_nop 1
    v_cndmask_b32 v60, v60, v57, vcc
    s_add_u32 s22, s20, 655360
    s_add_u32 s23, s22, 43008
    s_add_u32 s24, s23, 43008
L_rpoll:
    s_waitcnt vmcnt(4)
    v_pk_add_f32 v[64:65], v[80:81], v[84:85]
    v_pk_add_f32 v[72:73], v[88:89], v[92:93]
    v_pk_add_f32 v[66:67], v[82:83], v[86:87]
    v_pk_add_f32 v[74:75], v[90:91], v[94:95]
    v_pk_add_f32 v[64:65], v[64:65], v[72:73]
    v_pk_add_f32 v[66:67], v[66:67], v[74:75]
    s_nop 1
    v_permlane32_swap_b32 v64, v66
    v_permlane32_swap_b32 v65, v67
    v_pk_add_f32 v[68:69], v[64:65], v[66:67]
    v_cmp_u_f32 vcc, v68, v69
    s_cbranch_vccz L_rok0
    s_cmp_lt_u32 s21, 32704
    s_cbranch_scc1 L_rex0
L_rre0:
    buffer_load_dwordx4 v[80:83], v56, s[44:47], s14 offen sc1
    buffer_load_dwordx4 v[84:87], v56, s[44:47], s15 offen sc1
    buffer_load_dwordx4 v[88:91], v56, s[44:47], s17 offen sc1
    buffer_load_dwordx4 v[92:95], v56, s[44:47], s19 offen sc1
    s_sleep 2
    s_waitcnt vmcnt(4)
    v_pk_add_f32 v[64:65], v[96:97], v[100:101]
    v_pk_add_f32 v[72:73], v[104:105], v[108:109]
    v_pk_add_f32 v[66:67], v[98:99], v[102:103]
    v_pk_add_f32 v[74:75], v[106:107], v[110:111]
    v_pk_add_f32 v[64:65], v[64:65], v[72:73]
    v_pk_add_f32 v[66:67], v[66:67], v[74:75]
    s_nop 1
    v_permlane32_swap_b32 v64, v66
    v_permlane32_swap_b32 v65, v67
    v_pk_add_f32 v[68:69], v[64:65], v[66:67]
    v_cmp_u_f32 vcc, v68, v69
    s_cbranch_vccz L_rok0
    s_cmp_lt_u32 s21, 32704
    s_cbranch_scc1 L_rex1
L_rre1:
    buffer_load_dwordx4 v[96:99], v56, s[44:47], s14 offen sc1
    buffer_load_dwordx4 v[100:103], v56, s[44:47], s15 offen sc1
    buffer_load_dwordx4 v[104:107], v56, s[44:47], s17 offen sc1
    buffer_load_dwordx4 v[108:111], v56, s[44:47], s19 offen sc1
    s_sleep 2
    s_sub_u32 s21, s21, 1
    s_cmp_lg_u32 s21, 0
    s_cbranch_scc1 L_rpoll
L_rok0:
L_rjoin:
    v_permlane16_swap_b32 v68, v69
    v_add_f32 v68, v68, v69
    s_nop 1
    v_add_f32_dpp v68, v68, v68 row_ror:8 row_mask:0xf bank_mask:0xf
    v_cvt_pk_bf16_f32 v68, v68, v68
    v_lshlrev_b32 v68, 16, v68
    v_add_f32 v68, v68, v62
    v_mov_b32 v69, v68
    s_nop 1
    v_permlane16_swap_b32 v68, v69
    v_cvt_pk_bf16_f32 v68, v68, v69
    buffer_store_dword v68, v57, s[44:47], s22 offen sc1
    buffer_store_dword v68, v57, s[44:47], s23 offen sc1
    buffer_store_dword v68, v60, s[44:47], s24 offen sc1
    s_branch L_fin
L_down:
    v_and_b32 v56, 7, v47
    v_lshrrev_b32 v58, 3, v47
    v_lshlrev_b32 v57, 7, v46
    v_lshl_add_u32 v57, v56, 4, v57
    v_lshl_add_u32 v57, v58, 11, v57
    s_lshl_b32 s14, s3, 9
    v_add_u32 v57, s14, v57
    v_mul_u32_u24 v60, 1280, v56
    v_lshl_add_u32 v60, v46, 3, v60
    v_lshl_add_u32 v60, v58, 2, v60
    s_lshl_b32 s21, s18, 5
    s_mov_b32 s22, 86016
    s_add_u32 s22, s22, s21
    s_add_u32 s22, s22, 655360
    v_lshrrev_b32 v41, 2, v47
    v_lshl_add_u32 v41, v46, 3, v41
    v_lshlrev_b32 v41, 5, v41
    v_and_b32 v42, 3, v47
    v_lshl_add_u32 v41, v42, 3, v41
    s_mul_i32 s14, s3, 14336
    s_add_u32 s14, s14, 32768
    v_add_u32 v41, s14, v41
    v_lshlrev_b32 v59, 3, v1
    v_add_u32 v58, s14, v59
    s_lshl_b32 s14, s3, 9
    v_add_u32 v58, s14, v59
    s_waitcnt vmcnt(0)
    ds_read_b64_tr_b16 v[192:193], v41 offset:0
    ds_read_b64_tr_b16 v[194:195], v41 offset:128
    ds_read_b64_tr_b16 v[196:197], v41 offset:1024
    ds_read_b64_tr_b16 v[198:199], v41 offset:1152
    ds_read_b64_tr_b16 v[200:201], v41 offset:2048
    ds_read_b64_tr_b16 v[202:203], v41 offset:2176
    ds_read_b64_tr_b16 v[204:205], v41 offset:3072
    ds_read_b64_tr_b16 v[206:207], v41 offset:3200
    ds_read_b64_tr_b16 v[208:209], v41 offset:4096
    ds_read_b64_tr_b16 v[210:211], v41 offset:4224
    ds_read_b64_tr_b16 v[212:213], v41 offset:5120
    ds_read_b64_tr_b16 v[214:215], v41 offset:5248
    ds_read_b64_tr_b16 v[216:217], v41 offset:6144
    ds_read_b64_tr_b16 v[218:219], v41 offset:6272
    ds_read_b64_tr_b16 v[220:221], v41 offset:7168
    ds_read_b64_tr_b16 v[222:223], v41 offset:7296
    ds_read_b64_tr_b16 v[224:225], v41 offset:8192
    ds_read_b64_tr_b16 v[226:227], v41 offset:8320
    ds_read_b64_tr_b16 v[228:229], v41 offset:9216
    ds_read_b64_tr_b16 v[230:231], v41 offset:9344
    ds_read_b64_tr_b16 v[232:233], v41 offset:10240
    ds_read_b64_tr_b16 v[234:235], v41 offset:10368
    ds_read_b64_tr_b16 v[236:237], v41 offset:11264
    ds_read_b64_tr_b16 v[238:239], v41 offset:11392
    ds_read_b64_tr_b16 v[240:241], v41 offset:12288
    ds_read_b64_tr_b16 v[242:243], v41 offset:12416
    ds_read_b64_tr_b16 v[244:245], v41 offset:13312
    ds_read_b64_tr_b16 v[246:247], v41 offset:13440
    s_mov_b32 s15, 4096
    s_mov_b32 s17, 8192
    s_mov_b32 s19, 12288
    s_mov_b32 s23, 16384
    s_mov_b32 s24, 20480
    s_mov_b32 s25, 24576
    s_cmp_lg_u32 s3, 0
    s_cbranch_scc1 L_gok
    s_mov_b32 s20, 0x8000
L_gpoll:
    buffer_load_dword v61, v60, s[44:47], s22 offen sc1
    s_waitcnt vmcnt(0)
    v_cmp_eq_u32 vcc, -1, v61
    s_nop 3
    s_cbranch_vccz L_gok
    s_sleep 2
    s_sub_u32 s20, s20, 1
    s_cmp_lg_u32 s20, 0
    s_cbranch_scc1 L_gpoll
L_gok:
    s_barrier
    s_mov_b32 s20, 0x8000
    buffer_load_dwordx4 v[64:67], v57, s[32:35], 0 offen sc1
    buffer_load_dwordx4 v[68:71], v57, s[32:35], s15 offen sc1
    buffer_load_dwordx4 v[72:75], v57, s[32:35], s17 offen sc1
    buffer_load_dwordx4 v[76:79], v57, s[32:35], s19 offen sc1
    buffer_load_dwordx4 v[80:83], v57, s[32:35], s23 offen sc1
    buffer_load_dwordx4 v[84:87], v57, s[32:35], s24 offen sc1
    buffer_load_dwordx4 v[88:91], v57, s[32:35], s25 offen sc1
L_apoll:
    s_waitcnt vmcnt(0)
    v_pk_mul_f32 v[24:25], v[64:65], v[66:67]
    v_pk_fma_f32 v[24:25], v[68:69], v[70:71], v[24:25]
    v_pk_fma_f32 v[24:25], v[72:73], v[74:75], v[24:25]
    v_pk_fma_f32 v[24:25], v[76:77], v[78:79], v[24:25]
    v_pk_fma_f32 v[24:25], v[80:81], v[82:83], v[24:25]
    v_pk_fma_f32 v[24:25], v[84:85], v[86:87], v[24:25]
    v_pk_fma_f32 v[24:25], v[88:89], v[90:91], v[24:25]
    v_cmp_u_f32 vcc, v24, v25
    s_cbranch_vccz L_aok0
    s_cmp_lt_u32 s20, 32704
    s_cbranch_scc1 L_aex0
L_are0:
    s_sleep 1
    buffer_load_dwordx4 v[64:67], v57, s[32:35], 0 offen sc1
    buffer_load_dwordx4 v[68:71], v57, s[32:35], s15 offen sc1
    buffer_load_dwordx4 v[72:75], v57, s[32:35], s17 offen sc1
    buffer_load_dwordx4 v[76:79], v57, s[32:35], s19 offen sc1
    buffer_load_dwordx4 v[80:83], v57, s[32:35], s23 offen sc1
    buffer_load_dwordx4 v[84:87], v57, s[32:35], s24 offen sc1
    buffer_load_dwordx4 v[88:91], v57, s[32:35], s25 offen sc1
    s_sub_u32 s20, s20, 1
    s_cmp_lg_u32 s20, 0
    s_cbranch_scc1 L_apoll
L_aok0:
    s_waitcnt lgkmcnt(0)
    v_mfma_f32_16x16x32_bf16 v[32:35], v[192:195], v[64:67], 0
    v_mfma_f32_16x16x32_bf16 v[36:39], v[196:199], v[64:67], 0
    v_mfma_f32_16x16x32_bf16 v[32:35], v[200:203], v[68:71], v[32:35]
    v_mfma_f32_16x16x32_bf16 v[36:39], v[204:207], v[68:71], v[36:39]
    v_mfma_f32_16x16x32_bf16 v[32:35], v[208:211], v[72:75], v[32:35]
    v_mfma_f32_16x16x32_bf16 v[36:39], v[212:215], v[72:75], v[36:39]
    v_mfma_f32_16x16x32_bf16 v[32:35], v[216:219], v[76:79], v[32:35]
    v_mfma_f32_16x16x32_bf16 v[36:39], v[220:223], v[76:79], v[36:39]
    v_mfma_f32_16x16x32_bf16 v[32:35], v[224:227], v[80:83], v[32:35]
    v_mfma_f32_16x16x32_bf16 v[36:39], v[228:231], v[80:83], v[36:39]
    v_mfma_f32_16x16x32_bf16 v[32:35], v[232:235], v[84:87], v[32:35]
    v_mfma_f32_16x16x32_bf16 v[36:39], v[236:239], v[84:87], v[36:39]
    v_mfma_f32_16x16x32_bf16 v[32:35], v[240:243], v[88:91], v[32:35]
    v_mfma_f32_16x16x32_bf16 v[36:39], v[244:247], v[88:91], v[36:39]
L_ajoin:
    v_lshlrev_b32 v28, 16, v61
    v_and_b32 v29, 0xffff0000, v61
    s_nop 5
    v_add_f32_dpp v24, v36, v32 row_ror:8 row_mask:0xf bank_mask:0x3
    v_add_f32_dpp v25, v37, v33 row_ror:8 row_mask:0xf bank_mask:0x3
    s_nop 0
    v_add_f32_dpp v24, v34, v38 row_ror:8 row_mask:0xf bank_mask:0xc
    v_add_f32_dpp v25, v35, v39 row_ror:8 row_mask:0xf bank_mask:0xc
    ds_write_b64 v58, v[24:25] offset:0
    s_waitcnt lgkmcnt(0)
    s_barrier
    s_cmp_lg_u32 s3, 0
    s_cbranch_scc1 L_dfin
    ds_read_b64 v[30:31], v59 offset:512
    ds_read_b64 v[32:33], v59 offset:1024
    ds_read_b64 v[34:35], v59 offset:1536
    s_waitcnt lgkmcnt(1)
    v_pk_add_f32 v[24:25], v[24:25], v[30:31]
    s_waitcnt lgkmcnt(0)
    v_pk_add_f32 v[32:33], v[32:33], v[34:35]
    v_pk_add_f32 v[24:25], v[24:25], v[32:33]
    v_cvt_pk_bf16_f32 v26, v24, v25
    v_lshlrev_b32 v24, 16, v26
    v_and_b32 v25, 0xffff0000, v26
    v_pk_add_f32 v[24:25], v[24:25], v[28:29]
    v_cvt_pk_bf16_f32 v26, v24, v25
    buffer_store_dword v26, v60, s[64:67], s21 offen
L_dfin:
L_fin:
L_end:
    s_endpgm
L_hex0:
    s_waitcnt vmcnt(0)
    v_max3_u32 v61, v64, v65, v66
    v_max3_u32 v61, v61, v67, v68
    v_max3_u32 v61, v61, v69, v70
    v_max3_u32 v61, v61, v71, v72
    v_max3_u32 v61, v61, v73, v74
    v_max_u32 v61, v61, v75
    v_cmp_eq_u32 vcc, -1, v61
    s_nop 3
    s_cbranch_vccnz L_hre0
    v_pk_mul_f32 v[24:25], v[64:65], v[66:67]
    v_pk_fma_f32 v[24:25], v[68:69], v[70:71], v[24:25]
    v_pk_fma_f32 v[24:25], v[72:73], v[74:75], v[24:25]
    v_cmp_u_f32 vcc, v24, v25
    s_nop 3
    s_branch L_hok0
L_rex0:
    v_max3_u32 v58, v80, v81, v82
    v_max3_u32 v58, v58, v83, v84
    v_max3_u32 v58, v58, v85, v86
    v_max3_u32 v58, v58, v87, v88
    v_max3_u32 v58, v58, v89, v90
    v_max3_u32 v58, v58, v91, v92
    v_max3_u32 v58, v58, v93, v94
    v_max_u32 v58, v58, v95
    v_cmp_eq_u32 vcc, -1, v58
    s_nop 3
    s_cbranch_vccz L_rok0
    s_branch L_rre0
L_rex1:
    v_max3_u32 v58, v96, v97, v98
    v_max3_u32 v58, v58, v99, v100
    v_max3_u32 v58, v58, v101, v102
    v_max3_u32 v58, v58, v103, v104
    v_max3_u32 v58, v58, v105, v106
    v_max3_u32 v58, v58, v107, v108
    v_max3_u32 v58, v58, v109, v110
    v_max_u32 v58, v58, v111
    v_cmp_eq_u32 vcc, -1, v58
    s_nop 3
    s_cbranch_vccz L_rok0
    s_branch L_rre1
L_aex0:
    v_max3_u32 v56, v64, v65, v66
    v_max3_u32 v56, v56, v67, v68
    v_max3_u32 v56, v56, v69, v70
    v_max3_u32 v56, v56, v71, v72
    v_max3_u32 v56, v56, v73, v74
    v_max3_u32 v56, v56, v75, v76
    v_max3_u32 v56, v56, v77, v78
    v_max3_u32 v56, v56, v79, v80
    v_max3_u32 v56, v56, v81, v82
    v_max3_u32 v56, v56, v83, v84
    v_max3_u32 v56, v56, v85, v86
    v_max3_u32 v56, v56, v87, v88
    v_max3_u32 v56, v56, v89, v90
    v_max_u32 v56, v56, v91
    v_cmp_eq_u32 vcc, -1, v56
    s_nop 3
    s_cbranch_vccz L_aok0
    s_branch L_are0
.section .rodata,"a"
.p2align 6
.amdhsa_kernel sequential_preLN__mha_block_cached__geglu_ffn__decode_kernel
.amdhsa_next_free_vgpr 512
.amdhsa_next_free_sgpr 102
.amdhsa_accum_offset 256
.amdhsa_group_segment_fixed_size 0
.amdhsa_kernarg_size 96
.amdhsa_user_sgpr_count 2
.amdhsa_user_sgpr_kernarg_segment_ptr 1
.amdhsa_system_sgpr_workgroup_id_x 1
.amdhsa_float_denorm_mode_32 3
.end_amdhsa_kernel
```
